```python
import torch

def _softmax(x, axis=-1):
    return torch.softmax(x, dim=axis)

def _gelu(x):
    return torch.nn.functional.gelu(x, approximate='tanh')

def _silu(x):
    return torch.nn.functional.silu(x)

def _sigmoid(x):
    return torch.sigmoid(x)

def _layernorm(x, axis=-1, eps=1e-05):
    m = x.mean(dim=axis, keepdim=True)
    v = x.var(dim=axis, keepdim=True, unbiased=False)
    return (x - m) / torch.sqrt(v + eps)

def _scatter_add(tgt, idx, src, axis=0):
    return tgt.clone().index_add_(axis, idx, src)

def _segment_sum(src, seg, n):
    out = torch.zeros((n,) + src.shape[1:], dtype=src.dtype)
    return out.index_add_(0, seg, src)

def _pad(x, pw):
    flat = tuple((v for pair in reversed(pw) for v in pair))
    return torch.nn.functional.pad(x, flat)
kernel_name = 'gated_mix__memory_aug_recurrent_mem_tr__sliding_local_dilated__prompt'

def setup_inputs():

    _w = lambda a: (lambda t: t.to(torch.bfloat16) if t.is_floating_point() else t)(torch.as_tensor(a))

    def _A_setup():
        B, S, Dm = (1, 2048, 512)
        H, Dh = (32, 128)
        M, seg = (8, 32)
        seg = min(seg, S)
        S = S // seg * seg
        return {'x': _w((lambda *s: torch.randn(*s, dtype=torch.bfloat16) * 0.05)(B, S, Dm)), 'mem0': _w((lambda *s: torch.randn(*s, dtype=torch.bfloat16) * 1.6)(B, M, Dm)), 'Wq': _w((lambda *s: torch.randn(*s, dtype=torch.bfloat16) * 0.8)(Dm, H, Dh) * Dm ** (-0.5)), 'Wk': _w((lambda *s: torch.randn(*s, dtype=torch.bfloat16) * 0.8)(Dm, H, Dh) * Dm ** (-0.5)), 'Wv': _w((lambda *s: torch.randn(*s, dtype=torch.bfloat16) * 1.6)(Dm, H, Dh) * Dm ** (-0.5)), 'Wo': _w((lambda *s: torch.randn(*s, dtype=torch.bfloat16) * 1.6)(H, Dh, Dm) * (H * Dh) ** (-0.5)), 'seg_len': seg}
    _A_in = _A_setup()

    def _B_setup():
        B, S, D = (1, 2048, 512)
        return {'x': _w((lambda *s: torch.randn(*s, dtype=torch.bfloat16) * 0.05)(B, S, D)), 'wqkv': _w((lambda *s: torch.randn(*s, dtype=torch.bfloat16) * 0.8)(D, 3 * D)), 'wo': _w((lambda *s: torch.randn(*s, dtype=torch.bfloat16) * 0.05)(D, D))}
    _B_in = _B_setup()
    return {'A_x': _A_in['x'], 'A_mem0': _A_in['mem0'], 'A_Wq': _A_in['Wq'], 'A_Wk': _A_in['Wk'], 'A_Wv': _A_in['Wv'], 'A_Wo': _A_in['Wo'], 'A_seg_len': _A_in['seg_len'], 'B_x': _B_in['x'], 'B_wqkv': _B_in['wqkv'], 'B_wo': _B_in['wo'], 'gate_w': _w((lambda *s: torch.randn(*s, dtype=torch.bfloat16) * 0.05)(512) * 16.0)}

def reference(A_x, A_mem0, A_Wq, A_Wk, A_Wv, A_Wo, A_seg_len, B_x, B_wqkv, B_wo, gate_w):

    def _A_ref(x, mem0, Wq, Wk, Wv, Wo, seg_len):
        B, S, Dm = x.shape
        H, Dh = (Wq.shape[1], Wq.shape[2])
        M = mem0.shape[1]
        scale = Dh ** (-0.5)
        n_seg = S // seg_len
        L = M + seg_len
        idx = torch.arange(L)
        mask = (idx[:, None] < M) | (idx[:, None] >= idx[None, :])
        mem = mem0
        outs = []
        for s in range(n_seg):
            xs = x[:, s * seg_len:(s + 1) * seg_len, :].clone()
            h = torch.concatenate([mem, xs], axis=1)
            q = torch.einsum('btd,dhe->bhte', h, Wq)
            k = torch.einsum('btd,dhe->bhte', h, Wk)
            v = torch.einsum('btd,dhe->bhte', h, Wv)
            scores = torch.einsum('bhqe,bhke->bhqk', q, k) * scale
            scores = torch.where(mask[None, None], scores, -1000000000.0)
            p = _softmax(scores, axis=-1)
            o = torch.einsum('bhqk,bhke->bhqe', p, v)
            o = torch.einsum('bhte,hed->btd', o, Wo)
            mem = o[:, :M, :].clone()
            outs.append(o[:, M:, :])
        return torch.concatenate(outs, axis=1)

    def _B_ref(x, wqkv, wo):
        B, S, D = x.shape
        H = 32
        Dh = D // H
        W, dil = (8, 2)
        qkv = (lambda x, *d: x.permute(*d))((x @ wqkv).reshape(B, S, 3, H, Dh), 2, 0, 3, 1, 4)
        q, k, v = (qkv[0], qkv[1], qkv[2])
        scale = Dh ** (-0.5)
        pos = torch.arange(S)
        off = torch.arange(W) * dil
        idx = pos[:, None] - off[None, :]
        mask = idx >= 0
        idx_c = torch.where(mask, idx, 0).reshape(-1)
        kg = k[:, :, idx_c, :].reshape(B, H, S, W, Dh)
        vg = v[:, :, idx_c, :].reshape(B, H, S, W, Dh)
        logits = torch.einsum('bhsd,bhswd->bhsw', q, kg) * scale
        logits = torch.where(mask[None, None, :, :], logits, -1000000000.0)
        attn = _softmax(logits, axis=-1)
        o = torch.einsum('bhsw,bhswd->bhsd', attn, vg)
        return (lambda x, *d: x.permute(*d))(o, 0, 2, 1, 3).reshape(B, S, D) @ wo
    x = A_x
    g = _sigmoid((x * gate_w).sum(-1, keepdims=True))
    a = _A_ref(x, A_mem0, A_Wq, A_Wk, A_Wv, A_Wo, A_seg_len)
    b = _B_ref(x, B_wqkv, B_wo)
    return g * a + (1 - g) * b
```

```asm
; @launch grid=(256,1,1) block=(256,1,1) lds=163840
.amdgcn_target "amdgcn-amd-amdhsa--gfx950"
.text
.globl gated_mix__memory_aug_recurrent_mem_tr__sliding_local_dilated__prompt_kernel
.p2align 8
.type gated_mix__memory_aug_recurrent_mem_tr__sliding_local_dilated__prompt_kernel,@function
gated_mix__memory_aug_recurrent_mem_tr__sliding_local_dilated__prompt_kernel:
    s_cmp_ge_u32 s2, 256
    s_cbranch_scc1 L_exit
    s_load_dwordx16 s[32:47], s[0:1], 0
    s_load_dwordx8 s[48:55], s[0:1], 64
    s_load_dwordx4 s[56:59], s[0:1], 96
    s_getreg_b32 s20, hwreg(HW_REG_XCC_ID)
    v_lshrrev_b32 v1, 6, v0
    s_and_b32 s20, s20, 7
    v_readfirstlane_b32 s18, v1
    s_mov_b32 s60, 0x400000
    s_xor_b32 s20, s20, 3
    s_waitcnt lgkmcnt(0)
    s_mov_b32 s4, s58
    s_mov_b32 s5, s59
    s_mov_b32 s6, 0x10000000
    s_mov_b32 s7, 0x20000
    s_mov_b32 s12, s56
    s_mov_b32 s13, s57
    s_mov_b32 s14, 0x100
    s_mov_b32 s15, 0x20000
    s_mul_i32 s21, s20, 24
    s_add_u32 s21, s21, 40
    s_cmp_eq_u32 s20, 0
    s_cselect_b32 s21, 0, s21
    s_mov_b32 s29, s21
    s_lshr_b32 s17, s2, 3
    s_lshl_b32 s28, 1, s17
    s_mov_b32 s16, s20
    s_mov_b32 s19, 0
    v_mov_b32 v2, s21
    v_mov_b32 v63, s28
    v_cmp_ne_u32 vcc, 0, v0
    v_mov_b32 v4, 0x40000000
    s_nop 0
    v_cndmask_b32 v2, v2, v4, vcc
    buffer_atomic_or v63, v2, s[12:15], 0 offen sc0
    s_mov_b32 s8, s32
    s_mov_b32 s9, s33
    s_mov_b32 s10, 0x200000
    s_mov_b32 s11, 0x20000
    v_and_b32 v5, 63, v0
    v_lshlrev_b32 v5, 4, v5
    s_lshl_b32 s22, s2, 13
    s_lshl_b32 s23, s18, 11
    s_add_u32 s22, s22, s23
    buffer_load_dwordx4 v[8:11], v5, s[8:11], s22 offen
    buffer_load_dwordx4 v[12:15], v5, s[8:11], s22 offen offset:1024
    s_mov_b32 s24, s52
    s_mov_b32 s25, s53
    s_mov_b32 s26, 0x400
    s_mov_b32 s27, 0x20000
    buffer_load_dwordx4 v[16:19], v5, s[24:27], 0 offen
    v_mov_b32 v20, -1
    v_mov_b32 v21, -1
    v_mov_b32 v22, -1
    v_mov_b32 v23, -1
    v_mov_b32 v24, 0
    v_mov_b32 v25, 0
    v_mov_b32 v26, 0
    v_mov_b32 v27, 0
    v_lshlrev_b32 v6, 4, v0
    s_lshl_b32 s22, s2, 12
    s_add_u32 s22, s22, 0x4400000
    buffer_store_dwordx4 v[20:23], v6, s[4:7], s22 offen sc1
    v_cmp_le_u32 vcc, 0x80, v0
    s_lshl_b32 s22, s2, 11
    s_add_u32 s22, s22, 0x4300000
    v_cndmask_b32 v7, v6, v4, vcc
    buffer_store_dwordx4 v[24:27], v7, s[4:7], s22 offen sc1
L_role_ok:
    s_cmp_eq_u32 s16, 0
    s_cbranch_scc1 L_R
    s_branch L_worker
L_R:
    v_and_b32 v1, 63, v0
    v_lshrrev_b32 v2, 4, v1
    v_and_b32 v3, 15, v1
    v_lshlrev_b32 v4, 4, v3
    v_lshl_add_u32 v28, v2, 17, v4
    v_and_b32 v4, 0x70, v4
    v_lshrrev_b32 v3, 3, v3
    v_lshl_add_u32 v4, v3, 9, v4
    v_lshl_add_u32 v29, v2, 14, v4
    s_lshl_b32 s21, s18, 7
    v_add_u32 v29, s21, v29
    s_mul_i32 s78, s18, 16896
    s_mov_b32 s8, s42
    s_mov_b32 s9, s43
    s_mov_b32 s10, 0x400000
    s_mov_b32 s11, 0x20000
    s_add_u32 m0, s78, 0
    s_lshl_b32 s21, s17, 17
    s_add_u32 s21, s21, 0
    buffer_load_dwordx4 v29, s[8:11], s21 offen lds
    s_add_u32 m0, m0, 1056
    s_add_u32 s21, s21, 1024
    buffer_load_dwordx4 v29, s[8:11], s21 offen lds
    s_add_u32 m0, m0, 1056
    s_add_u32 s21, s21, 1024
    buffer_load_dwordx4 v29, s[8:11], s21 offen lds
    s_add_u32 m0, m0, 1056
    s_add_u32 s21, s21, 1024
    buffer_load_dwordx4 v29, s[8:11], s21 offen lds
    s_add_u32 m0, m0, 1056
    s_add_u32 s21, s21, 1024
    buffer_load_dwordx4 v29, s[8:11], s21 offen lds
    s_add_u32 m0, m0, 1056
    s_add_u32 s21, s21, 1024
    buffer_load_dwordx4 v29, s[8:11], s21 offen lds
    s_add_u32 m0, m0, 1056
    s_add_u32 s21, s21, 1024
    buffer_load_dwordx4 v29, s[8:11], s21 offen lds
    s_add_u32 m0, m0, 1056
    s_add_u32 s21, s21, 1024
    buffer_load_dwordx4 v29, s[8:11], s21 offen lds
    s_add_u32 m0, m0, 1056
    s_add_u32 s21, s21, 1024
    buffer_load_dwordx4 v29, s[8:11], s21 offen lds
    s_add_u32 m0, m0, 1056
    s_add_u32 s21, s21, 1024
    buffer_load_dwordx4 v29, s[8:11], s21 offen lds
    s_add_u32 m0, m0, 1056
    s_add_u32 s21, s21, 1024
    buffer_load_dwordx4 v29, s[8:11], s21 offen lds
    s_add_u32 m0, m0, 1056
    s_add_u32 s21, s21, 1024
    buffer_load_dwordx4 v29, s[8:11], s21 offen lds
    s_add_u32 m0, m0, 1056
    s_add_u32 s21, s21, 1024
    buffer_load_dwordx4 v29, s[8:11], s21 offen lds
    s_add_u32 m0, m0, 1056
    s_add_u32 s21, s21, 1024
    buffer_load_dwordx4 v29, s[8:11], s21 offen lds
    s_add_u32 m0, m0, 1056
    s_add_u32 s21, s21, 1024
    buffer_load_dwordx4 v29, s[8:11], s21 offen lds
    s_add_u32 m0, m0, 1056
    s_add_u32 s21, s21, 1024
    buffer_load_dwordx4 v29, s[8:11], s21 offen lds
    s_getpc_b64 s[12:13]
L_pc_1:
    s_add_u32 s12, s12, T_R-L_pc_1
    s_addc_u32 s13, s13, 0
    s_mov_b32 s14, 28672
    s_mov_b32 s15, 0x20000
    v_mul_u32_u24 v7, 112, v0
    buffer_load_dwordx4 v[96:99], v7, s[12:15], 0 offen offset:0
    buffer_load_dwordx4 v[100:103], v7, s[12:15], 0 offen offset:16
    buffer_load_dwordx4 v[104:107], v7, s[12:15], 0 offen offset:32
    buffer_load_dwordx4 v[108:111], v7, s[12:15], 0 offen offset:48
    buffer_load_dwordx4 v[112:115], v7, s[12:15], 0 offen offset:64
    buffer_load_dwordx4 v[116:119], v7, s[12:15], 0 offen offset:80
    buffer_load_dwordx4 v[120:123], v7, s[12:15], 0 offen offset:96
    s_cmp_eq_u32 s19, 1
    s_cbranch_scc1 L_cf_2
    v_mov_b32 v62, 163808
    s_cmp_lg_u32 s18, 0
    s_cbranch_scc1 L_cfs_3
    s_waitcnt vmcnt(28)
    v_readfirstlane_b32 s21, v63
    s_nop 1
    v_mov_b32 v63, s21
    ds_write_b32 v62, v63
    s_waitcnt lgkmcnt(0)
L_cfs_3:
    s_barrier
    ds_read_b32 v61, v62
    s_waitcnt lgkmcnt(0)
    v_readfirstlane_b32 s21, v61
    s_mov_b32 s19, 1
    s_and_b32 s22, s21, s28
    s_cbranch_scc1 L_reclaim
L_cf_2:
    s_add_u32 m0, s78, 67584
    s_lshl_b32 s21, s17, 17
    s_add_u32 s21, s21, 65536
    buffer_load_dwordx4 v29, s[8:11], s21 offen lds
    s_add_u32 m0, m0, 1056
    s_add_u32 s21, s21, 1024
    buffer_load_dwordx4 v29, s[8:11], s21 offen lds
    s_add_u32 m0, m0, 1056
    s_add_u32 s21, s21, 1024
    buffer_load_dwordx4 v29, s[8:11], s21 offen lds
    s_add_u32 m0, m0, 1056
    s_add_u32 s21, s21, 1024
    buffer_load_dwordx4 v29, s[8:11], s21 offen lds
    s_add_u32 m0, m0, 1056
    s_add_u32 s21, s21, 1024
    buffer_load_dwordx4 v29, s[8:11], s21 offen lds
    s_add_u32 m0, m0, 1056
    s_add_u32 s21, s21, 1024
    buffer_load_dwordx4 v29, s[8:11], s21 offen lds
    s_add_u32 m0, m0, 1056
    s_add_u32 s21, s21, 1024
    buffer_load_dwordx4 v29, s[8:11], s21 offen lds
    s_add_u32 m0, m0, 1056
    s_add_u32 s21, s21, 1024
    buffer_load_dwordx4 v29, s[8:11], s21 offen lds
    s_add_u32 m0, m0, 1056
    s_add_u32 s21, s21, 1024
    buffer_load_dwordx4 v29, s[8:11], s21 offen lds
    s_add_u32 m0, m0, 1056
    s_add_u32 s21, s21, 1024
    buffer_load_dwordx4 v29, s[8:11], s21 offen lds
    s_add_u32 m0, m0, 1056
    s_add_u32 s21, s21, 1024
    buffer_load_dwordx4 v29, s[8:11], s21 offen lds
    s_add_u32 m0, m0, 1056
    s_add_u32 s21, s21, 1024
    buffer_load_dwordx4 v29, s[8:11], s21 offen lds
    s_add_u32 m0, m0, 1056
    s_add_u32 s21, s21, 1024
    buffer_load_dwordx4 v29, s[8:11], s21 offen lds
    s_add_u32 m0, m0, 1056
    s_add_u32 s21, s21, 1024
    buffer_load_dwordx4 v29, s[8:11], s21 offen lds
    s_add_u32 m0, m0, 1056
    s_add_u32 s21, s21, 1024
    buffer_load_dwordx4 v29, s[8:11], s21 offen lds
    s_add_u32 m0, m0, 1056
    s_add_u32 s21, s21, 1024
    buffer_load_dwordx4 v29, s[8:11], s21 offen lds
    v_mov_b32 v20, 0
    v_mov_b32 v21, 0
    s_waitcnt vmcnt(41)
    v_dot2c_f32_bf16 v20, v8, v16
    v_dot2c_f32_bf16 v21, v12, v16
    v_dot2c_f32_bf16 v20, v9, v17
    v_dot2c_f32_bf16 v21, v13, v17
    v_dot2c_f32_bf16 v20, v10, v18
    v_dot2c_f32_bf16 v21, v14, v18
    v_dot2c_f32_bf16 v20, v11, v19
    v_dot2c_f32_bf16 v21, v15, v19
    s_nop 2
    v_permlane32_swap_b32 v20, v21
    v_add_f32 v20, v20, v21
    v_mov_b32 v21, v20
    s_nop 1
    v_permlane16_swap_b32 v20, v21
    v_add_f32 v20, v20, v21
    s_nop 1
    v_add_f32_dpp v20, v20, v20 row_ror:8 row_mask:0xf bank_mask:0xf
    s_nop 1
    v_add_f32_dpp v20, v20, v20 row_ror:4 row_mask:0xf bank_mask:0xf
    s_nop 1
    v_add_f32_dpp v20, v20, v20 row_ror:2 row_mask:0xf bank_mask:0xf
    s_nop 1
    v_add_f32_dpp v20, v20, v20 row_ror:1 row_mask:0xf bank_mask:0xf
    v_mul_f32 v20, 0xbfb8aa3b, v20
    v_exp_f32 v20, v20
    s_nop 0
    v_add_f32 v20, 1.0, v20
    v_rcp_f32 v20, v20
    v_and_b32 v21, 63, v0
    v_lshrrev_b32 v22, 5, v21
    v_lshlrev_b32 v22, 2, v22
    v_and_b32 v21, 31, v21
    v_cmp_ne_u32 vcc, 0, v21
    v_mov_b32 v23, 0x40000000
    s_nop 0
    v_cndmask_b32 v22, v22, v23, vcc
    s_lshl_b32 s22, s2, 5
    s_lshl_b32 s23, s18, 3
    s_add_u32 s22, s22, s23
    s_add_u32 s22, s22, 0x4200000
    buffer_store_dword v20, v22, s[4:7], s22 offen sc1
    s_waitcnt vmcnt(20)
    v_mov_b32 v30, v110
    v_mov_b32 v31, v111
    v_add_u32 v6, 65536, v106
    buffer_load_dword v27, v107, s[4:7], 0 offen
    buffer_load_dword v26, v109, s[4:7], 0 offen
    s_lshr_b32 s84, s17, 2
    s_and_b32 s85, s17, 3
    s_mov_b32 s86, s18
    s_lshl_b32 s66, s84, 2
    s_add_u32 s66, s66, s85
    s_lshl_b32 s66, s66, 2
    s_add_u32 s66, s66, s86
    s_lshl_b32 s66, s66, 11
    s_add_u32 s66, s66, 0x4400000
    s_lshl_b32 s63, s84, 10
    s_and_b32 s22, s85, 2
    s_lshl_b32 s22, s22, 7
    s_add_u32 s63, s63, s22
    s_and_b32 s22, s85, 1
    s_lshl_b32 s22, s22, 5
    s_add_u32 s63, s63, s22
    s_lshl_b32 s22, s86, 6
    s_add_u32 s63, s63, s22
    s_add_u32 s63, s63, 0x4480000
    s_and_b32 s22, s84, 1
    s_lshl_b32 s22, s22, 9
    s_lshr_b32 s21, s84, 1
    s_lshl_b32 s21, s21, 7
    s_add_u32 s21, s21, s22
    s_lshl_b32 s22, s85, 3
    s_add_u32 s21, s21, s22
    s_lshl_b32 s22, s86, 11
    s_add_u32 s75, s21, s22
    s_mul_i32 s67, s17, 24576
    s_mul_i32 s21, s18, 6144
    s_add_u32 s67, s67, s21
    s_lshl_b32 s68, s17, 6
    s_lshl_b32 s21, s18, 2
    s_add_u32 s68, s68, s21
    s_add_u32 s70, s68, 0x431f000
    s_add_u32 s68, s68, 0x4300000
    s_lshl_b32 s69, s17, 12
    s_lshl_b32 s21, s18, 10
    s_add_u32 s69, s69, s21
    s_add_u32 s69, s69, 0x2fe0000
    s_lshl_b32 s21, s18, 11
    s_add_u32 s62, s21, 0x4480000
    s_lshl_b32 s64, s17, 6
    s_add_u32 s64, s64, 0x4400000
    s_mov_b32 s72, 0x33333333
    s_mov_b32 s73, 0x33333333
    s_mov_b32 s74, 0x3e0293ee
    s_mov_b32 s61, 0
    v_and_b32 v2, 1, v0
    v_lshlrev_b32 v2, 11, v2
    s_add_u32 s47, s68, 0xfff10000
    buffer_load_dword v143, v2, s[4:7], s47 offen sc1
    s_mov_b32 s24, s34
    s_mov_b32 s25, s35
    s_mov_b32 s26, 0x2000
    s_mov_b32 s27, 0x20000
    buffer_load_ushort v140, v120, s[24:27], s75 offen
    buffer_load_ushort v141, v120, s[24:27], s75 offen offset:32
    s_waitcnt vmcnt(21)
    s_barrier
    v_add_u32 v7, 0, v31
    ds_read_b64_tr_b16 v[56:57], v7 offset:0
    ds_read_b64_tr_b16 v[58:59], v7 offset:2112
    ds_read_b64_tr_b16 v[60:61], v7 offset:8448
    ds_read_b64_tr_b16 v[62:63], v7 offset:10560
    ds_read_b64_tr_b16 v[144:145], v7 offset:512
    ds_read_b64_tr_b16 v[146:147], v7 offset:2624
    ds_read_b64_tr_b16 v[148:149], v7 offset:8960
    ds_read_b64_tr_b16 v[150:151], v7 offset:11072
    ds_read_b64_tr_b16 v[40:41], v7 offset:64
    ds_read_b64_tr_b16 v[42:43], v7 offset:2176
    ds_read_b64_tr_b16 v[44:45], v7 offset:8512
    ds_read_b64_tr_b16 v[46:47], v7 offset:10624
    ds_read_b64_tr_b16 v[168:169], v7 offset:576
    ds_read_b64_tr_b16 v[170:171], v7 offset:2688
    ds_read_b64_tr_b16 v[172:173], v7 offset:9024
    ds_read_b64_tr_b16 v[174:175], v7 offset:11136
    ds_read_b64_tr_b16 v[192:193], v7 offset:128
    ds_read_b64_tr_b16 v[194:195], v7 offset:2240
    ds_read_b64_tr_b16 v[196:197], v7 offset:8576
    ds_read_b64_tr_b16 v[198:199], v7 offset:10688
    ds_read_b64_tr_b16 v[200:201], v7 offset:640
    ds_read_b64_tr_b16 v[202:203], v7 offset:2752
    ds_read_b64_tr_b16 v[204:205], v7 offset:9088
    ds_read_b64_tr_b16 v[206:207], v7 offset:11200
    ds_read_b64_tr_b16 v[224:225], v7 offset:192
    ds_read_b64_tr_b16 v[226:227], v7 offset:2304
    ds_read_b64_tr_b16 v[228:229], v7 offset:8640
    ds_read_b64_tr_b16 v[230:231], v7 offset:10752
    ds_read_b64_tr_b16 v[232:233], v7 offset:704
    ds_read_b64_tr_b16 v[234:235], v7 offset:2816
    ds_read_b64_tr_b16 v[236:237], v7 offset:9152
    ds_read_b64_tr_b16 v[238:239], v7 offset:11264
    s_waitcnt lgkmcnt(0)
    ds_write_b128 v99, v[56:59] offset:16384
    ds_write_b128 v99, v[60:63] offset:17408
    ds_write_b128 v99, v[40:43] offset:24576
    ds_write_b128 v99, v[44:47] offset:25600
    s_barrier
    s_mov_b32 s8, s36
    s_mov_b32 s9, s37
    s_mov_b32 s10, 0x400000
    s_mov_b32 s11, 0x20000
    s_add_u32 m0, s78, 0
    s_add_u32 s21, s18, 0
    s_lshl_b32 s21, s21, 19
    s_lshl_b32 s22, s17, 8
    s_add_u32 s21, s21, s22
    buffer_load_dwordx4 v28, s[8:11], s21 offen lds
    s_add_u32 m0, m0, 1056
    s_add_u32 s21, s21, 8192
    buffer_load_dwordx4 v28, s[8:11], s21 offen lds
    s_add_u32 m0, m0, 1056
    s_add_u32 s21, s21, 8192
    buffer_load_dwordx4 v28, s[8:11], s21 offen lds
    s_add_u32 m0, m0, 1056
    s_add_u32 s21, s21, 8192
    buffer_load_dwordx4 v28, s[8:11], s21 offen lds
    s_add_u32 m0, m0, 1056
    s_add_u32 s21, s21, 8192
    buffer_load_dwordx4 v28, s[8:11], s21 offen lds
    s_add_u32 m0, m0, 1056
    s_add_u32 s21, s21, 8192
    buffer_load_dwordx4 v28, s[8:11], s21 offen lds
    s_add_u32 m0, m0, 1056
    s_add_u32 s21, s21, 8192
    buffer_load_dwordx4 v28, s[8:11], s21 offen lds
    s_add_u32 m0, m0, 1056
    s_add_u32 s21, s21, 8192
    buffer_load_dwordx4 v28, s[8:11], s21 offen lds
    s_add_u32 m0, m0, 1056
    s_add_u32 s21, s21, 8192
    buffer_load_dwordx4 v28, s[8:11], s21 offen lds
    s_add_u32 m0, m0, 1056
    s_add_u32 s21, s21, 8192
    buffer_load_dwordx4 v28, s[8:11], s21 offen lds
    s_add_u32 m0, m0, 1056
    s_add_u32 s21, s21, 8192
    buffer_load_dwordx4 v28, s[8:11], s21 offen lds
    s_add_u32 m0, m0, 1056
    s_add_u32 s21, s21, 8192
    buffer_load_dwordx4 v28, s[8:11], s21 offen lds
    s_add_u32 m0, m0, 1056
    s_add_u32 s21, s21, 8192
    buffer_load_dwordx4 v28, s[8:11], s21 offen lds
    s_add_u32 m0, m0, 1056
    s_add_u32 s21, s21, 8192
    buffer_load_dwordx4 v28, s[8:11], s21 offen lds
    s_add_u32 m0, m0, 1056
    s_add_u32 s21, s21, 8192
    buffer_load_dwordx4 v28, s[8:11], s21 offen lds
    s_add_u32 m0, m0, 1056
    s_add_u32 s21, s21, 8192
    buffer_load_dwordx4 v28, s[8:11], s21 offen lds
    s_waitcnt vmcnt(18)
    s_barrier
    v_add_u32 v7, 67584, v31
    ds_read_b64_tr_b16 v[152:153], v7 offset:0
    ds_read_b64_tr_b16 v[154:155], v7 offset:2112
    ds_read_b64_tr_b16 v[156:157], v7 offset:8448
    ds_read_b64_tr_b16 v[158:159], v7 offset:10560
    ds_read_b64_tr_b16 v[160:161], v7 offset:512
    ds_read_b64_tr_b16 v[162:163], v7 offset:2624
    ds_read_b64_tr_b16 v[164:165], v7 offset:8960
    ds_read_b64_tr_b16 v[166:167], v7 offset:11072
    ds_read_b64_tr_b16 v[176:177], v7 offset:64
    ds_read_b64_tr_b16 v[178:179], v7 offset:2176
    ds_read_b64_tr_b16 v[180:181], v7 offset:8512
    ds_read_b64_tr_b16 v[182:183], v7 offset:10624
    ds_read_b64_tr_b16 v[184:185], v7 offset:576
    ds_read_b64_tr_b16 v[186:187], v7 offset:2688
    ds_read_b64_tr_b16 v[188:189], v7 offset:9024
    ds_read_b64_tr_b16 v[190:191], v7 offset:11136
    ds_read_b64_tr_b16 v[208:209], v7 offset:128
    ds_read_b64_tr_b16 v[210:211], v7 offset:2240
    ds_read_b64_tr_b16 v[212:213], v7 offset:8576
    ds_read_b64_tr_b16 v[214:215], v7 offset:10688
    ds_read_b64_tr_b16 v[216:217], v7 offset:640
    ds_read_b64_tr_b16 v[218:219], v7 offset:2752
    ds_read_b64_tr_b16 v[220:221], v7 offset:9088
    ds_read_b64_tr_b16 v[222:223], v7 offset:11200
    ds_read_b64_tr_b16 v[240:241], v7 offset:192
    ds_read_b64_tr_b16 v[242:243], v7 offset:2304
    ds_read_b64_tr_b16 v[244:245], v7 offset:8640
    ds_read_b64_tr_b16 v[246:247], v7 offset:10752
    ds_read_b64_tr_b16 v[248:249], v7 offset:704
    ds_read_b64_tr_b16 v[250:251], v7 offset:2816
    ds_read_b64_tr_b16 v[252:253], v7 offset:9152
    ds_read_b64_tr_b16 v[254:255], v7 offset:11264
    s_waitcnt lgkmcnt(0)
    s_barrier
    s_mov_b32 s12, s56
    s_mov_b32 s13, s57
    s_mov_b32 s14, 0x100
    s_mov_b32 s15, 0x20000
    v_and_b32 v5, 1, v0
    v_lshlrev_b32 v5, 3, v5
    buffer_load_dword v3, v5, s[12:15], 0 offen sc1
    s_add_u32 m0, s78, 67584
    s_add_u32 s21, s18, 4
    s_lshl_b32 s21, s21, 19
    s_lshl_b32 s22, s17, 8
    s_add_u32 s21, s21, s22
    buffer_load_dwordx4 v28, s[8:11], s21 offen lds
    s_add_u32 m0, m0, 1056
    s_add_u32 s21, s21, 8192
    buffer_load_dwordx4 v28, s[8:11], s21 offen lds
    s_add_u32 m0, m0, 1056
    s_add_u32 s21, s21, 8192
    buffer_load_dwordx4 v28, s[8:11], s21 offen lds
    s_add_u32 m0, m0, 1056
    s_add_u32 s21, s21, 8192
    buffer_load_dwordx4 v28, s[8:11], s21 offen lds
    s_add_u32 m0, m0, 1056
    s_add_u32 s21, s21, 8192
    buffer_load_dwordx4 v28, s[8:11], s21 offen lds
    s_add_u32 m0, m0, 1056
    s_add_u32 s21, s21, 8192
    buffer_load_dwordx4 v28, s[8:11], s21 offen lds
    s_add_u32 m0, m0, 1056
    s_add_u32 s21, s21, 8192
    buffer_load_dwordx4 v28, s[8:11], s21 offen lds
    s_add_u32 m0, m0, 1056
    s_add_u32 s21, s21, 8192
    buffer_load_dwordx4 v28, s[8:11], s21 offen lds
    s_add_u32 m0, m0, 1056
    s_add_u32 s21, s21, 8192
    buffer_load_dwordx4 v28, s[8:11], s21 offen lds
    s_add_u32 m0, m0, 1056
    s_add_u32 s21, s21, 8192
    buffer_load_dwordx4 v28, s[8:11], s21 offen lds
    s_add_u32 m0, m0, 1056
    s_add_u32 s21, s21, 8192
    buffer_load_dwordx4 v28, s[8:11], s21 offen lds
    s_add_u32 m0, m0, 1056
    s_add_u32 s21, s21, 8192
    buffer_load_dwordx4 v28, s[8:11], s21 offen lds
    s_add_u32 m0, m0, 1056
    s_add_u32 s21, s21, 8192
    buffer_load_dwordx4 v28, s[8:11], s21 offen lds
    s_add_u32 m0, m0, 1056
    s_add_u32 s21, s21, 8192
    buffer_load_dwordx4 v28, s[8:11], s21 offen lds
    s_add_u32 m0, m0, 1056
    s_add_u32 s21, s21, 8192
    buffer_load_dwordx4 v28, s[8:11], s21 offen lds
    s_add_u32 m0, m0, 1056
    s_add_u32 s21, s21, 8192
    buffer_load_dwordx4 v28, s[8:11], s21 offen lds
    s_mov_b32 s12, s56
    s_mov_b32 s13, s57
    s_mov_b32 s14, 0x100
    s_mov_b32 s15, 0x20000
    s_cmp_lg_u32 s18, 0
    s_cbranch_scc1 L_sig_4
    s_and_b32 s21, s2, 3
    s_lshl_b32 s21, s21, 6
    s_add_u32 s21, s21, 60
    v_mov_b32 v20, s21
    v_mov_b32 v21, 1
    v_mov_b32 v22, 0x40000000
    v_and_b32 v23, 63, v0
    v_cmp_ne_u32 vcc, 0, v23
    s_nop 1
    v_cndmask_b32 v20, v20, v22, vcc
    buffer_atomic_add v21, v20, s[12:15], 0 offen
L_sig_4:
    s_waitcnt vmcnt(16)
    s_barrier
    s_xor_b32 s21, s18, 0
    s_mul_i32 s21, s21, 16896
    s_add_u32 s21, s21, 0
    v_add_u32 v7, s21, v30
    ds_read_b64_tr_b16 a[208:209], v7 offset:0
    ds_read_b64_tr_b16 a[210:211], v7 offset:1056
    ds_read_b64_tr_b16 a[212:213], v7 offset:512
    ds_read_b64_tr_b16 a[214:215], v7 offset:1568
    ds_read_b64_tr_b16 a[216:217], v7 offset:32
    ds_read_b64_tr_b16 a[218:219], v7 offset:1088
    ds_read_b64_tr_b16 a[220:221], v7 offset:544
    ds_read_b64_tr_b16 a[222:223], v7 offset:1600
    s_xor_b32 s21, s18, 1
    s_mul_i32 s21, s21, 16896
    s_add_u32 s21, s21, 0
    v_add_u32 v7, s21, v30
    ds_read_b64_tr_b16 a[0:1], v7 offset:0
    ds_read_b64_tr_b16 a[2:3], v7 offset:1056
    ds_read_b64_tr_b16 a[4:5], v7 offset:512
    ds_read_b64_tr_b16 a[6:7], v7 offset:1568
    ds_read_b64_tr_b16 a[8:9], v7 offset:32
    ds_read_b64_tr_b16 a[10:11], v7 offset:1088
    ds_read_b64_tr_b16 a[12:13], v7 offset:544
    ds_read_b64_tr_b16 a[14:15], v7 offset:1600
    s_xor_b32 s21, s18, 2
    s_mul_i32 s21, s21, 16896
    s_add_u32 s21, s21, 0
    v_add_u32 v7, s21, v30
    ds_read_b64_tr_b16 a[32:33], v7 offset:0
    ds_read_b64_tr_b16 a[34:35], v7 offset:1056
    ds_read_b64_tr_b16 a[36:37], v7 offset:512
    ds_read_b64_tr_b16 a[38:39], v7 offset:1568
    ds_read_b64_tr_b16 a[40:41], v7 offset:32
    ds_read_b64_tr_b16 a[42:43], v7 offset:1088
    ds_read_b64_tr_b16 a[44:45], v7 offset:544
    ds_read_b64_tr_b16 a[46:47], v7 offset:1600
    s_xor_b32 s21, s18, 3
    s_mul_i32 s21, s21, 16896
    s_add_u32 s21, s21, 0
    v_add_u32 v7, s21, v30
    ds_read_b64_tr_b16 a[64:65], v7 offset:0
    ds_read_b64_tr_b16 a[66:67], v7 offset:1056
    ds_read_b64_tr_b16 a[68:69], v7 offset:512
    ds_read_b64_tr_b16 a[70:71], v7 offset:1568
    ds_read_b64_tr_b16 a[72:73], v7 offset:32
    ds_read_b64_tr_b16 a[74:75], v7 offset:1088
    ds_read_b64_tr_b16 a[76:77], v7 offset:544
    ds_read_b64_tr_b16 a[78:79], v7 offset:1600
    s_waitcnt lgkmcnt(0)
    s_barrier
    s_mov_b32 s8, s38
    s_mov_b32 s9, s39
    s_mov_b32 s10, 0x400000
    s_mov_b32 s11, 0x20000
    s_add_u32 m0, s78, 0
    s_add_u32 s21, s18, 0
    s_lshl_b32 s21, s21, 19
    s_lshl_b32 s22, s17, 8
    s_add_u32 s21, s21, s22
    buffer_load_dwordx4 v28, s[8:11], s21 offen lds
    s_add_u32 m0, m0, 1056
    s_add_u32 s21, s21, 8192
    buffer_load_dwordx4 v28, s[8:11], s21 offen lds
    s_add_u32 m0, m0, 1056
    s_add_u32 s21, s21, 8192
    buffer_load_dwordx4 v28, s[8:11], s21 offen lds
    s_add_u32 m0, m0, 1056
    s_add_u32 s21, s21, 8192
    buffer_load_dwordx4 v28, s[8:11], s21 offen lds
    s_add_u32 m0, m0, 1056
    s_add_u32 s21, s21, 8192
    buffer_load_dwordx4 v28, s[8:11], s21 offen lds
    s_add_u32 m0, m0, 1056
    s_add_u32 s21, s21, 8192
    buffer_load_dwordx4 v28, s[8:11], s21 offen lds
    s_add_u32 m0, m0, 1056
    s_add_u32 s21, s21, 8192
    buffer_load_dwordx4 v28, s[8:11], s21 offen lds
    s_add_u32 m0, m0, 1056
    s_add_u32 s21, s21, 8192
    buffer_load_dwordx4 v28, s[8:11], s21 offen lds
    s_add_u32 m0, m0, 1056
    s_add_u32 s21, s21, 8192
    buffer_load_dwordx4 v28, s[8:11], s21 offen lds
    s_add_u32 m0, m0, 1056
    s_add_u32 s21, s21, 8192
    buffer_load_dwordx4 v28, s[8:11], s21 offen lds
    s_add_u32 m0, m0, 1056
    s_add_u32 s21, s21, 8192
    buffer_load_dwordx4 v28, s[8:11], s21 offen lds
    s_add_u32 m0, m0, 1056
    s_add_u32 s21, s21, 8192
    buffer_load_dwordx4 v28, s[8:11], s21 offen lds
    s_add_u32 m0, m0, 1056
    s_add_u32 s21, s21, 8192
    buffer_load_dwordx4 v28, s[8:11], s21 offen lds
    s_add_u32 m0, m0, 1056
    s_add_u32 s21, s21, 8192
    buffer_load_dwordx4 v28, s[8:11], s21 offen lds
    s_add_u32 m0, m0, 1056
    s_add_u32 s21, s21, 8192
    buffer_load_dwordx4 v28, s[8:11], s21 offen lds
    s_add_u32 m0, m0, 1056
    s_add_u32 s21, s21, 8192
    buffer_load_dwordx4 v28, s[8:11], s21 offen lds
    s_waitcnt vmcnt(16)
    s_barrier
    s_xor_b32 s21, s18, 0
    s_mul_i32 s21, s21, 16896
    s_add_u32 s21, s21, 67584
    v_add_u32 v7, s21, v30
    ds_read_b64_tr_b16 a[240:241], v7 offset:0
    ds_read_b64_tr_b16 a[242:243], v7 offset:1056
    ds_read_b64_tr_b16 a[244:245], v7 offset:512
    ds_read_b64_tr_b16 a[246:247], v7 offset:1568
    ds_read_b64_tr_b16 a[248:249], v7 offset:32
    ds_read_b64_tr_b16 a[250:251], v7 offset:1088
    ds_read_b64_tr_b16 a[252:253], v7 offset:544
    ds_read_b64_tr_b16 a[254:255], v7 offset:1600
    s_xor_b32 s21, s18, 1
    s_mul_i32 s21, s21, 16896
    s_add_u32 s21, s21, 67584
    v_add_u32 v7, s21, v30
    ds_read_b64_tr_b16 a[16:17], v7 offset:0
    ds_read_b64_tr_b16 a[18:19], v7 offset:1056
    ds_read_b64_tr_b16 a[20:21], v7 offset:512
    ds_read_b64_tr_b16 a[22:23], v7 offset:1568
    ds_read_b64_tr_b16 a[24:25], v7 offset:32
    ds_read_b64_tr_b16 a[26:27], v7 offset:1088
    ds_read_b64_tr_b16 a[28:29], v7 offset:544
    ds_read_b64_tr_b16 a[30:31], v7 offset:1600
    s_xor_b32 s21, s18, 2
    s_mul_i32 s21, s21, 16896
    s_add_u32 s21, s21, 67584
    v_add_u32 v7, s21, v30
    ds_read_b64_tr_b16 a[48:49], v7 offset:0
    ds_read_b64_tr_b16 a[50:51], v7 offset:1056
    ds_read_b64_tr_b16 a[52:53], v7 offset:512
    ds_read_b64_tr_b16 a[54:55], v7 offset:1568
    ds_read_b64_tr_b16 a[56:57], v7 offset:32
    ds_read_b64_tr_b16 a[58:59], v7 offset:1088
    ds_read_b64_tr_b16 a[60:61], v7 offset:544
    ds_read_b64_tr_b16 a[62:63], v7 offset:1600
    s_xor_b32 s21, s18, 3
    s_mul_i32 s21, s21, 16896
    s_add_u32 s21, s21, 67584
    v_add_u32 v7, s21, v30
    ds_read_b64_tr_b16 a[80:81], v7 offset:0
    ds_read_b64_tr_b16 a[82:83], v7 offset:1056
    ds_read_b64_tr_b16 a[84:85], v7 offset:512
    ds_read_b64_tr_b16 a[86:87], v7 offset:1568
    ds_read_b64_tr_b16 a[88:89], v7 offset:32
    ds_read_b64_tr_b16 a[90:91], v7 offset:1088
    ds_read_b64_tr_b16 a[92:93], v7 offset:544
    ds_read_b64_tr_b16 a[94:95], v7 offset:1600
    s_waitcnt lgkmcnt(0)
    s_barrier
    s_add_u32 m0, s78, 67584
    s_add_u32 s21, s18, 4
    s_lshl_b32 s21, s21, 19
    s_lshl_b32 s22, s17, 8
    s_add_u32 s21, s21, s22
    buffer_load_dwordx4 v28, s[8:11], s21 offen lds
    s_add_u32 m0, m0, 1056
    s_add_u32 s21, s21, 8192
    buffer_load_dwordx4 v28, s[8:11], s21 offen lds
    s_add_u32 m0, m0, 1056
    s_add_u32 s21, s21, 8192
    buffer_load_dwordx4 v28, s[8:11], s21 offen lds
    s_add_u32 m0, m0, 1056
    s_add_u32 s21, s21, 8192
    buffer_load_dwordx4 v28, s[8:11], s21 offen lds
    s_add_u32 m0, m0, 1056
    s_add_u32 s21, s21, 8192
    buffer_load_dwordx4 v28, s[8:11], s21 offen lds
    s_add_u32 m0, m0, 1056
    s_add_u32 s21, s21, 8192
    buffer_load_dwordx4 v28, s[8:11], s21 offen lds
    s_add_u32 m0, m0, 1056
    s_add_u32 s21, s21, 8192
    buffer_load_dwordx4 v28, s[8:11], s21 offen lds
    s_add_u32 m0, m0, 1056
    s_add_u32 s21, s21, 8192
    buffer_load_dwordx4 v28, s[8:11], s21 offen lds
    s_add_u32 m0, m0, 1056
    s_add_u32 s21, s21, 8192
    buffer_load_dwordx4 v28, s[8:11], s21 offen lds
    s_add_u32 m0, m0, 1056
    s_add_u32 s21, s21, 8192
    buffer_load_dwordx4 v28, s[8:11], s21 offen lds
    s_add_u32 m0, m0, 1056
    s_add_u32 s21, s21, 8192
    buffer_load_dwordx4 v28, s[8:11], s21 offen lds
    s_add_u32 m0, m0, 1056
    s_add_u32 s21, s21, 8192
    buffer_load_dwordx4 v28, s[8:11], s21 offen lds
    s_add_u32 m0, m0, 1056
    s_add_u32 s21, s21, 8192
    buffer_load_dwordx4 v28, s[8:11], s21 offen lds
    s_add_u32 m0, m0, 1056
    s_add_u32 s21, s21, 8192
    buffer_load_dwordx4 v28, s[8:11], s21 offen lds
    s_add_u32 m0, m0, 1056
    s_add_u32 s21, s21, 8192
    buffer_load_dwordx4 v28, s[8:11], s21 offen lds
    s_add_u32 m0, m0, 1056
    s_add_u32 s21, s21, 8192
    buffer_load_dwordx4 v28, s[8:11], s21 offen lds
    s_waitcnt vmcnt(16)
    s_barrier
    s_xor_b32 s21, s18, 0
    s_mul_i32 s21, s21, 16896
    s_add_u32 s21, s21, 0
    v_add_u32 v7, s21, v30
    ds_read_b64_tr_b16 v[32:33], v7 offset:0
    ds_read_b64_tr_b16 v[34:35], v7 offset:1056
    ds_read_b64_tr_b16 v[36:37], v7 offset:512
    ds_read_b64_tr_b16 v[38:39], v7 offset:1568
    ds_read_b64_tr_b16 a[96:97], v7 offset:32
    ds_read_b64_tr_b16 a[98:99], v7 offset:1088
    ds_read_b64_tr_b16 a[100:101], v7 offset:544
    ds_read_b64_tr_b16 a[102:103], v7 offset:1600
    s_xor_b32 s21, s18, 1
    s_mul_i32 s21, s21, 16896
    s_add_u32 s21, s21, 0
    v_add_u32 v7, s21, v30
    ds_read_b64_tr_b16 a[120:121], v7 offset:0
    ds_read_b64_tr_b16 a[122:123], v7 offset:1056
    ds_read_b64_tr_b16 a[124:125], v7 offset:512
    ds_read_b64_tr_b16 a[126:127], v7 offset:1568
    ds_read_b64_tr_b16 v[64:65], v7 offset:32
    ds_read_b64_tr_b16 v[66:67], v7 offset:1088
    ds_read_b64_tr_b16 v[68:69], v7 offset:544
    ds_read_b64_tr_b16 v[70:71], v7 offset:1600
    s_xor_b32 s21, s18, 2
    s_mul_i32 s21, s21, 16896
    s_add_u32 s21, s21, 0
    v_add_u32 v7, s21, v30
    ds_read_b64_tr_b16 a[136:137], v7 offset:0
    ds_read_b64_tr_b16 a[138:139], v7 offset:1056
    ds_read_b64_tr_b16 a[140:141], v7 offset:512
    ds_read_b64_tr_b16 a[142:143], v7 offset:1568
    ds_read_b64_tr_b16 v[80:81], v7 offset:32
    ds_read_b64_tr_b16 v[82:83], v7 offset:1088
    ds_read_b64_tr_b16 v[84:85], v7 offset:544
    ds_read_b64_tr_b16 v[86:87], v7 offset:1600
    s_xor_b32 s21, s18, 3
    s_mul_i32 s21, s21, 16896
    s_add_u32 s21, s21, 0
    v_add_u32 v7, s21, v30
    ds_read_b64_tr_b16 a[152:153], v7 offset:0
    ds_read_b64_tr_b16 a[154:155], v7 offset:1056
    ds_read_b64_tr_b16 a[156:157], v7 offset:512
    ds_read_b64_tr_b16 a[158:159], v7 offset:1568
    ds_read_b64_tr_b16 v[124:125], v7 offset:32
    ds_read_b64_tr_b16 v[126:127], v7 offset:1088
    ds_read_b64_tr_b16 v[128:129], v7 offset:544
    ds_read_b64_tr_b16 v[130:131], v7 offset:1600
    s_waitcnt lgkmcnt(0)
    s_barrier
    s_mov_b32 s8, s40
    s_mov_b32 s9, s41
    s_mov_b32 s10, 0x400000
    s_mov_b32 s11, 0x20000
    s_add_u32 m0, s78, 0
    s_add_u32 s21, s18, 0
    s_lshl_b32 s21, s21, 19
    s_lshl_b32 s22, s17, 8
    s_add_u32 s21, s21, s22
    buffer_load_dwordx4 v28, s[8:11], s21 offen lds
    s_add_u32 m0, m0, 1056
    s_add_u32 s21, s21, 8192
    buffer_load_dwordx4 v28, s[8:11], s21 offen lds
    s_add_u32 m0, m0, 1056
    s_add_u32 s21, s21, 8192
    buffer_load_dwordx4 v28, s[8:11], s21 offen lds
    s_add_u32 m0, m0, 1056
    s_add_u32 s21, s21, 8192
    buffer_load_dwordx4 v28, s[8:11], s21 offen lds
    s_add_u32 m0, m0, 1056
    s_add_u32 s21, s21, 8192
    buffer_load_dwordx4 v28, s[8:11], s21 offen lds
    s_add_u32 m0, m0, 1056
    s_add_u32 s21, s21, 8192
    buffer_load_dwordx4 v28, s[8:11], s21 offen lds
    s_add_u32 m0, m0, 1056
    s_add_u32 s21, s21, 8192
    buffer_load_dwordx4 v28, s[8:11], s21 offen lds
    s_add_u32 m0, m0, 1056
    s_add_u32 s21, s21, 8192
    buffer_load_dwordx4 v28, s[8:11], s21 offen lds
    s_add_u32 m0, m0, 1056
    s_add_u32 s21, s21, 8192
    buffer_load_dwordx4 v28, s[8:11], s21 offen lds
    s_add_u32 m0, m0, 1056
    s_add_u32 s21, s21, 8192
    buffer_load_dwordx4 v28, s[8:11], s21 offen lds
    s_add_u32 m0, m0, 1056
    s_add_u32 s21, s21, 8192
    buffer_load_dwordx4 v28, s[8:11], s21 offen lds
    s_add_u32 m0, m0, 1056
    s_add_u32 s21, s21, 8192
    buffer_load_dwordx4 v28, s[8:11], s21 offen lds
    s_add_u32 m0, m0, 1056
    s_add_u32 s21, s21, 8192
    buffer_load_dwordx4 v28, s[8:11], s21 offen lds
    s_add_u32 m0, m0, 1056
    s_add_u32 s21, s21, 8192
    buffer_load_dwordx4 v28, s[8:11], s21 offen lds
    s_add_u32 m0, m0, 1056
    s_add_u32 s21, s21, 8192
    buffer_load_dwordx4 v28, s[8:11], s21 offen lds
    s_add_u32 m0, m0, 1056
    s_add_u32 s21, s21, 8192
    buffer_load_dwordx4 v28, s[8:11], s21 offen lds
    s_waitcnt vmcnt(16)
    s_barrier
    s_xor_b32 s21, s18, 0
    s_mul_i32 s21, s21, 16896
    s_add_u32 s21, s21, 67584
    v_add_u32 v7, s21, v30
    ds_read_b64_tr_b16 a[104:105], v7 offset:0
    ds_read_b64_tr_b16 a[106:107], v7 offset:1056
    ds_read_b64_tr_b16 a[108:109], v7 offset:512
    ds_read_b64_tr_b16 a[110:111], v7 offset:1568
    ds_read_b64_tr_b16 a[112:113], v7 offset:32
    ds_read_b64_tr_b16 a[114:115], v7 offset:1088
    ds_read_b64_tr_b16 a[116:117], v7 offset:544
    ds_read_b64_tr_b16 a[118:119], v7 offset:1600
    s_xor_b32 s21, s18, 1
    s_mul_i32 s21, s21, 16896
    s_add_u32 s21, s21, 67584
    v_add_u32 v7, s21, v30
    ds_read_b64_tr_b16 a[128:129], v7 offset:0
    ds_read_b64_tr_b16 a[130:131], v7 offset:1056
    ds_read_b64_tr_b16 a[132:133], v7 offset:512
    ds_read_b64_tr_b16 a[134:135], v7 offset:1568
    ds_read_b64_tr_b16 v[72:73], v7 offset:32
    ds_read_b64_tr_b16 v[74:75], v7 offset:1088
    ds_read_b64_tr_b16 v[76:77], v7 offset:544
    ds_read_b64_tr_b16 v[78:79], v7 offset:1600
    s_xor_b32 s21, s18, 2
    s_mul_i32 s21, s21, 16896
    s_add_u32 s21, s21, 67584
    v_add_u32 v7, s21, v30
    ds_read_b64_tr_b16 a[144:145], v7 offset:0
    ds_read_b64_tr_b16 a[146:147], v7 offset:1056
    ds_read_b64_tr_b16 a[148:149], v7 offset:512
    ds_read_b64_tr_b16 a[150:151], v7 offset:1568
    ds_read_b64_tr_b16 v[88:89], v7 offset:32
    ds_read_b64_tr_b16 v[90:91], v7 offset:1088
    ds_read_b64_tr_b16 v[92:93], v7 offset:544
    ds_read_b64_tr_b16 v[94:95], v7 offset:1600
    s_xor_b32 s21, s18, 3
    s_mul_i32 s21, s21, 16896
    s_add_u32 s21, s21, 67584
    v_add_u32 v7, s21, v30
    ds_read_b64_tr_b16 v[8:9], v7 offset:0
    ds_read_b64_tr_b16 v[10:11], v7 offset:1056
    ds_read_b64_tr_b16 v[12:13], v7 offset:512
    ds_read_b64_tr_b16 v[14:15], v7 offset:1568
    ds_read_b64_tr_b16 v[132:133], v7 offset:32
    ds_read_b64_tr_b16 v[134:135], v7 offset:1088
    ds_read_b64_tr_b16 v[136:137], v7 offset:544
    ds_read_b64_tr_b16 v[138:139], v7 offset:1600
    s_waitcnt lgkmcnt(0)
    s_barrier
    buffer_load_dword v4, v2, s[4:7], s47 offen sc1
    s_add_u32 m0, s78, 67584
    s_add_u32 s21, s18, 4
    s_lshl_b32 s21, s21, 19
    s_lshl_b32 s22, s17, 8
    s_add_u32 s21, s21, s22
    buffer_load_dwordx4 v28, s[8:11], s21 offen lds
    s_add_u32 m0, m0, 1056
    s_add_u32 s21, s21, 8192
    buffer_load_dwordx4 v28, s[8:11], s21 offen lds
    s_add_u32 m0, m0, 1056
    s_add_u32 s21, s21, 8192
    buffer_load_dwordx4 v28, s[8:11], s21 offen lds
    s_add_u32 m0, m0, 1056
    s_add_u32 s21, s21, 8192
    buffer_load_dwordx4 v28, s[8:11], s21 offen lds
    s_add_u32 m0, m0, 1056
    s_add_u32 s21, s21, 8192
    buffer_load_dwordx4 v28, s[8:11], s21 offen lds
    s_add_u32 m0, m0, 1056
    s_add_u32 s21, s21, 8192
    buffer_load_dwordx4 v28, s[8:11], s21 offen lds
    s_add_u32 m0, m0, 1056
    s_add_u32 s21, s21, 8192
    buffer_load_dwordx4 v28, s[8:11], s21 offen lds
    s_add_u32 m0, m0, 1056
    s_add_u32 s21, s21, 8192
    buffer_load_dwordx4 v28, s[8:11], s21 offen lds
    s_add_u32 m0, m0, 1056
    s_add_u32 s21, s21, 8192
    buffer_load_dwordx4 v28, s[8:11], s21 offen lds
    s_add_u32 m0, m0, 1056
    s_add_u32 s21, s21, 8192
    buffer_load_dwordx4 v28, s[8:11], s21 offen lds
    s_add_u32 m0, m0, 1056
    s_add_u32 s21, s21, 8192
    buffer_load_dwordx4 v28, s[8:11], s21 offen lds
    s_add_u32 m0, m0, 1056
    s_add_u32 s21, s21, 8192
    buffer_load_dwordx4 v28, s[8:11], s21 offen lds
    s_add_u32 m0, m0, 1056
    s_add_u32 s21, s21, 8192
    buffer_load_dwordx4 v28, s[8:11], s21 offen lds
    s_add_u32 m0, m0, 1056
    s_add_u32 s21, s21, 8192
    buffer_load_dwordx4 v28, s[8:11], s21 offen lds
    s_add_u32 m0, m0, 1056
    s_add_u32 s21, s21, 8192
    buffer_load_dwordx4 v28, s[8:11], s21 offen lds
    s_add_u32 m0, m0, 1056
    s_add_u32 s21, s21, 8192
    buffer_load_dwordx4 v28, s[8:11], s21 offen lds
    s_waitcnt vmcnt(16)
    v_lshl_or_b32 v140, v141, 16, v140
    s_mov_b32 s76, 0
    s_mov_b32 s77, 1
    v_readlane_b32 s21, v3, 0
    v_readlane_b32 s22, v3, 1
    v_cmp_eq_u32 vcc, v143, v4
    s_bcnt1_i32_b32 s21, s21
    s_add_u32 s85, s21, s22
    s_cbranch_vccnz L_R_notyet
    s_cmp_lt_u32 s85, 32
    s_cbranch_scc1 L_R_notyet
    s_mov_b32 s76, 1
    buffer_store_dword v140, v98, s[4:7], s63 offen sc1
    buffer_load_dwordx4 v[48:51], v96, s[4:7], s67 offen offset:0 sc1
    buffer_load_dwordx4 v[40:43], v96, s[4:7], s67 offen offset:2048 sc1
    buffer_load_dwordx4 v[52:55], v96, s[4:7], s67 offen offset:1024 sc1
    buffer_load_dwordx4 v[44:47], v96, s[4:7], s67 offen offset:3072 sc1
L_R_notyet:
    s_getpc_b64 s[12:13]
L_pc_5:
    s_add_u32 s12, s12, L_R_ready-L_pc_5
    s_addc_u32 s13, s13, 0
    s_mov_b32 s14, L_R_slow-L_R_ready
    s_mov_b32 s15, 0x20000
    v_lshlrev_b32 v1, 4, v0
    buffer_load_dwordx4 v[24:27], v1, s[12:15], 0 offen
    v_add_u32 v1, 4096, v1
    buffer_load_dwordx4 v[24:27], v1, s[12:15], 0 offen
    v_add_u32 v1, 4096, v1
    buffer_load_dwordx4 v[24:27], v1, s[12:15], 0 offen
    v_add_u32 v1, 4096, v1
    buffer_load_dwordx4 v[24:27], v1, s[12:15], 0 offen
    v_add_u32 v1, 4096, v1
    buffer_load_dwordx4 v[24:27], v1, s[12:15], 0 offen
    v_add_u32 v1, 4096, v1
    s_barrier
    s_xor_b32 s21, s18, 0
    s_mul_i32 s21, s21, 16896
    s_add_u32 s21, s21, 0
    v_add_u32 v7, s21, v30
    ds_read_b64_tr_b16 a[160:161], v7 offset:0
    ds_read_b64_tr_b16 a[162:163], v7 offset:1056
    ds_read_b64_tr_b16 a[164:165], v7 offset:512
    ds_read_b64_tr_b16 a[166:167], v7 offset:1568
    ds_read_b64_tr_b16 a[168:169], v7 offset:32
    ds_read_b64_tr_b16 a[170:171], v7 offset:1088
    ds_read_b64_tr_b16 a[172:173], v7 offset:544
    ds_read_b64_tr_b16 a[174:175], v7 offset:1600
    s_xor_b32 s21, s18, 1
    s_mul_i32 s21, s21, 16896
    s_add_u32 s21, s21, 0
    v_add_u32 v7, s21, v30
    ds_read_b64_tr_b16 a[192:193], v7 offset:0
    ds_read_b64_tr_b16 a[194:195], v7 offset:1056
    ds_read_b64_tr_b16 a[196:197], v7 offset:512
    ds_read_b64_tr_b16 a[198:199], v7 offset:1568
    ds_read_b64_tr_b16 a[200:201], v7 offset:32
    ds_read_b64_tr_b16 a[202:203], v7 offset:1088
    ds_read_b64_tr_b16 a[204:205], v7 offset:544
    ds_read_b64_tr_b16 a[206:207], v7 offset:1600
    s_xor_b32 s21, s18, 2
    s_mul_i32 s21, s21, 16896
    s_add_u32 s21, s21, 0
    v_add_u32 v7, s21, v30
    ds_read_b64_tr_b16 a[224:225], v7 offset:0
    ds_read_b64_tr_b16 a[226:227], v7 offset:1056
    ds_read_b64_tr_b16 a[228:229], v7 offset:512
    ds_read_b64_tr_b16 a[230:231], v7 offset:1568
    ds_read_b64_tr_b16 a[232:233], v7 offset:32
    ds_read_b64_tr_b16 a[234:235], v7 offset:1088
    ds_read_b64_tr_b16 a[236:237], v7 offset:544
    ds_read_b64_tr_b16 a[238:239], v7 offset:1600
    s_xor_b32 s21, s18, 3
    s_mul_i32 s21, s21, 16896
    s_add_u32 s21, s21, 0
    v_add_u32 v7, s21, v30
    ds_read_b64_tr_b16 v[56:57], v7 offset:0
    ds_read_b64_tr_b16 v[58:59], v7 offset:1056
    ds_read_b64_tr_b16 v[60:61], v7 offset:512
    ds_read_b64_tr_b16 v[62:63], v7 offset:1568
    ds_read_b64_tr_b16 v[16:17], v7 offset:32
    ds_read_b64_tr_b16 v[18:19], v7 offset:1088
    ds_read_b64_tr_b16 v[20:21], v7 offset:544
    ds_read_b64_tr_b16 v[22:23], v7 offset:1600
    s_waitcnt lgkmcnt(0)
    s_barrier
    buffer_load_dword v4, v2, s[4:7], s47 offen sc1
    ds_write_b128 v106, a[248:251] offset:0
    ds_write_b128 v106, a[252:255] offset:1024
    ds_write_b128 v106, a[240:243] offset:8192
    ds_write_b128 v106, a[244:247] offset:9216
    ds_write_b128 v106, a[216:219] offset:16384
    ds_write_b128 v106, a[220:223] offset:17408
    ds_write_b128 v106, a[208:211] offset:24576
    ds_write_b128 v106, a[212:215] offset:25600
    ds_write_b128 v106, v[32:35] offset:32768
    ds_write_b128 v106, v[36:39] offset:33792
    ds_write_b128 v106, v[64:67] offset:40960
    ds_write_b128 v106, v[68:71] offset:41984
    ds_write_b128 v106, v[80:83] offset:49152
    ds_write_b128 v106, v[84:87] offset:50176
    ds_write_b128 v106, v[124:127] offset:57344
    ds_write_b128 v106, v[128:131] offset:58368
    s_waitcnt vmcnt(0)
    s_cmp_eq_u32 s76, 1
    s_cbranch_scc1 L_R_notyet2
    v_readlane_b32 s21, v3, 0
    v_readlane_b32 s22, v3, 1
    v_cmp_eq_u32 vcc, v143, v4
    s_bcnt1_i32_b32 s21, s21
    s_add_u32 s85, s21, s22
    s_cbranch_vccnz L_R_notyet2
    s_cmp_lt_u32 s85, 32
    s_cbranch_scc1 L_R_notyet2
    s_mov_b32 s76, 1
    buffer_store_dword v140, v98, s[4:7], s63 offen sc1
    buffer_load_dwordx4 v[48:51], v96, s[4:7], s67 offen offset:0 sc1
    buffer_load_dwordx4 v[40:43], v96, s[4:7], s67 offen offset:2048 sc1
    buffer_load_dwordx4 v[52:55], v96, s[4:7], s67 offen offset:1024 sc1
    buffer_load_dwordx4 v[44:47], v96, s[4:7], s67 offen offset:3072 sc1
L_R_notyet2:
    v_mov_b64 v[24:25], -1
    v_mov_b64 v[26:27], -1
    s_cmp_eq_u32 s76, 1
    s_cselect_b32 s21, s66, 0x40000000
    s_cselect_b32 s22, s63, 0x40000000
    s_add_u32 s23, s21, 0x40000
    s_lshl_b32 s84, s17, 10
    s_add_u32 s84, s84, 0x4480000
    s_cmp_ge_u32 s21, 0x40000000
    s_cselect_b32 s84, s21, s84
    buffer_load_dwordx4 v[24:27], v96, s[4:7], s21 offen offset:0
    buffer_load_dwordx4 v[24:27], v96, s[4:7], s21 offen offset:1024
    buffer_load_dwordx4 v[24:27], v96, s[4:7], s23 offen offset:0
    buffer_load_dwordx4 v[24:27], v96, s[4:7], s23 offen offset:1024
    buffer_load_dwordx4 v[24:27], v96, s[4:7], s84 offen
    s_barrier
    s_xor_b32 s21, s18, 0
    s_mul_i32 s21, s21, 16896
    s_add_u32 s21, s21, 67584
    v_add_u32 v7, s21, v30
    ds_read_b64_tr_b16 a[176:177], v7 offset:0
    ds_read_b64_tr_b16 a[178:179], v7 offset:1056
    ds_read_b64_tr_b16 a[180:181], v7 offset:512
    ds_read_b64_tr_b16 a[182:183], v7 offset:1568
    ds_read_b64_tr_b16 a[184:185], v7 offset:32
    ds_read_b64_tr_b16 a[186:187], v7 offset:1088
    ds_read_b64_tr_b16 a[188:189], v7 offset:544
    ds_read_b64_tr_b16 a[190:191], v7 offset:1600
    s_xor_b32 s21, s18, 1
    s_mul_i32 s21, s21, 16896
    s_add_u32 s21, s21, 67584
    v_add_u32 v7, s21, v30
    ds_read_b64_tr_b16 a[208:209], v7 offset:0
    ds_read_b64_tr_b16 a[210:211], v7 offset:1056
    ds_read_b64_tr_b16 a[212:213], v7 offset:512
    ds_read_b64_tr_b16 a[214:215], v7 offset:1568
    ds_read_b64_tr_b16 a[216:217], v7 offset:32
    ds_read_b64_tr_b16 a[218:219], v7 offset:1088
    ds_read_b64_tr_b16 a[220:221], v7 offset:544
    ds_read_b64_tr_b16 a[222:223], v7 offset:1600
    s_xor_b32 s21, s18, 2
    s_mul_i32 s21, s21, 16896
    s_add_u32 s21, s21, 67584
    v_add_u32 v7, s21, v30
    ds_read_b64_tr_b16 a[240:241], v7 offset:0
    ds_read_b64_tr_b16 a[242:243], v7 offset:1056
    ds_read_b64_tr_b16 a[244:245], v7 offset:512
    ds_read_b64_tr_b16 a[246:247], v7 offset:1568
    ds_read_b64_tr_b16 a[248:249], v7 offset:32
    ds_read_b64_tr_b16 a[250:251], v7 offset:1088
    ds_read_b64_tr_b16 a[252:253], v7 offset:544
    ds_read_b64_tr_b16 a[254:255], v7 offset:1600
    s_xor_b32 s21, s18, 3
    s_mul_i32 s21, s21, 16896
    s_add_u32 s21, s21, 67584
    v_add_u32 v7, s21, v30
    ds_read_b64_tr_b16 v[32:33], v7 offset:0
    ds_read_b64_tr_b16 v[34:35], v7 offset:1056
    ds_read_b64_tr_b16 v[36:37], v7 offset:512
    ds_read_b64_tr_b16 v[38:39], v7 offset:1568
    ds_read_b64_tr_b16 v[64:65], v7 offset:32
    ds_read_b64_tr_b16 v[66:67], v7 offset:1088
    ds_read_b64_tr_b16 v[68:69], v7 offset:544
    ds_read_b64_tr_b16 v[70:71], v7 offset:1600
    s_waitcnt lgkmcnt(0)
    s_barrier
    ds_write_b128 v6, v[72:75] offset:0
    ds_write_b128 v6, v[76:79] offset:1024
    ds_write_b128 v6, v[88:91] offset:8192
    ds_write_b128 v6, v[92:95] offset:9216
    ds_write_b128 v6, v[8:11] offset:16384
    ds_write_b128 v6, v[12:15] offset:17408
    ds_write_b128 v6, v[132:135] offset:24576
    ds_write_b128 v6, v[136:139] offset:25600
    ds_write_b128 v6, v[56:59] offset:32768
    ds_write_b128 v6, v[60:63] offset:33792
    ds_write_b128 v6, v[16:19] offset:40960
    ds_write_b128 v6, v[20:23] offset:41984
    ds_write_b128 v6, v[32:35] offset:49152
    ds_write_b128 v6, v[36:39] offset:50176
    ds_write_b128 v6, v[64:67] offset:57344
    ds_write_b128 v6, v[68:71] offset:58368
    s_waitcnt vmcnt(0) lgkmcnt(0)
    v_mov_b32 v19, v6
    v_mov_b32 v1, v96
    v_mov_b32 v2, v97
    v_mov_b32 v3, v98
    v_mov_b32 v4, v99
    v_mov_b32 v5, v100
    v_mov_b32 v6, v101
    v_mov_b32 v7, v102
    v_mov_b32 v8, v103
    v_mov_b32 v9, v104
    v_mov_b32 v10, v105
    v_mov_b32 v11, v106
    v_mov_b32 v18, v108
    v_mov_b32 v26, v107
    v_mov_b32 v27, v121
    v_mov_b32 v20, v112
    v_mov_b32 v21, v113
    v_mov_b32 v22, v114
    v_mov_b32 v23, v115
    v_mov_b32 v24, v116
    v_mov_b32 v25, v117
    v_mov_b32 v28, v118
    v_mov_b32 v31, v118
    v_mov_b32 v128, v119
    v_mov_b32 v131, v119
    v_mov_b32 v29, 0
    v_mov_b32 v30, 0
    v_mov_b32 v129, 0
    v_mov_b32 v130, 0
    s_cmp_eq_u32 s76, 1
    s_cbranch_scc1 L_R_ready
    s_cmp_ge_u32 s85, 32
    s_cbranch_scc1 L_R_mode
    s_mov_b32 s12, s56
    s_mov_b32 s13, s57
    s_mov_b32 s14, 0x100
    s_mov_b32 s15, 0x20000
    v_and_b32 v136, 3, v0
    v_lshlrev_b32 v136, 6, v136
    v_add_u32 v136, 60, v136
    s_mul_i32 s21, s16, 24
    s_add_u32 s21, s21, 40
    s_cmp_eq_u32 s16, 0
    s_cselect_b32 s21, 0, s21
    v_and_b32 v138, 1, v0
    v_lshl_add_u32 v138, v138, 3, s21
    s_mov_b32 s23, s60
L_wi_6:
    buffer_load_dword v137, v136, s[12:15], 0 offen sc1
    buffer_load_dword v139, v138, s[12:15], 0 offen sc1
    s_waitcnt vmcnt(0)
    v_readlane_b32 s22, v139, 1
    v_readlane_b32 s84, v137, 0
    v_readlane_b32 s85, v137, 1
    v_readlane_b32 s86, v137, 2
    v_readlane_b32 s87, v137, 3
    v_readlane_b32 s21, v139, 0
    s_nop 1
    s_bcnt1_i32_b32 s21, s21
    s_add_u32 s21, s21, s22
    s_add_u32 s84, s84, s85
    s_add_u32 s86, s86, s87
    s_add_u32 s84, s84, s86
    s_cmp_ge_u32 s84, 256
    s_cbranch_scc1 L_wiok_7
    s_sleep 16
    s_sub_u32 s23, s23, 1
    s_cbranch_scc0 L_wi_6
L_wiok_7:
    s_cmp_ge_u32 s21, 32
    s_cselect_b32 s77, 1, 0
L_R_mode:
    v_and_b32 v136, 1, v0
    v_lshlrev_b32 v136, 11, v136
    s_mov_b32 s23, s60
L_f2_8:
    buffer_load_dword v137, v136, s[4:7], s47 offen sc1
    s_waitcnt vmcnt(0)
    v_cmp_eq_u32 vcc, v143, v137
    s_cbranch_vccz L_f2_8k
    s_sub_u32 s23, s23, 1
    s_cbranch_scc0 L_f2_8
    s_mov_b32 s60, 0x400
L_f2_8k:
    buffer_store_dword v140, v3, s[4:7], s63 offen sc1
    buffer_load_dwordx4 v[48:51], v1, s[4:7], s67 offen offset:0 sc1
    buffer_load_dwordx4 v[40:43], v1, s[4:7], s67 offen offset:2048 sc1
    buffer_load_dwordx4 v[52:55], v1, s[4:7], s67 offen offset:1024 sc1
    buffer_load_dwordx4 v[44:47], v1, s[4:7], s67 offen offset:3072 sc1
    s_cmp_eq_u32 s77, 1
    s_cselect_b32 s21, s66, 0x40000000
    s_lshl_b32 s22, s17, 10
    s_add_u32 s22, s22, 0x4480000
    s_cmp_eq_u32 s77, 0
    s_cselect_b32 s22, s21, s22
    s_add_u32 s84, s21, 0x40000
    buffer_load_dwordx4 v[136:139], v1, s[4:7], s21 offen offset:0
    buffer_load_dwordx4 v[136:139], v1, s[4:7], s21 offen offset:1024
    buffer_load_dwordx4 v[136:139], v1, s[4:7], s84 offen offset:0
    buffer_load_dwordx4 v[136:139], v1, s[4:7], s84 offen offset:1024
    buffer_load_dwordx4 v[136:139], v1, s[4:7], s22 offen
L_R_ready:
    s_waitcnt vmcnt(0)
    s_add_u32 s68, s68, 2048
    v_mov_b32 v0, 1
    v_mov_b64 v[96:97], -1
    v_mov_b64 v[98:99], -1
    v_mov_b64 v[100:101], -1
    v_mov_b64 v[102:103], -1
    s_lshl_b32 s10, s18, 5
    s_add_u32 s10, s10, s17
    s_lshl_b32 s10, s10, 2
    s_add_u32 s10, s10, 0x436c000
    s_lshr_b32 s11, s17, 3
    s_lshl_b32 s11, s11, 7
    s_add_u32 s11, s11, 0x436c000
    s_mov_b32 s26, 0x3f803f80
    s_mov_b32 s27, 0x3f803f80
    s_mov_b32 s8, 0x3f003f00
    s_mov_b32 s9, 0x3f003f00
    ds_write_b64 v10, v[96:97]
    s_waitcnt lgkmcnt(0)
    s_cmp_eq_u32 s77, 0
    s_cbranch_scc1 L_R_slow
    s_cmp_eq_u32 s18, 1
    s_cbranch_scc1 L_R_w1
    s_cmp_eq_u32 s18, 2
    s_cbranch_scc1 L_R_w2
    s_cmp_eq_u32 s18, 3
    s_cbranch_scc1 L_R_w3
    ds_read_b128 v[120:123], v11 offset:24576
    ds_read_b128 v[124:127], v11 offset:25600
    ds_read_b128 v[112:115], v11 offset:16384
    ds_read_b128 v[116:119], v11 offset:17408
    ds_read_b128 v[56:59], v11 offset:8192
    ds_read_b128 v[60:63], v11 offset:9216
    ds_read_b128 v[64:67], v11 offset:0
    ds_read_b128 v[68:71], v11 offset:1024
    ds_read_b128 v[132:135], v11 offset:32768
    ds_read_b128 v[136:139], v11 offset:33792
    v_mov_b64 v[72:73], 0
    v_mov_b64 v[74:75], 0
    v_mov_b64 v[76:77], 0
    v_mov_b64 v[78:79], 0
    v_mov_b64 v[80:81], 0
    v_mov_b64 v[82:83], 0
    v_mov_b64 v[84:85], 0
    v_mov_b64 v[86:87], 0
    v_mov_b64 v[88:89], 0
    v_mov_b64 v[90:91], 0
    v_mov_b64 v[92:93], 0
    v_mov_b64 v[94:95], 0
    s_xor_b32 s66, s66, 0x40000
    s_waitcnt lgkmcnt(0)
L_Rloop_f:
    v_cmp_eq_u32 vcc, 0, v0
    s_cbranch_vccnz L_kvspin_f
L_kvback_f:
    v_mov_b64 v[32:33], v[40:41]
    v_mov_b64 v[34:35], v[42:43]
    v_mov_b64 v[36:37], v[44:45]
    v_mov_b64 v[38:39], v[46:47]
    s_xor_b32 s66, s66, 0x40000
    s_cmp_lt_u32 s61, 63
    s_cselect_b32 s75, 786432, 0
    s_add_u32 s67, s67, s75
    s_cmp_lt_u32 s61, 62
    s_cselect_b32 s75, 2048, 0
    s_add_u32 s68, s68, s75
    s_cmp_ge_u32 s61, 2
    s_cselect_b32 s76, s70, 0x40000000
    s_cmp_ge_u32 s61, 1
    s_cselect_b32 s75, s69, 0x40000000
    s_add_u32 s70, s70, 2048
    s_cmp_eq_u32 s61, 61
    s_cselect_b32 s78, 0xd00000, 0
    s_add_u32 s69, s69, s78
    s_add_u32 s69, s69, 131072
    s_lshr_b32 s78, s61, 1
    s_and_b32 s78, s78, 1
    s_sub_u32 s79, s78, 1
    buffer_load_dwordx4 v[96:99], v1, s[4:7], s62 offen offset:0 sc1
    s_add_u32 s65, s64, 32768
    s_and_b32 s24, s61, 1
    s_sub_u32 s25, s24, 1
    s_nop 3
    buffer_load_dwordx4 v[100:103], v1, s[4:7], s62 offen offset:1024 sc1
    s_nop 15
    s_nop 11
    buffer_load_dwordx4 v[96:99], v1, s[4:7], s62 offen offset:0 sc1
    s_nop 7
    buffer_load_dwordx4 v[100:103], v1, s[4:7], s62 offen offset:1024 sc1
    s_mov_b32 s23, s60
L_pw_Bf:
    s_waitcnt vmcnt(3)
    v_max3_u32 v140, v96, v97, v98
    v_max_u32 v140, v140, v99
    v_cmp_eq_u32 vcc, -1, v140
    ds_write_b128 v4, v[96:99]
    v_smfmac_f32_16x16x64_bf16 v[72:75], v[96:99], v[120:127], v18
    s_cbranch_vccnz L_poll_Bf
L_pok_Bf:
    v_smfmac_f32_16x16x64_bf16 v[76:79], v[96:99], v[112:119], v18
    s_waitcnt vmcnt(2)
    v_max3_u32 v140, v100, v101, v102
    v_smfmac_f32_16x16x64_bf16 v[80:83], v[96:99], v[132:139], v18
    v_max_u32 v140, v140, v103
    v_smfmac_f32_16x16x64_bf16 v[84:87], v[96:99], a[96:103], v18
    v_cmp_eq_u32 vcc, -1, v140
    v_smfmac_f32_16x16x64_bf16 v[88:91], v[96:99], a[160:167], v18
    s_cbranch_vccnz L_pol1_Bf
L_pk1_Bf:
    ds_write_b128 v4, v[100:103] offset:1024
    s_cmp_eq_u32 s61, 63
    v_smfmac_f32_16x16x64_bf16 v[80:83], v[100:103], a[104:111], v18
    s_cbranch_scc1 L_Rlast_f
    v_smfmac_f32_16x16x64_bf16 v[72:75], v[100:103], v[56:63], v18
    v_smfmac_f32_16x16x64_bf16 v[76:79], v[100:103], v[64:71], v18
    v_smfmac_f32_16x16x64_bf16 v[84:87], v[100:103], a[112:119], v18
    s_waitcnt lgkmcnt(0)
    s_barrier
    ds_read_b128 v[104:107], v5 offset:0
    ds_read_b128 v[108:111], v5 offset:1024
    ds_read_b128 v[112:115], v6 offset:0
    v_smfmac_f32_16x16x64_bf16 v[92:95], v[96:99], a[168:175], v18
    ds_read_b128 v[116:119], v6 offset:1024
    v_smfmac_f32_16x16x64_bf16 v[88:91], v[100:103], a[176:183], v18
    ds_read_b128 v[120:123], v7 offset:0
    v_smfmac_f32_16x16x64_bf16 v[92:95], v[100:103], a[184:191], v18
    ds_read_b128 v[124:127], v7 offset:1024
    s_waitcnt lgkmcnt(5)
    v_smfmac_f32_16x16x64_bf16 v[72:75], v[104:107], a[0:7], v18
    ds_read_b128 v[56:59], v11 offset:40960
    s_waitcnt lgkmcnt(5)
    v_smfmac_f32_16x16x64_bf16 v[72:75], v[108:111], a[16:23], v18
    ds_read_b128 v[60:63], v11 offset:41984
    s_waitcnt lgkmcnt(5)
    v_smfmac_f32_16x16x64_bf16 v[72:75], v[112:115], a[32:39], v18
    ds_read_b128 v[64:67], v19 offset:0
    s_waitcnt lgkmcnt(5)
    v_smfmac_f32_16x16x64_bf16 v[72:75], v[116:119], a[48:55], v18
    ds_read_b128 v[68:71], v19 offset:1024
    s_waitcnt lgkmcnt(5)
    v_smfmac_f32_16x16x64_bf16 v[72:75], v[120:123], a[64:71], v18
    ds_read_b128 v[132:135], v11 offset:49152
    s_waitcnt lgkmcnt(5)
    v_smfmac_f32_16x16x64_bf16 v[72:75], v[124:127], a[80:87], v18
    ds_read_b128 v[136:139], v11 offset:50176
    s_waitcnt vmcnt(0)
    buffer_store_dwordx4 v[12:15], v1, s[4:7], s75 offen sc1
    v_smfmac_f32_16x16x64_bf16 v[76:79], v[104:107], a[8:15], v18
    v_smfmac_f32_16x16x64_bf16 v[76:79], v[108:111], a[24:31], v18
    v_smfmac_f32_16x16x64_bf16 v[76:79], v[112:115], a[40:47], v18
    v_smfmac_f32_16x16x64_bf16 v[76:79], v[116:119], a[56:63], v18
    ds_read_b128 v[96:99], v19 offset:8192
    buffer_load_dwordx4 v[40:43], v1, s[4:7], s67 offen offset:2048 sc1
    v_add_f32 v72, v72, v74
    v_smfmac_f32_16x16x64_bf16 v[76:79], v[120:123], a[72:79], v18
    ds_read_b128 v[100:103], v19 offset:9216
    v_add_f32 v73, v73, v75
    v_smfmac_f32_16x16x64_bf16 v[76:79], v[124:127], a[88:95], v18
    v_cvt_pk_bf16_f32 v74, v72, v73
    v_smfmac_f32_16x16x64_bf16 v[80:83], v[104:107], a[120:127], v18
    s_waitcnt lgkmcnt(6)
    v_smfmac_f32_16x16x64_bf16 v[84:87], v[104:107], v[56:63], v18
    ds_read_b128 v[56:59], v11 offset:57344
    buffer_load_dwordx4 v[44:47], v1, s[4:7], s67 offen offset:3072 sc1
    v_smfmac_f32_16x16x64_bf16 v[80:83], v[108:111], a[128:135], v18
    ds_read_b128 v[60:63], v11 offset:58368
    s_waitcnt lgkmcnt(6)
    v_smfmac_f32_16x16x64_bf16 v[84:87], v[108:111], v[64:71], v18
    ds_read_b128 v[64:67], v19 offset:16384
    v_add_f32 v76, v76, v78
    v_smfmac_f32_16x16x64_bf16 v[80:83], v[112:115], a[136:143], v18
    ds_read_b128 v[68:71], v19 offset:17408
    v_add_f32 v77, v77, v79
    s_waitcnt lgkmcnt(6)
    v_smfmac_f32_16x16x64_bf16 v[84:87], v[112:115], v[132:139], v18
    ds_read_b128 v[132:135], v19 offset:24576
    buffer_store_dword v8, v26, s[4:7], s76 offen sc1
    buffer_load_dword v0, v29, s[4:7], s68 offen sc1
    v_cvt_pk_bf16_f32 v75, v76, v77
    v_smfmac_f32_16x16x64_bf16 v[80:83], v[116:119], a[144:151], v18
    ds_read_b128 v[136:139], v19 offset:25600
    v_mfma_f32_16x16x16_bf16 v[76:79], v[74:75], v[28:29], 0
    v_mfma_f32_16x16x16_bf16 v[140:143], v[74:75], v[30:31], 0
    s_waitcnt lgkmcnt(6)
    v_smfmac_f32_16x16x64_bf16 v[84:87], v[116:119], v[96:103], v18
    ds_read_b128 v[96:99], v19 offset:32768
    v_smfmac_f32_16x16x64_bf16 v[80:83], v[120:123], a[152:159], v18
    ds_read_b128 v[100:103], v19 offset:33792
    s_waitcnt lgkmcnt(4)
    v_smfmac_f32_16x16x64_bf16 v[80:83], v[124:127], v[64:71], v18
    ds_read_b128 v[64:67], v19 offset:49152
    v_cvt_pk_bf16_f32 v72, v76, v77
    v_smfmac_f32_16x16x64_bf16 v[84:87], v[120:123], v[56:63], v18
    ds_read_b128 v[68:71], v19 offset:50176
    v_cvt_pk_bf16_f32 v73, v78, v79
    v_cvt_pk_bf16_f32 v74, v140, v141
    s_waitcnt lgkmcnt(4)
    v_smfmac_f32_16x16x64_bf16 v[84:87], v[124:127], v[132:139], v18
    ds_read_b128 v[56:59], v19 offset:40960
    v_cvt_pk_bf16_f32 v75, v142, v143
    ds_read_b128 v[60:63], v19 offset:41984
    v_add_f32 v80, v80, v82
    v_mfma_f32_16x16x32_bf16 v[76:79], v[48:51], v[72:75], 0
    v_add_f32 v81, v81, v83
    v_cvt_pk_bf16_f32 v82, v80, v81
    v_mfma_f32_16x16x32_bf16 v[140:143], v[52:55], v[72:75], 0
    v_add_f32 v84, v84, v86
    v_add_f32 v85, v85, v87
    v_cvt_pk_bf16_f32 v83, v84, v85
    s_nop 1
    v_mfma_f32_16x16x16_bf16 v[84:87], v[82:83], v[128:129], 0
    v_mfma_f32_16x16x16_bf16 v[132:135], v[82:83], v[130:131], 0
    v_cndmask_b32 v80, v140, v76, s[72:73]
    v_cndmask_b32 v81, v141, v77, s[72:73]
    v_cndmask_b32 v82, v142, v78, s[72:73]
    v_cndmask_b32 v83, v143, v79, s[72:73]
    v_cvt_pk_bf16_f32 v12, v84, v85
    v_cvt_pk_bf16_f32 v13, v86, v87
    s_nop 0
    v_cvt_pk_bf16_f32 v14, v132, v133
    v_cvt_pk_bf16_f32 v15, v134, v135
    s_nop 1
    v_mfma_f32_16x16x32_bf16 v[136:139], v[12:15], v[72:75], 0
    v_smfmac_f32_16x16x64_bf16 v[88:91], v[104:107], a[192:199], v18
    ds_write_b128 v4, v[80:83] offset:8192
    s_nop 2
    v_cndmask_b32 v136, v137, v136, s[72:73]
    v_smfmac_f32_16x16x64_bf16 v[92:95], v[104:107], a[200:207], v18
    ds_write_b32 v9, v136
    v_smfmac_f32_16x16x64_bf16 v[88:91], v[108:111], a[208:215], v18
    buffer_load_dwordx4 v[48:51], v1, s[4:7], s67 offen offset:0 sc1
    v_smfmac_f32_16x16x64_bf16 v[92:95], v[108:111], a[216:223], v18
    ds_read_b128 v[104:107], v19 offset:57344
    s_waitcnt lgkmcnt(7)
    v_smfmac_f32_16x16x64_bf16 v[88:91], v[120:123], v[96:103], v18
    ds_read_b128 v[108:111], v19 offset:58368
    s_waitcnt lgkmcnt(4)
    v_smfmac_f32_16x16x64_bf16 v[92:95], v[120:123], v[56:63], v18
    s_waitcnt lgkmcnt(2)
    s_barrier
    ds_read_b128 v[136:139], v5 offset:8192
    v_smfmac_f32_16x16x64_bf16 v[88:91], v[124:127], v[64:71], v18
    ds_read_b128 v[140:143], v6 offset:8192
    ds_read_b128 v[76:79], v7 offset:8192
    v_smfmac_f32_16x16x64_bf16 v[88:91], v[112:115], a[224:231], v18
    ds_read_b128 v[132:135], v8 offset:1024
    v_mov_b64 v[96:97], s[26:27]
    v_smfmac_f32_16x16x64_bf16 v[92:95], v[112:115], a[232:239], v18
    buffer_load_dwordx4 v[52:55], v1, s[4:7], s67 offen offset:1024 sc1
    v_mov_b64 v[98:99], s[26:27]
    v_smfmac_f32_16x16x64_bf16 v[88:91], v[116:119], a[240:247], v18
    v_mov_b64 v[100:101], s[8:9]
    s_waitcnt lgkmcnt(4)
    v_smfmac_f32_16x16x64_bf16 v[92:95], v[124:127], v[104:111], v18
    v_smfmac_f32_16x16x64_bf16 v[92:95], v[116:119], a[248:255], v18
    s_waitcnt lgkmcnt(3)
    v_add_f32 v80, v80, v136
    v_add_f32 v81, v81, v137
    v_add_f32 v82, v82, v138
    v_add_f32 v83, v83, v139
    s_waitcnt lgkmcnt(1)
    v_pk_add_f32 v[140:141], v[140:141], v[76:77]
    v_pk_add_f32 v[142:143], v[142:143], v[78:79]
    s_waitcnt lgkmcnt(0)
    v_pk_add_f32 v[132:133], v[132:133], v[134:135]
    v_pk_add_f32 v[80:81], v[80:81], v[140:141]
    v_pk_add_f32 v[82:83], v[82:83], v[142:143]
    v_add_f32 v132, v132, v133
    v_max3_f32 v134, v80, v81, v82
    v_max3_f32 v134, v134, v83, v132
    v_pk_add_f32 v[88:89], v[88:89], v[90:91]
    v_pk_add_f32 v[92:93], v[92:93], v[94:95]
    v_max_f32_dpp v135, v134, v134 quad_perm:[2,3,0,1] row_mask:0xf bank_mask:0xf
    v_max_f32_dpp v134, v134, v134 quad_perm:[2,3,0,1] row_mask:0xf bank_mask:0xf
    v_cvt_pk_bf16_f32 v90, v88, v89
    v_cvt_pk_bf16_f32 v91, v92, v93
    v_permlane16_swap_b32 v134, v135
    v_max_f32 v133, v134, v135
    v_max_f32 v134, v134, v135
    v_mfma_f32_16x16x16_bf16 v[92:95], v[24:25], v[90:91], 0
    ds_read_b128 v[56:59], v4 offset:16384
    v_permlane32_swap_b32 v134, v133
    v_max_f32 v134, v134, v133
    v_mul_f32 v134, s74, v134
    v_fma_f32 v80, v80, s74, -v134
    v_fma_f32 v81, v81, s74, -v134
    v_fma_f32 v82, v82, s74, -v134
    v_fma_f32 v83, v83, s74, -v134
    v_fma_f32 v132, v132, s74, -v134
    v_exp_f32 v80, v80
    v_exp_f32 v81, v81
    v_exp_f32 v82, v82
    v_exp_f32 v83, v83
    v_exp_f32 v132, v132
    v_cvt_pk_bf16_f32 v140, v80, v81
    v_cvt_pk_bf16_f32 v141, v82, v83
    v_cndmask_b32 v72, 0, v140, s[72:73]
    v_cndmask_b32 v73, 0, v141, s[72:73]
    v_cndmask_b32 v74, v140, 0, s[72:73]
    v_cndmask_b32 v75, v141, 0, s[72:73]
    v_mov_b32_dpp v133, v132 quad_perm:[2,3,0,1] row_mask:0xf bank_mask:0xf
    v_cvt_pk_bf16_f32 v16, v92, v93
    v_mfma_f32_16x16x32_bf16 v[140:143], v[96:99], v[72:75], 0
    ds_read_b128 v[60:63], v4 offset:17408
    v_cvt_pk_bf16_f32 v136, v132, v133
    v_cvt_pk_bf16_f32 v137, v133, v132
    v_mfma_f32_16x16x32_bf16 v[84:87], v[36:39], v[72:75], 0
    ds_read_b128 v[64:67], v4 offset:24576
    v_cndmask_b32 v138, 0, v136, s[72:73]
    v_cndmask_b32 v139, v137, 0, s[72:73]
    v_mfma_f32_16x16x32_bf16 v[76:79], v[32:35], v[72:75], 0
    ds_read_b128 v[68:71], v4 offset:25600
    v_cvt_pk_bf16_f32 v17, v94, v95
    v_mfma_f32_16x16x16_bf16 v[140:143], v[100:101], v[138:139], v[140:143]
    v_mov_b64 v[112:113], 0
    v_mfma_f32_16x16x16_bf16 v[76:79], v[16:17], v[138:139], v[76:79]
    v_mov_b64 v[114:115], 0
    v_mov_b64 v[116:117], 0
    v_mov_b64 v[118:119], 0
    v_mov_b64 v[120:121], 0
    v_mov_b64 v[122:123], 0
    v_add_f32_dpp v141, v140, v140 quad_perm:[2,3,0,1] row_mask:0xf bank_mask:0xf
    v_rcp_f32 v141, v141
    v_add_f32_dpp v76, v84, v76 quad_perm:[2,3,0,1] row_mask:0xf bank_mask:0xf
    v_add_f32_dpp v77, v85, v77 quad_perm:[2,3,0,1] row_mask:0xf bank_mask:0xf
    v_add_f32_dpp v78, v86, v78 quad_perm:[2,3,0,1] row_mask:0xf bank_mask:0xf
    v_add_f32_dpp v79, v87, v79 quad_perm:[2,3,0,1] row_mask:0xf bank_mask:0xf
    v_pk_mul_f32 v[76:77], v[76:77], v[140:141] op_sel:[0,1] op_sel_hi:[1,1]
    v_pk_mul_f32 v[78:79], v[78:79], v[140:141] op_sel:[0,1] op_sel_hi:[1,1]
    v_cvt_pk_bf16_f32 v132, v76, v77
    v_cvt_pk_bf16_f32 v133, v78, v79
    v_and_or_b32 v132, v132, -2, s24
    ds_write_b64 v10, v[132:133]
    s_nop 2
    v_mov_b64 v[124:125], 0
    v_mov_b64 v[126:127], 0
    s_nop 3
    ds_read_b128 v[80:83], v27 offset:0
    ds_read_b128 v[84:87], v27 offset:512
    ds_read_b128 v[88:91], v27 offset:2048
    ds_read_b128 v[92:95], v27 offset:2560
    v_mfma_f32_16x16x16_bf16 v[96:99], v[28:29], v[28:29], v[96:99]
    v_mfma_f32_16x16x16_bf16 v[96:99], v[28:29], v[28:29], v[96:99]
L_wo_f:
    s_waitcnt lgkmcnt(3)
    v_smfmac_f32_16x16x64_bf16 v[112:115], v[80:83], v[56:63], v18
    v_bitop3_b32 v134, v80, v82, s25 bitop3:0x42
    v_smfmac_f32_16x16x64_bf16 v[116:119], v[80:83], v[64:71], v18
    s_waitcnt lgkmcnt(2)
    v_bitop3_b32 v135, v84, v86, s25 bitop3:0x42
    v_smfmac_f32_16x16x64_bf16 v[112:115], v[84:87], v[144:151], v18
    s_waitcnt lgkmcnt(1)
    v_bitop3_b32 v136, v88, v90, s25 bitop3:0x42
    v_smfmac_f32_16x16x64_bf16 v[116:119], v[84:87], v[168:175], v18
    s_waitcnt lgkmcnt(0)
    v_bitop3_b32 v137, v92, v94, s25 bitop3:0x42
    v_smfmac_f32_16x16x64_bf16 v[112:115], v[88:91], v[152:159], v18
    v_bitop3_b32 v134, v134, v135, v136 bitop3:0x80
    v_smfmac_f32_16x16x64_bf16 v[116:119], v[88:91], v[176:183], v18
    v_bitop3_b32 v134, v134, v137, 1 bitop3:0x80
    v_smfmac_f32_16x16x64_bf16 v[112:115], v[92:95], v[160:167], v18
    v_cmp_eq_u32 vcc, 0, v134
    v_smfmac_f32_16x16x64_bf16 v[116:119], v[92:95], v[184:191], v18
    v_smfmac_f32_16x16x64_bf16 v[120:123], v[80:83], v[192:199], v18
    s_cbranch_vccnz L_ofix_f
    v_smfmac_f32_16x16x64_bf16 v[124:127], v[80:83], v[224:231], v18
    s_nop 1
    v_mov_b32 v1, v1
    v_cvt_pk_bf16_f32 v72, v112, v113
    v_cvt_pk_bf16_f32 v73, v114, v115
    v_smfmac_f32_16x16x64_bf16 v[120:123], v[84:87], v[200:207], v18
    v_cvt_pk_bf16_f32 v74, v116, v117
    v_cvt_pk_bf16_f32 v75, v118, v119
    v_smfmac_f32_16x16x64_bf16 v[124:127], v[84:87], v[232:239], v18
    v_and_or_b32 v72, v72, -2, s78
    buffer_store_dwordx4 v[72:75], v2, s[4:7], s64 offen
    v_smfmac_f32_16x16x64_bf16 v[120:123], v[88:91], v[208:215], v18
    v_smfmac_f32_16x16x64_bf16 v[124:127], v[88:91], v[240:247], v18
    v_smfmac_f32_16x16x64_bf16 v[120:123], v[92:95], v[216:223], v18
    v_smfmac_f32_16x16x64_bf16 v[124:127], v[92:95], v[248:255], v18
    s_nop 3
    v_cvt_pk_bf16_f32 v76, v120, v121
    v_cvt_pk_bf16_f32 v77, v122, v123
    v_and_or_b32 v76, v76, -2, s78
    s_nop 0
    v_cvt_pk_bf16_f32 v78, v124, v125
    v_cvt_pk_bf16_f32 v79, v126, v127
    buffer_store_dwordx4 v[76:79], v2, s[4:7], s65 offen
    s_mov_b64 vcc, s[72:73]
    v_cndmask_b32_dpp v12, v16, v12, vcc quad_perm:[0,0,0,2] row_mask:0xf bank_mask:0xf
    v_cndmask_b32_dpp v13, v17, v13, vcc quad_perm:[0,0,0,2] row_mask:0xf bank_mask:0xf
    v_cndmask_b32_dpp v14, v16, v14, vcc quad_perm:[0,0,1,3] row_mask:0xf bank_mask:0xf
    v_cndmask_b32_dpp v15, v17, v15, vcc quad_perm:[0,0,1,3] row_mask:0xf bank_mask:0xf
    s_add_u32 s61, s61, 1
    s_xor_b32 s64, s64, 0x40000
    s_and_b32 s75, s61, 3
    s_lshl_b32 s75, s75, 13
    s_andn2_b32 s63, s63, 0x6000
    s_andn2_b32 s62, s62, 0x6000
    s_or_b32 s62, s62, s75
    s_xor_b32 s71, s75, 0x4000
    s_or_b32 s71, s71, s63
    s_or_b32 s63, s63, s75
    ds_read_b128 v[120:123], v11 offset:24576
    v_mov_b64 v[72:73], 0
    ds_read_b128 v[124:127], v11 offset:25600
    v_mov_b64 v[74:75], 0
    ds_read_b128 v[112:115], v11 offset:16384
    v_mov_b64 v[76:77], 0
    ds_read_b128 v[116:119], v11 offset:17408
    v_mov_b64 v[78:79], 0
    ds_read_b128 v[56:59], v11 offset:8192
    v_mov_b64 v[80:81], 0
    ds_read_b128 v[60:63], v11 offset:9216
    v_mov_b64 v[82:83], 0
    ds_read_b128 v[64:67], v11 offset:0
    v_mov_b64 v[84:85], 0
    ds_read_b128 v[68:71], v11 offset:1024
    v_mov_b64 v[86:87], 0
    ds_read_b128 v[132:135], v11 offset:32768
    v_mov_b64 v[88:89], 0
    buffer_load_dwordx4 v[104:107], v1, s[4:7], s66 offen sc1
    buffer_load_dwordx4 v[108:111], v1, s[4:7], s66 offen offset:1024 sc1
    ds_read_b128 v[136:139], v11 offset:33792
    v_mov_b64 v[90:91], 0
    v_mov_b64 v[92:93], 0
    v_mov_b64 v[94:95], 0
    v_mov_b32 v96, -1
    s_waitcnt lgkmcnt(0)
    v_mov_b64 v[140:141], 0
    v_mov_b64 v[142:143], 0
    v_mfma_f32_16x16x16_bf16 v[36:39], v[28:29], v[28:29], v[36:39]
    v_mfma_f32_16x16x16_bf16 v[36:39], v[28:29], v[28:29], v[36:39]
    v_mfma_f32_16x16x16_bf16 v[36:39], v[28:29], v[28:29], v[36:39]
    v_mfma_f32_16x16x16_bf16 v[36:39], v[28:29], v[28:29], v[36:39]
    v_mfma_f32_16x16x16_bf16 v[36:39], v[28:29], v[28:29], v[36:39]
    buffer_load_dwordx4 v[104:107], v1, s[4:7], s66 offen sc1
    buffer_load_dwordx4 v[108:111], v1, s[4:7], s66 offen offset:1024 sc1
    s_mov_b32 s23, s60
    s_branch L_pw_Af
L_poll_Af:
    s_sub_u32 s23, s23, 1
    s_cbranch_scc1 L_pto_Af
    buffer_load_dwordx4 v[104:107], v1, s[4:7], s66 offen sc1
    buffer_load_dwordx4 v[108:111], v1, s[4:7], s66 offen offset:1024 sc1
    s_nop 1
    v_mov_b32 v1, v1
    v_mov_b64 v[140:141], 0
    v_mov_b64 v[142:143], 0
L_pw_Af:
    s_waitcnt vmcnt(2)
    v_bitop3_b32 v32, v104, v108, s79 bitop3:0x42
    v_and_b32 v32, 1, v32
    v_cmp_eq_u32 vcc, 0, v32
    v_smfmac_f32_16x16x64_bf16 v[140:143], v[20:23], v[104:111], v18 abid:1
    s_cbranch_vccnz L_poll_Af
L_pok_Af:
    s_nop 1
    v_mov_b32 v1, v1
    s_nop 1
    v_mov_b32 v1, v1
    s_nop 0
    v_add_f32_dpp v140, v140, v140 row_ror:8 row_mask:0xf bank_mask:0x3
    v_add_f32_dpp v141, v141, v141 row_ror:8 row_mask:0xf bank_mask:0x3
    v_add_f32_dpp v140, v142, v142 row_ror:8 row_mask:0xf bank_mask:0xc
    v_add_f32_dpp v141, v143, v143 row_ror:8 row_mask:0xf bank_mask:0xc
    s_nop 0
    v_add_f32_dpp v140, v140, v140 row_ror:12 row_mask:0xf bank_mask:0xf
    v_add_f32_dpp v141, v141, v141 row_ror:12 row_mask:0xf bank_mask:0xf
    v_cvt_pk_bf16_f32 v142, v140, v141
    buffer_store_dword v142, v3, s[4:7], s63 offen
    buffer_store_dword v96, v3, s[4:7], s71 offen
    s_branch L_Rloop_f
L_kvspin_f:
    s_mov_b32 s23, s60
L_sf_9:
    buffer_load_dword v0, v29, s[4:7], s68 offen sc1
    s_waitcnt vmcnt(0)
    v_cmp_ne_u32 vcc, 0, v0
    s_cbranch_vccnz L_sfok_10
    s_sleep 2
    s_sub_u32 s23, s23, 1
    s_cbranch_scc0 L_sf_9
    s_mov_b32 s60, 0x400
L_sfok_10:
    s_branch L_kvback_f
L_pto_Af:
    s_mov_b32 s60, 0x400
    s_waitcnt vmcnt(0)
    s_nop 7
    v_mov_b64 v[140:141], 0
    v_mov_b64 v[142:143], 0
    s_nop 1
    v_smfmac_f32_16x16x64_bf16 v[140:143], v[20:23], v[104:111], v18 abid:1
    s_nop 7
    s_branch L_pok_Af
L_poll_Bf:
    s_sub_u32 s23, s23, 1
    s_cbranch_scc1 L_pto_Bf
    buffer_load_dwordx4 v[96:99], v1, s[4:7], s62 offen offset:0 sc1
    buffer_load_dwordx4 v[100:103], v1, s[4:7], s62 offen offset:1024 sc1
    s_nop 2
    v_mov_b64 v[72:73], 0
    v_mov_b64 v[74:75], 0
    s_branch L_pw_Bf
L_pto_Bf:
    s_mov_b32 s60, 0x400
    s_branch L_pok_Bf
L_pol1_Bf:
    s_waitcnt vmcnt(0)
    v_max3_u32 v140, v100, v101, v102
    v_max_u32 v140, v140, v103
    v_cmp_eq_u32 vcc, -1, v140
    s_cbranch_vccz L_pk1_Bf
    s_sub_u32 s23, s23, 1
    s_cbranch_scc1 L_pt1_Bf
    buffer_load_dwordx4 v[100:103], v1, s[4:7], s62 offen offset:1024 sc1
    s_branch L_pol1_Bf
L_pt1_Bf:
    s_mov_b32 s60, 0x400
    s_branch L_pk1_Bf
L_ofix_f:
    s_mov_b32 s23, s60
L_ofix2_f:
    ds_read_b128 v[80:83], v27 offset:0
    ds_read_b128 v[84:87], v27 offset:512
    ds_read_b128 v[88:91], v27 offset:2048
    ds_read_b128 v[92:95], v27 offset:2560
    s_waitcnt lgkmcnt(0)
    v_bitop3_b32 v134, v80, v82, s25 bitop3:0x42
    v_bitop3_b32 v135, v84, v86, s25 bitop3:0x42
    v_bitop3_b32 v136, v88, v90, s25 bitop3:0x42
    v_bitop3_b32 v137, v92, v94, s25 bitop3:0x42
    v_bitop3_b32 v134, v134, v135, v136 bitop3:0x80
    v_bitop3_b32 v134, v134, v137, 1 bitop3:0x80
    v_cmp_eq_u32 vcc, 0, v134
    s_cbranch_vccz L_ofix3_f
    s_sub_u32 s23, s23, 1
    s_cbranch_scc0 L_ofix2_f
    s_endpgm
L_ofix3_f:
    v_mov_b64 v[112:113], 0
    v_mov_b64 v[114:115], 0
    v_mov_b64 v[116:117], 0
    v_mov_b64 v[118:119], 0
    v_mov_b64 v[120:121], 0
    v_mov_b64 v[122:123], 0
    v_mov_b64 v[124:125], 0
    v_mov_b64 v[126:127], 0
    s_branch L_wo_f
L_Rlast_f:
    ds_read_b128 v[56:59], v11 offset:40960
    ds_read_b128 v[60:63], v11 offset:41984
    v_smfmac_f32_16x16x64_bf16 v[84:87], v[100:103], a[112:119], v18
    ds_read_b128 v[64:67], v19 offset:0
    ds_read_b128 v[68:71], v19 offset:1024
    v_smfmac_f32_16x16x64_bf16 v[92:95], v[96:99], a[168:175], v18
    ds_read_b128 v[132:135], v11 offset:49152
    ds_read_b128 v[136:139], v11 offset:50176
    v_smfmac_f32_16x16x64_bf16 v[88:91], v[100:103], a[176:183], v18
    v_smfmac_f32_16x16x64_bf16 v[92:95], v[100:103], a[184:191], v18
    s_waitcnt lgkmcnt(6)
    s_barrier
    ds_read_b128 v[104:107], v5 offset:0
    ds_read_b128 v[108:111], v5 offset:1024
    ds_read_b128 v[112:115], v6 offset:0
    ds_read_b128 v[116:119], v6 offset:1024
    ds_read_b128 v[120:123], v7 offset:0
    ds_read_b128 v[124:127], v7 offset:1024
    s_waitcnt vmcnt(0)
    buffer_store_dwordx4 v[12:15], v1, s[4:7], s75 offen sc1
    buffer_store_dword v8, v26, s[4:7], s76 offen sc1
    ds_read_b128 v[96:99], v19 offset:8192
    ds_read_b128 v[100:103], v19 offset:9216
    s_waitcnt lgkmcnt(7)
    v_smfmac_f32_16x16x64_bf16 v[80:83], v[104:107], a[120:127], v18
    v_smfmac_f32_16x16x64_bf16 v[84:87], v[104:107], v[56:63], v18
    ds_read_b128 v[56:59], v11 offset:57344
    ds_read_b128 v[60:63], v11 offset:58368
    s_waitcnt lgkmcnt(8)
    v_smfmac_f32_16x16x64_bf16 v[80:83], v[108:111], a[128:135], v18
    v_smfmac_f32_16x16x64_bf16 v[84:87], v[108:111], v[64:71], v18
    ds_read_b128 v[64:67], v19 offset:16384
    ds_read_b128 v[68:71], v19 offset:17408
    s_waitcnt lgkmcnt(9)
    v_smfmac_f32_16x16x64_bf16 v[80:83], v[112:115], a[136:143], v18
    v_smfmac_f32_16x16x64_bf16 v[84:87], v[112:115], v[132:139], v18
    ds_read_b128 v[132:135], v19 offset:24576
    ds_read_b128 v[136:139], v19 offset:25600
    s_waitcnt lgkmcnt(10)
    v_smfmac_f32_16x16x64_bf16 v[80:83], v[116:119], a[144:151], v18
    s_waitcnt lgkmcnt(6)
    v_smfmac_f32_16x16x64_bf16 v[84:87], v[116:119], v[96:103], v18
    ds_read_b128 v[96:99], v19 offset:32768
    ds_read_b128 v[100:103], v19 offset:33792
    v_smfmac_f32_16x16x64_bf16 v[80:83], v[120:123], a[152:159], v18
    s_waitcnt lgkmcnt(6)
    v_smfmac_f32_16x16x64_bf16 v[84:87], v[120:123], v[56:63], v18
    ds_read_b128 v[56:59], v19 offset:40960
    ds_read_b128 v[60:63], v19 offset:41984
    v_smfmac_f32_16x16x64_bf16 v[88:91], v[104:107], a[192:199], v18
    s_waitcnt lgkmcnt(6)
    v_smfmac_f32_16x16x64_bf16 v[80:83], v[124:127], v[64:71], v18
    ds_read_b128 v[64:67], v19 offset:49152
    ds_read_b128 v[68:71], v19 offset:50176
    v_smfmac_f32_16x16x64_bf16 v[92:95], v[104:107], a[200:207], v18
    s_waitcnt lgkmcnt(6)
    v_smfmac_f32_16x16x64_bf16 v[84:87], v[124:127], v[132:139], v18
    ds_read_b128 v[132:135], v19 offset:57344
    ds_read_b128 v[136:139], v19 offset:58368
    v_smfmac_f32_16x16x64_bf16 v[88:91], v[108:111], a[208:215], v18
    s_waitcnt lgkmcnt(6)
    v_smfmac_f32_16x16x64_bf16 v[88:91], v[120:123], v[96:103], v18
    v_smfmac_f32_16x16x64_bf16 v[92:95], v[108:111], a[216:223], v18
    s_waitcnt lgkmcnt(4)
    v_smfmac_f32_16x16x64_bf16 v[92:95], v[120:123], v[56:63], v18
    v_smfmac_f32_16x16x64_bf16 v[88:91], v[112:115], a[224:231], v18
    s_waitcnt lgkmcnt(2)
    v_smfmac_f32_16x16x64_bf16 v[88:91], v[124:127], v[64:71], v18
    v_smfmac_f32_16x16x64_bf16 v[92:95], v[112:115], a[232:239], v18
    s_waitcnt lgkmcnt(0)
    v_smfmac_f32_16x16x64_bf16 v[92:95], v[124:127], v[132:139], v18
    v_smfmac_f32_16x16x64_bf16 v[88:91], v[116:119], a[240:247], v18
    v_smfmac_f32_16x16x64_bf16 v[92:95], v[116:119], a[248:255], v18
    v_add_f32 v80, v80, v82
    v_add_f32 v81, v81, v83
    v_add_f32 v84, v84, v86
    v_add_f32 v85, v85, v87
    v_cvt_pk_bf16_f32 v82, v80, v81
    v_cvt_pk_bf16_f32 v83, v84, v85
    s_nop 0
    v_add_f32 v88, v88, v90
    v_add_f32 v89, v89, v91
    v_add_f32 v92, v92, v94
    v_add_f32 v93, v93, v95
    v_cvt_pk_bf16_f32 v90, v88, v89
    v_cvt_pk_bf16_f32 v91, v92, v93
    v_mfma_f32_16x16x16_bf16 v[84:87], v[82:83], v[128:129], 0
    v_mfma_f32_16x16x16_bf16 v[132:135], v[82:83], v[130:131], 0
    v_mfma_f32_16x16x16_bf16 v[92:95], v[24:25], v[90:91], 0
    s_nop 5
    v_cvt_pk_bf16_f32 v12, v84, v85
    v_cvt_pk_bf16_f32 v13, v86, v87
    v_cvt_pk_bf16_f32 v14, v132, v133
    v_cvt_pk_bf16_f32 v15, v134, v135
    v_cvt_pk_bf16_f32 v16, v92, v93
    v_cvt_pk_bf16_f32 v17, v94, v95
L_Rtail_f:
    s_mov_b64 vcc, s[72:73]
    v_cndmask_b32_dpp v12, v16, v12, vcc quad_perm:[0,0,0,2] row_mask:0xf bank_mask:0xf
    v_cndmask_b32_dpp v13, v17, v13, vcc quad_perm:[0,0,0,2] row_mask:0xf bank_mask:0xf
    v_cndmask_b32_dpp v14, v16, v14, vcc quad_perm:[0,0,1,3] row_mask:0xf bank_mask:0xf
    v_cndmask_b32_dpp v15, v17, v15, vcc quad_perm:[0,0,1,3] row_mask:0xf bank_mask:0xf
    buffer_store_dwordx4 v[12:15], v1, s[4:7], s69 offen sc1
    s_waitcnt vmcnt(0) lgkmcnt(0)
    buffer_store_dword v8, v26, s[4:7], s70 offen sc1
    buffer_store_dword v8, v26, s[4:7], s70 offen offset:2048 sc1
    s_endpgm
L_R_w1:
    ds_read_b128 v[120:123], v11 offset:24576
    ds_read_b128 v[124:127], v11 offset:25600
    ds_read_b128 v[112:115], v11 offset:16384
    ds_read_b128 v[116:119], v11 offset:17408
    ds_read_b128 v[56:59], v11 offset:8192
    ds_read_b128 v[60:63], v11 offset:9216
    ds_read_b128 v[64:67], v11 offset:0
    ds_read_b128 v[68:71], v11 offset:1024
    ds_read_b128 v[132:135], v11 offset:32768
    ds_read_b128 v[136:139], v11 offset:33792
    v_mov_b64 v[72:73], 0
    v_mov_b64 v[74:75], 0
    v_mov_b64 v[76:77], 0
    v_mov_b64 v[78:79], 0
    v_mov_b64 v[80:81], 0
    v_mov_b64 v[82:83], 0
    v_mov_b64 v[84:85], 0
    v_mov_b64 v[86:87], 0
    v_mov_b64 v[88:89], 0
    v_mov_b64 v[90:91], 0
    v_mov_b64 v[92:93], 0
    v_mov_b64 v[94:95], 0
    s_xor_b32 s66, s66, 0x40000
    s_waitcnt lgkmcnt(0)
L_Rloop_f1:
    v_cmp_eq_u32 vcc, 0, v0
    s_cbranch_vccnz L_kvspin_f1
L_kvback_f1:
    v_mov_b64 v[32:33], v[40:41]
    v_mov_b64 v[34:35], v[42:43]
    v_mov_b64 v[36:37], v[44:45]
    v_mov_b64 v[38:39], v[46:47]
    s_xor_b32 s66, s66, 0x40000
    s_cmp_lt_u32 s61, 63
    s_cselect_b32 s75, 786432, 0
    s_add_u32 s67, s67, s75
    s_cmp_lt_u32 s61, 62
    s_cselect_b32 s75, 2048, 0
    s_add_u32 s68, s68, s75
    s_cmp_ge_u32 s61, 2
    s_cselect_b32 s76, s70, 0x40000000
    s_cmp_ge_u32 s61, 1
    s_cselect_b32 s75, s69, 0x40000000
    s_add_u32 s70, s70, 2048
    s_cmp_eq_u32 s61, 61
    s_cselect_b32 s78, 0xd00000, 0
    s_add_u32 s69, s69, s78
    s_add_u32 s69, s69, 131072
    s_lshr_b32 s78, s61, 1
    s_and_b32 s78, s78, 1
    s_sub_u32 s79, s78, 1
    buffer_load_dwordx4 v[96:99], v1, s[4:7], s62 offen offset:0 sc1
    s_add_u32 s65, s64, 32768
    s_and_b32 s24, s61, 1
    s_sub_u32 s25, s24, 1
    s_nop 3
    buffer_load_dwordx4 v[100:103], v1, s[4:7], s62 offen offset:1024 sc1
    s_nop 15
    s_nop 11
    buffer_load_dwordx4 v[96:99], v1, s[4:7], s62 offen offset:0 sc1
    s_nop 7
    buffer_load_dwordx4 v[100:103], v1, s[4:7], s62 offen offset:1024 sc1
    s_mov_b32 s23, s60
L_pw_Bf1:
    s_waitcnt vmcnt(3)
    v_max3_u32 v140, v96, v97, v98
    v_max_u32 v140, v140, v99
    v_cmp_eq_u32 vcc, -1, v140
    ds_write_b128 v4, v[96:99]
    v_smfmac_f32_16x16x64_bf16 v[72:75], v[96:99], v[120:127], v18
    s_cbranch_vccnz L_poll_Bf1
L_pok_Bf1:
    v_smfmac_f32_16x16x64_bf16 v[76:79], v[96:99], v[112:119], v18
    s_waitcnt vmcnt(2)
    v_max3_u32 v140, v100, v101, v102
    v_smfmac_f32_16x16x64_bf16 v[80:83], v[96:99], v[132:139], v18
    v_max_u32 v140, v140, v103
    v_smfmac_f32_16x16x64_bf16 v[84:87], v[96:99], a[96:103], v18
    v_cmp_eq_u32 vcc, -1, v140
    v_smfmac_f32_16x16x64_bf16 v[88:91], v[96:99], a[160:167], v18
    s_cbranch_vccnz L_pol1_Bf1
L_pk1_Bf1:
    ds_write_b128 v4, v[100:103] offset:1024
    s_cmp_eq_u32 s61, 63
    v_smfmac_f32_16x16x64_bf16 v[80:83], v[100:103], a[104:111], v18
    s_cbranch_scc1 L_Rlast_f1
    v_smfmac_f32_16x16x64_bf16 v[72:75], v[100:103], v[56:63], v18
    v_smfmac_f32_16x16x64_bf16 v[76:79], v[100:103], v[64:71], v18
    v_smfmac_f32_16x16x64_bf16 v[84:87], v[100:103], a[112:119], v18
    s_waitcnt lgkmcnt(0)
    s_barrier
    ds_read_b128 v[104:107], v5 offset:0
    ds_read_b128 v[108:111], v5 offset:1024
    ds_read_b128 v[112:115], v6 offset:0
    v_smfmac_f32_16x16x64_bf16 v[92:95], v[96:99], a[168:175], v18
    ds_read_b128 v[116:119], v6 offset:1024
    v_smfmac_f32_16x16x64_bf16 v[88:91], v[100:103], a[176:183], v18
    ds_read_b128 v[120:123], v7 offset:0
    v_smfmac_f32_16x16x64_bf16 v[92:95], v[100:103], a[184:191], v18
    ds_read_b128 v[124:127], v7 offset:1024
    s_waitcnt lgkmcnt(5)
    v_smfmac_f32_16x16x64_bf16 v[72:75], v[104:107], a[0:7], v18
    ds_read_b128 v[56:59], v11 offset:40960
    s_waitcnt lgkmcnt(5)
    v_smfmac_f32_16x16x64_bf16 v[72:75], v[108:111], a[16:23], v18
    ds_read_b128 v[60:63], v11 offset:41984
    s_waitcnt lgkmcnt(5)
    v_smfmac_f32_16x16x64_bf16 v[72:75], v[112:115], a[32:39], v18
    ds_read_b128 v[64:67], v19 offset:0
    s_waitcnt lgkmcnt(5)
    v_smfmac_f32_16x16x64_bf16 v[72:75], v[116:119], a[48:55], v18
    ds_read_b128 v[68:71], v19 offset:1024
    s_waitcnt lgkmcnt(5)
    v_smfmac_f32_16x16x64_bf16 v[72:75], v[120:123], a[64:71], v18
    ds_read_b128 v[132:135], v11 offset:49152
    s_waitcnt lgkmcnt(5)
    v_smfmac_f32_16x16x64_bf16 v[72:75], v[124:127], a[80:87], v18
    ds_read_b128 v[136:139], v11 offset:50176
    v_smfmac_f32_16x16x64_bf16 v[76:79], v[104:107], a[8:15], v18
    s_waitcnt vmcnt(0)
    buffer_store_dwordx4 v[12:15], v1, s[4:7], s75 offen sc1
    v_smfmac_f32_16x16x64_bf16 v[76:79], v[108:111], a[24:31], v18
    v_smfmac_f32_16x16x64_bf16 v[76:79], v[112:115], a[40:47], v18
    v_smfmac_f32_16x16x64_bf16 v[76:79], v[116:119], a[56:63], v18
    ds_read_b128 v[96:99], v19 offset:8192
    v_add_f32 v72, v72, v74
    v_smfmac_f32_16x16x64_bf16 v[76:79], v[120:123], a[72:79], v18
    ds_read_b128 v[100:103], v19 offset:9216
    buffer_load_dwordx4 v[40:43], v1, s[4:7], s67 offen offset:2048 sc1
    v_add_f32 v73, v73, v75
    v_smfmac_f32_16x16x64_bf16 v[76:79], v[124:127], a[88:95], v18
    v_cvt_pk_bf16_f32 v74, v72, v73
    v_smfmac_f32_16x16x64_bf16 v[80:83], v[104:107], a[120:127], v18
    s_waitcnt lgkmcnt(6)
    v_smfmac_f32_16x16x64_bf16 v[84:87], v[104:107], v[56:63], v18
    ds_read_b128 v[56:59], v11 offset:57344
    v_smfmac_f32_16x16x64_bf16 v[80:83], v[108:111], a[128:135], v18
    ds_read_b128 v[60:63], v11 offset:58368
    buffer_load_dwordx4 v[44:47], v1, s[4:7], s67 offen offset:3072 sc1
    s_waitcnt lgkmcnt(6)
    v_smfmac_f32_16x16x64_bf16 v[84:87], v[108:111], v[64:71], v18
    ds_read_b128 v[64:67], v19 offset:16384
    v_add_f32 v76, v76, v78
    v_smfmac_f32_16x16x64_bf16 v[80:83], v[112:115], a[136:143], v18
    ds_read_b128 v[68:71], v19 offset:17408
    v_add_f32 v77, v77, v79
    s_waitcnt lgkmcnt(6)
    v_smfmac_f32_16x16x64_bf16 v[84:87], v[112:115], v[132:139], v18
    ds_read_b128 v[132:135], v19 offset:24576
    v_cvt_pk_bf16_f32 v75, v76, v77
    v_smfmac_f32_16x16x64_bf16 v[80:83], v[116:119], a[144:151], v18
    ds_read_b128 v[136:139], v19 offset:25600
    buffer_store_dword v8, v26, s[4:7], s76 offen sc1
    buffer_load_dword v0, v29, s[4:7], s68 offen sc1
    v_mfma_f32_16x16x16_bf16 v[76:79], v[74:75], v[28:29], 0
    v_mfma_f32_16x16x16_bf16 v[140:143], v[74:75], v[30:31], 0
    s_waitcnt lgkmcnt(6)
    v_smfmac_f32_16x16x64_bf16 v[84:87], v[116:119], v[96:103], v18
    ds_read_b128 v[96:99], v19 offset:32768
    v_smfmac_f32_16x16x64_bf16 v[80:83], v[120:123], a[152:159], v18
    ds_read_b128 v[100:103], v19 offset:33792
    s_waitcnt lgkmcnt(4)
    v_smfmac_f32_16x16x64_bf16 v[80:83], v[124:127], v[64:71], v18
    ds_read_b128 v[64:67], v19 offset:49152
    v_cvt_pk_bf16_f32 v72, v76, v77
    v_smfmac_f32_16x16x64_bf16 v[84:87], v[120:123], v[56:63], v18
    ds_read_b128 v[68:71], v19 offset:50176
    v_cvt_pk_bf16_f32 v73, v78, v79
    v_cvt_pk_bf16_f32 v74, v140, v141
    s_waitcnt lgkmcnt(4)
    v_smfmac_f32_16x16x64_bf16 v[84:87], v[124:127], v[132:139], v18
    ds_read_b128 v[56:59], v19 offset:40960
    v_cvt_pk_bf16_f32 v75, v142, v143
    ds_read_b128 v[60:63], v19 offset:41984
    v_add_f32 v80, v80, v82
    v_mfma_f32_16x16x32_bf16 v[76:79], v[48:51], v[72:75], 0
    v_add_f32 v81, v81, v83
    v_cvt_pk_bf16_f32 v82, v80, v81
    v_mfma_f32_16x16x32_bf16 v[140:143], v[52:55], v[72:75], 0
    v_add_f32 v84, v84, v86
    v_add_f32 v85, v85, v87
    v_cvt_pk_bf16_f32 v83, v84, v85
    s_nop 1
    v_mfma_f32_16x16x16_bf16 v[84:87], v[82:83], v[128:129], 0
    v_mfma_f32_16x16x16_bf16 v[132:135], v[82:83], v[130:131], 0
    v_cndmask_b32 v80, v140, v76, s[72:73]
    v_cndmask_b32 v81, v141, v77, s[72:73]
    v_cndmask_b32 v82, v142, v78, s[72:73]
    v_cndmask_b32 v83, v143, v79, s[72:73]
    v_cvt_pk_bf16_f32 v12, v84, v85
    v_cvt_pk_bf16_f32 v13, v86, v87
    s_nop 0
    v_cvt_pk_bf16_f32 v14, v132, v133
    v_cvt_pk_bf16_f32 v15, v134, v135
    s_nop 1
    v_mfma_f32_16x16x32_bf16 v[136:139], v[12:15], v[72:75], 0
    v_smfmac_f32_16x16x64_bf16 v[88:91], v[104:107], a[192:199], v18
    ds_write_b128 v4, v[80:83] offset:8192
    s_nop 2
    v_cndmask_b32 v136, v137, v136, s[72:73]
    v_smfmac_f32_16x16x64_bf16 v[92:95], v[104:107], a[200:207], v18
    ds_write_b32 v9, v136
    v_smfmac_f32_16x16x64_bf16 v[88:91], v[108:111], a[208:215], v18
    v_smfmac_f32_16x16x64_bf16 v[92:95], v[108:111], a[216:223], v18
    ds_read_b128 v[104:107], v19 offset:57344
    buffer_load_dwordx4 v[48:51], v1, s[4:7], s67 offen offset:0 sc1
    s_waitcnt lgkmcnt(7)
    v_smfmac_f32_16x16x64_bf16 v[88:91], v[120:123], v[96:103], v18
    ds_read_b128 v[108:111], v19 offset:58368
    s_waitcnt lgkmcnt(4)
    v_smfmac_f32_16x16x64_bf16 v[92:95], v[120:123], v[56:63], v18
    s_waitcnt lgkmcnt(2)
    s_barrier
    ds_read_b128 v[136:139], v5 offset:8192
    v_smfmac_f32_16x16x64_bf16 v[88:91], v[124:127], v[64:71], v18
    ds_read_b128 v[140:143], v6 offset:8192
    ds_read_b128 v[76:79], v7 offset:8192
    v_smfmac_f32_16x16x64_bf16 v[88:91], v[112:115], a[224:231], v18
    ds_read_b128 v[132:135], v8 offset:1024
    v_mov_b64 v[96:97], s[26:27]
    v_smfmac_f32_16x16x64_bf16 v[92:95], v[112:115], a[232:239], v18
    v_mov_b64 v[98:99], s[26:27]
    v_smfmac_f32_16x16x64_bf16 v[88:91], v[116:119], a[240:247], v18
    buffer_load_dwordx4 v[52:55], v1, s[4:7], s67 offen offset:1024 sc1
    v_mov_b64 v[100:101], s[8:9]
    s_waitcnt lgkmcnt(4)
    v_smfmac_f32_16x16x64_bf16 v[92:95], v[124:127], v[104:111], v18
    v_smfmac_f32_16x16x64_bf16 v[92:95], v[116:119], a[248:255], v18
    s_waitcnt lgkmcnt(3)
    v_add_f32 v80, v80, v136
    v_add_f32 v81, v81, v137
    v_add_f32 v82, v82, v138
    v_add_f32 v83, v83, v139
    s_waitcnt lgkmcnt(1)
    v_pk_add_f32 v[140:141], v[140:141], v[76:77]
    v_pk_add_f32 v[142:143], v[142:143], v[78:79]
    s_waitcnt lgkmcnt(0)
    v_pk_add_f32 v[132:133], v[132:133], v[134:135]
    v_pk_add_f32 v[80:81], v[80:81], v[140:141]
    v_pk_add_f32 v[82:83], v[82:83], v[142:143]
    v_add_f32 v132, v132, v133
    v_max3_f32 v134, v80, v81, v82
    v_max3_f32 v134, v134, v83, v132
    v_pk_add_f32 v[88:89], v[88:89], v[90:91]
    v_pk_add_f32 v[92:93], v[92:93], v[94:95]
    v_max_f32_dpp v135, v134, v134 quad_perm:[2,3,0,1] row_mask:0xf bank_mask:0xf
    v_max_f32_dpp v134, v134, v134 quad_perm:[2,3,0,1] row_mask:0xf bank_mask:0xf
    v_cvt_pk_bf16_f32 v90, v88, v89
    v_cvt_pk_bf16_f32 v91, v92, v93
    v_permlane16_swap_b32 v134, v135
    v_max_f32 v133, v134, v135
    v_max_f32 v134, v134, v135
    v_mfma_f32_16x16x16_bf16 v[92:95], v[24:25], v[90:91], 0
    ds_read_b128 v[56:59], v4 offset:16384
    v_permlane32_swap_b32 v134, v133
    v_max_f32 v134, v134, v133
    v_mul_f32 v134, s74, v134
    v_fma_f32 v80, v80, s74, -v134
    v_fma_f32 v81, v81, s74, -v134
    v_fma_f32 v82, v82, s74, -v134
    v_fma_f32 v83, v83, s74, -v134
    v_fma_f32 v132, v132, s74, -v134
    v_exp_f32 v80, v80
    v_exp_f32 v81, v81
    v_exp_f32 v82, v82
    v_exp_f32 v83, v83
    v_exp_f32 v132, v132
    v_cvt_pk_bf16_f32 v140, v80, v81
    v_cvt_pk_bf16_f32 v141, v82, v83
    v_cndmask_b32 v72, 0, v140, s[72:73]
    v_cndmask_b32 v73, 0, v141, s[72:73]
    v_cndmask_b32 v74, v140, 0, s[72:73]
    v_cndmask_b32 v75, v141, 0, s[72:73]
    v_mov_b32_dpp v133, v132 quad_perm:[2,3,0,1] row_mask:0xf bank_mask:0xf
    v_cvt_pk_bf16_f32 v16, v92, v93
    v_mfma_f32_16x16x32_bf16 v[140:143], v[96:99], v[72:75], 0
    ds_read_b128 v[60:63], v4 offset:17408
    v_cvt_pk_bf16_f32 v136, v132, v133
    v_cvt_pk_bf16_f32 v137, v133, v132
    v_mfma_f32_16x16x32_bf16 v[84:87], v[36:39], v[72:75], 0
    ds_read_b128 v[64:67], v4 offset:24576
    v_cndmask_b32 v138, 0, v136, s[72:73]
    v_cndmask_b32 v139, v137, 0, s[72:73]
    v_mfma_f32_16x16x32_bf16 v[76:79], v[32:35], v[72:75], 0
    ds_read_b128 v[68:71], v4 offset:25600
    v_cvt_pk_bf16_f32 v17, v94, v95
    v_mfma_f32_16x16x16_bf16 v[140:143], v[100:101], v[138:139], v[140:143]
    v_mov_b64 v[112:113], 0
    v_mfma_f32_16x16x16_bf16 v[76:79], v[16:17], v[138:139], v[76:79]
    v_mov_b64 v[114:115], 0
    v_mov_b64 v[116:117], 0
    v_mov_b64 v[118:119], 0
    v_mov_b64 v[120:121], 0
    v_mov_b64 v[122:123], 0
    v_add_f32_dpp v141, v140, v140 quad_perm:[2,3,0,1] row_mask:0xf bank_mask:0xf
    v_rcp_f32 v141, v141
    v_add_f32_dpp v76, v84, v76 quad_perm:[2,3,0,1] row_mask:0xf bank_mask:0xf
    v_add_f32_dpp v77, v85, v77 quad_perm:[2,3,0,1] row_mask:0xf bank_mask:0xf
    v_add_f32_dpp v78, v86, v78 quad_perm:[2,3,0,1] row_mask:0xf bank_mask:0xf
    v_add_f32_dpp v79, v87, v79 quad_perm:[2,3,0,1] row_mask:0xf bank_mask:0xf
    v_pk_mul_f32 v[76:77], v[76:77], v[140:141] op_sel:[0,1] op_sel_hi:[1,1]
    v_pk_mul_f32 v[78:79], v[78:79], v[140:141] op_sel:[0,1] op_sel_hi:[1,1]
    v_cvt_pk_bf16_f32 v132, v76, v77
    v_cvt_pk_bf16_f32 v133, v78, v79
    v_and_or_b32 v132, v132, -2, s24
    ds_write_b64 v10, v[132:133]
    s_nop 2
    v_mov_b64 v[124:125], 0
    v_mov_b64 v[126:127], 0
    s_nop 3
    ds_read_b128 v[80:83], v27 offset:0
    ds_read_b128 v[84:87], v27 offset:512
    ds_read_b128 v[88:91], v27 offset:2048
    ds_read_b128 v[92:95], v27 offset:2560
    v_mfma_f32_16x16x16_bf16 v[96:99], v[28:29], v[28:29], v[96:99]
    v_mfma_f32_16x16x16_bf16 v[96:99], v[28:29], v[28:29], v[96:99]
L_wo_f1:
    s_waitcnt lgkmcnt(3)
    v_smfmac_f32_16x16x64_bf16 v[112:115], v[80:83], v[56:63], v18
    v_bitop3_b32 v134, v80, v82, s25 bitop3:0x42
    v_smfmac_f32_16x16x64_bf16 v[116:119], v[80:83], v[64:71], v18
    s_waitcnt lgkmcnt(2)
    v_bitop3_b32 v135, v84, v86, s25 bitop3:0x42
    v_smfmac_f32_16x16x64_bf16 v[112:115], v[84:87], v[144:151], v18
    s_waitcnt lgkmcnt(1)
    v_bitop3_b32 v136, v88, v90, s25 bitop3:0x42
    v_smfmac_f32_16x16x64_bf16 v[116:119], v[84:87], v[168:175], v18
    s_waitcnt lgkmcnt(0)
    v_bitop3_b32 v137, v92, v94, s25 bitop3:0x42
    v_smfmac_f32_16x16x64_bf16 v[112:115], v[88:91], v[152:159], v18
    v_bitop3_b32 v134, v134, v135, v136 bitop3:0x80
    v_smfmac_f32_16x16x64_bf16 v[116:119], v[88:91], v[176:183], v18
    v_bitop3_b32 v134, v134, v137, 1 bitop3:0x80
    v_smfmac_f32_16x16x64_bf16 v[112:115], v[92:95], v[160:167], v18
    v_cmp_eq_u32 vcc, 0, v134
    v_smfmac_f32_16x16x64_bf16 v[116:119], v[92:95], v[184:191], v18
    v_smfmac_f32_16x16x64_bf16 v[120:123], v[80:83], v[192:199], v18
    s_cbranch_vccnz L_ofix_f1
    v_smfmac_f32_16x16x64_bf16 v[124:127], v[80:83], v[224:231], v18
    s_nop 1
    v_mov_b32 v1, v1
    v_cvt_pk_bf16_f32 v72, v112, v113
    v_cvt_pk_bf16_f32 v73, v114, v115
    v_smfmac_f32_16x16x64_bf16 v[120:123], v[84:87], v[200:207], v18
    v_cvt_pk_bf16_f32 v74, v116, v117
    v_cvt_pk_bf16_f32 v75, v118, v119
    v_smfmac_f32_16x16x64_bf16 v[124:127], v[84:87], v[232:239], v18
    v_and_or_b32 v72, v72, -2, s78
    buffer_store_dwordx4 v[72:75], v2, s[4:7], s64 offen
    v_smfmac_f32_16x16x64_bf16 v[120:123], v[88:91], v[208:215], v18
    v_smfmac_f32_16x16x64_bf16 v[124:127], v[88:91], v[240:247], v18
    v_smfmac_f32_16x16x64_bf16 v[120:123], v[92:95], v[216:223], v18
    v_smfmac_f32_16x16x64_bf16 v[124:127], v[92:95], v[248:255], v18
    s_nop 3
    v_cvt_pk_bf16_f32 v76, v120, v121
    v_cvt_pk_bf16_f32 v77, v122, v123
    v_and_or_b32 v76, v76, -2, s78
    s_nop 0
    v_cvt_pk_bf16_f32 v78, v124, v125
    v_cvt_pk_bf16_f32 v79, v126, v127
    buffer_store_dwordx4 v[76:79], v2, s[4:7], s65 offen
    s_mov_b64 vcc, s[72:73]
    v_cndmask_b32_dpp v12, v16, v12, vcc quad_perm:[0,0,0,2] row_mask:0xf bank_mask:0xf
    v_cndmask_b32_dpp v13, v17, v13, vcc quad_perm:[0,0,0,2] row_mask:0xf bank_mask:0xf
    v_cndmask_b32_dpp v14, v16, v14, vcc quad_perm:[0,0,1,3] row_mask:0xf bank_mask:0xf
    v_cndmask_b32_dpp v15, v17, v15, vcc quad_perm:[0,0,1,3] row_mask:0xf bank_mask:0xf
    s_add_u32 s61, s61, 1
    s_xor_b32 s64, s64, 0x40000
    s_and_b32 s75, s61, 3
    s_lshl_b32 s75, s75, 13
    s_andn2_b32 s63, s63, 0x6000
    s_andn2_b32 s62, s62, 0x6000
    s_or_b32 s62, s62, s75
    s_xor_b32 s71, s75, 0x4000
    s_or_b32 s71, s71, s63
    s_or_b32 s63, s63, s75
    ds_read_b128 v[120:123], v11 offset:24576
    v_mov_b64 v[72:73], 0
    ds_read_b128 v[124:127], v11 offset:25600
    v_mov_b64 v[74:75], 0
    ds_read_b128 v[112:115], v11 offset:16384
    v_mov_b64 v[76:77], 0
    ds_read_b128 v[116:119], v11 offset:17408
    v_mov_b64 v[78:79], 0
    ds_read_b128 v[56:59], v11 offset:8192
    v_mov_b64 v[80:81], 0
    ds_read_b128 v[60:63], v11 offset:9216
    v_mov_b64 v[82:83], 0
    ds_read_b128 v[64:67], v11 offset:0
    v_mov_b64 v[84:85], 0
    ds_read_b128 v[68:71], v11 offset:1024
    v_mov_b64 v[86:87], 0
    ds_read_b128 v[132:135], v11 offset:32768
    v_mov_b64 v[88:89], 0
    buffer_load_dwordx4 v[104:107], v1, s[4:7], s66 offen sc1
    buffer_load_dwordx4 v[108:111], v1, s[4:7], s66 offen offset:1024 sc1
    ds_read_b128 v[136:139], v11 offset:33792
    v_mov_b64 v[90:91], 0
    v_mov_b64 v[92:93], 0
    v_mov_b64 v[94:95], 0
    v_mov_b32 v96, -1
    s_waitcnt lgkmcnt(0)
    v_mov_b64 v[140:141], 0
    v_mov_b64 v[142:143], 0
    v_mfma_f32_16x16x16_bf16 v[36:39], v[28:29], v[28:29], v[36:39]
    v_mfma_f32_16x16x16_bf16 v[36:39], v[28:29], v[28:29], v[36:39]
    v_mfma_f32_16x16x16_bf16 v[36:39], v[28:29], v[28:29], v[36:39]
    v_mfma_f32_16x16x16_bf16 v[36:39], v[28:29], v[28:29], v[36:39]
    v_mfma_f32_16x16x16_bf16 v[36:39], v[28:29], v[28:29], v[36:39]
    buffer_load_dwordx4 v[104:107], v1, s[4:7], s66 offen sc1
    buffer_load_dwordx4 v[108:111], v1, s[4:7], s66 offen offset:1024 sc1
    s_mov_b32 s23, s60
    s_branch L_pw_Af1
L_poll_Af1:
    s_sub_u32 s23, s23, 1
    s_cbranch_scc1 L_pto_Af1
    buffer_load_dwordx4 v[104:107], v1, s[4:7], s66 offen sc1
    buffer_load_dwordx4 v[108:111], v1, s[4:7], s66 offen offset:1024 sc1
    s_nop 1
    v_mov_b32 v1, v1
    v_mov_b64 v[140:141], 0
    v_mov_b64 v[142:143], 0
L_pw_Af1:
    s_waitcnt vmcnt(2)
    v_bitop3_b32 v32, v104, v108, s79 bitop3:0x42
    v_and_b32 v32, 1, v32
    v_cmp_eq_u32 vcc, 0, v32
    v_smfmac_f32_16x16x64_bf16 v[140:143], v[20:23], v[104:111], v18 abid:1
    s_cbranch_vccnz L_poll_Af1
L_pok_Af1:
    s_nop 1
    v_mov_b32 v1, v1
    s_nop 1
    v_mov_b32 v1, v1
    s_nop 0
    v_add_f32_dpp v140, v140, v140 row_ror:8 row_mask:0xf bank_mask:0x3
    v_add_f32_dpp v141, v141, v141 row_ror:8 row_mask:0xf bank_mask:0x3
    v_add_f32_dpp v140, v142, v142 row_ror:8 row_mask:0xf bank_mask:0xc
    v_add_f32_dpp v141, v143, v143 row_ror:8 row_mask:0xf bank_mask:0xc
    s_nop 0
    v_add_f32_dpp v140, v140, v140 row_ror:12 row_mask:0xf bank_mask:0xf
    v_add_f32_dpp v141, v141, v141 row_ror:12 row_mask:0xf bank_mask:0xf
    v_cvt_pk_bf16_f32 v142, v140, v141
    buffer_store_dword v142, v3, s[4:7], s63 offen
    buffer_store_dword v96, v3, s[4:7], s71 offen
    s_branch L_Rloop_f1
L_kvspin_f1:
    s_mov_b32 s23, s60
L_sf_11:
    buffer_load_dword v0, v29, s[4:7], s68 offen sc1
    s_waitcnt vmcnt(0)
    v_cmp_ne_u32 vcc, 0, v0
    s_cbranch_vccnz L_sfok_12
    s_sleep 2
    s_sub_u32 s23, s23, 1
    s_cbranch_scc0 L_sf_11
    s_mov_b32 s60, 0x400
L_sfok_12:
    s_branch L_kvback_f1
L_pto_Af1:
    s_mov_b32 s60, 0x400
    s_waitcnt vmcnt(0)
    s_nop 7
    v_mov_b64 v[140:141], 0
    v_mov_b64 v[142:143], 0
    s_nop 1
    v_smfmac_f32_16x16x64_bf16 v[140:143], v[20:23], v[104:111], v18 abid:1
    s_nop 7
    s_branch L_pok_Af1
L_poll_Bf1:
    s_sub_u32 s23, s23, 1
    s_cbranch_scc1 L_pto_Bf1
    buffer_load_dwordx4 v[96:99], v1, s[4:7], s62 offen offset:0 sc1
    buffer_load_dwordx4 v[100:103], v1, s[4:7], s62 offen offset:1024 sc1
    s_nop 2
    v_mov_b64 v[72:73], 0
    v_mov_b64 v[74:75], 0
    s_branch L_pw_Bf1
L_pto_Bf1:
    s_mov_b32 s60, 0x400
    s_branch L_pok_Bf1
L_pol1_Bf1:
    s_waitcnt vmcnt(0)
    v_max3_u32 v140, v100, v101, v102
    v_max_u32 v140, v140, v103
    v_cmp_eq_u32 vcc, -1, v140
    s_cbranch_vccz L_pk1_Bf1
    s_sub_u32 s23, s23, 1
    s_cbranch_scc1 L_pt1_Bf1
    buffer_load_dwordx4 v[100:103], v1, s[4:7], s62 offen offset:1024 sc1
    s_branch L_pol1_Bf1
L_pt1_Bf1:
    s_mov_b32 s60, 0x400
    s_branch L_pk1_Bf1
L_ofix_f1:
    s_mov_b32 s23, s60
L_ofix2_f1:
    ds_read_b128 v[80:83], v27 offset:0
    ds_read_b128 v[84:87], v27 offset:512
    ds_read_b128 v[88:91], v27 offset:2048
    ds_read_b128 v[92:95], v27 offset:2560
    s_waitcnt lgkmcnt(0)
    v_bitop3_b32 v134, v80, v82, s25 bitop3:0x42
    v_bitop3_b32 v135, v84, v86, s25 bitop3:0x42
    v_bitop3_b32 v136, v88, v90, s25 bitop3:0x42
    v_bitop3_b32 v137, v92, v94, s25 bitop3:0x42
    v_bitop3_b32 v134, v134, v135, v136 bitop3:0x80
    v_bitop3_b32 v134, v134, v137, 1 bitop3:0x80
    v_cmp_eq_u32 vcc, 0, v134
    s_cbranch_vccz L_ofix3_f1
    s_sub_u32 s23, s23, 1
    s_cbranch_scc0 L_ofix2_f1
    s_endpgm
L_ofix3_f1:
    v_mov_b64 v[112:113], 0
    v_mov_b64 v[114:115], 0
    v_mov_b64 v[116:117], 0
    v_mov_b64 v[118:119], 0
    v_mov_b64 v[120:121], 0
    v_mov_b64 v[122:123], 0
    v_mov_b64 v[124:125], 0
    v_mov_b64 v[126:127], 0
    s_branch L_wo_f1
L_Rlast_f1:
    ds_read_b128 v[56:59], v11 offset:40960
    ds_read_b128 v[60:63], v11 offset:41984
    v_smfmac_f32_16x16x64_bf16 v[84:87], v[100:103], a[112:119], v18
    ds_read_b128 v[64:67], v19 offset:0
    ds_read_b128 v[68:71], v19 offset:1024
    v_smfmac_f32_16x16x64_bf16 v[92:95], v[96:99], a[168:175], v18
    ds_read_b128 v[132:135], v11 offset:49152
    ds_read_b128 v[136:139], v11 offset:50176
    v_smfmac_f32_16x16x64_bf16 v[88:91], v[100:103], a[176:183], v18
    v_smfmac_f32_16x16x64_bf16 v[92:95], v[100:103], a[184:191], v18
    s_waitcnt lgkmcnt(6)
    s_barrier
    ds_read_b128 v[104:107], v5 offset:0
    ds_read_b128 v[108:111], v5 offset:1024
    ds_read_b128 v[112:115], v6 offset:0
    ds_read_b128 v[116:119], v6 offset:1024
    ds_read_b128 v[120:123], v7 offset:0
    ds_read_b128 v[124:127], v7 offset:1024
    s_waitcnt vmcnt(0)
    buffer_store_dwordx4 v[12:15], v1, s[4:7], s75 offen sc1
    buffer_store_dword v8, v26, s[4:7], s76 offen sc1
    ds_read_b128 v[96:99], v19 offset:8192
    ds_read_b128 v[100:103], v19 offset:9216
    s_waitcnt lgkmcnt(7)
    v_smfmac_f32_16x16x64_bf16 v[80:83], v[104:107], a[120:127], v18
    v_smfmac_f32_16x16x64_bf16 v[84:87], v[104:107], v[56:63], v18
    ds_read_b128 v[56:59], v11 offset:57344
    ds_read_b128 v[60:63], v11 offset:58368
    s_waitcnt lgkmcnt(8)
    v_smfmac_f32_16x16x64_bf16 v[80:83], v[108:111], a[128:135], v18
    v_smfmac_f32_16x16x64_bf16 v[84:87], v[108:111], v[64:71], v18
    ds_read_b128 v[64:67], v19 offset:16384
    ds_read_b128 v[68:71], v19 offset:17408
    s_waitcnt lgkmcnt(9)
    v_smfmac_f32_16x16x64_bf16 v[80:83], v[112:115], a[136:143], v18
    v_smfmac_f32_16x16x64_bf16 v[84:87], v[112:115], v[132:139], v18
    ds_read_b128 v[132:135], v19 offset:24576
    ds_read_b128 v[136:139], v19 offset:25600
    s_waitcnt lgkmcnt(10)
    v_smfmac_f32_16x16x64_bf16 v[80:83], v[116:119], a[144:151], v18
    s_waitcnt lgkmcnt(6)
    v_smfmac_f32_16x16x64_bf16 v[84:87], v[116:119], v[96:103], v18
    ds_read_b128 v[96:99], v19 offset:32768
    ds_read_b128 v[100:103], v19 offset:33792
    v_smfmac_f32_16x16x64_bf16 v[80:83], v[120:123], a[152:159], v18
    s_waitcnt lgkmcnt(6)
    v_smfmac_f32_16x16x64_bf16 v[84:87], v[120:123], v[56:63], v18
    ds_read_b128 v[56:59], v19 offset:40960
    ds_read_b128 v[60:63], v19 offset:41984
    v_smfmac_f32_16x16x64_bf16 v[88:91], v[104:107], a[192:199], v18
    s_waitcnt lgkmcnt(6)
    v_smfmac_f32_16x16x64_bf16 v[80:83], v[124:127], v[64:71], v18
    ds_read_b128 v[64:67], v19 offset:49152
    ds_read_b128 v[68:71], v19 offset:50176
    v_smfmac_f32_16x16x64_bf16 v[92:95], v[104:107], a[200:207], v18
    s_waitcnt lgkmcnt(6)
    v_smfmac_f32_16x16x64_bf16 v[84:87], v[124:127], v[132:139], v18
    ds_read_b128 v[132:135], v19 offset:57344
    ds_read_b128 v[136:139], v19 offset:58368
    v_smfmac_f32_16x16x64_bf16 v[88:91], v[108:111], a[208:215], v18
    s_waitcnt lgkmcnt(6)
    v_smfmac_f32_16x16x64_bf16 v[88:91], v[120:123], v[96:103], v18
    v_smfmac_f32_16x16x64_bf16 v[92:95], v[108:111], a[216:223], v18
    s_waitcnt lgkmcnt(4)
    v_smfmac_f32_16x16x64_bf16 v[92:95], v[120:123], v[56:63], v18
    v_smfmac_f32_16x16x64_bf16 v[88:91], v[112:115], a[224:231], v18
    s_waitcnt lgkmcnt(2)
    v_smfmac_f32_16x16x64_bf16 v[88:91], v[124:127], v[64:71], v18
    v_smfmac_f32_16x16x64_bf16 v[92:95], v[112:115], a[232:239], v18
    s_waitcnt lgkmcnt(0)
    v_smfmac_f32_16x16x64_bf16 v[92:95], v[124:127], v[132:139], v18
    v_smfmac_f32_16x16x64_bf16 v[88:91], v[116:119], a[240:247], v18
    v_smfmac_f32_16x16x64_bf16 v[92:95], v[116:119], a[248:255], v18
    v_add_f32 v80, v80, v82
    v_add_f32 v81, v81, v83
    v_add_f32 v84, v84, v86
    v_add_f32 v85, v85, v87
    v_cvt_pk_bf16_f32 v82, v80, v81
    v_cvt_pk_bf16_f32 v83, v84, v85
    s_nop 0
    v_add_f32 v88, v88, v90
    v_add_f32 v89, v89, v91
    v_add_f32 v92, v92, v94
    v_add_f32 v93, v93, v95
    v_cvt_pk_bf16_f32 v90, v88, v89
    v_cvt_pk_bf16_f32 v91, v92, v93
    v_mfma_f32_16x16x16_bf16 v[84:87], v[82:83], v[128:129], 0
    v_mfma_f32_16x16x16_bf16 v[132:135], v[82:83], v[130:131], 0
    v_mfma_f32_16x16x16_bf16 v[92:95], v[24:25], v[90:91], 0
    s_nop 5
    v_cvt_pk_bf16_f32 v12, v84, v85
    v_cvt_pk_bf16_f32 v13, v86, v87
    v_cvt_pk_bf16_f32 v14, v132, v133
    v_cvt_pk_bf16_f32 v15, v134, v135
    v_cvt_pk_bf16_f32 v16, v92, v93
    v_cvt_pk_bf16_f32 v17, v94, v95
L_Rtail_f1:
    s_mov_b64 vcc, s[72:73]
    v_cndmask_b32_dpp v12, v16, v12, vcc quad_perm:[0,0,0,2] row_mask:0xf bank_mask:0xf
    v_cndmask_b32_dpp v13, v17, v13, vcc quad_perm:[0,0,0,2] row_mask:0xf bank_mask:0xf
    v_cndmask_b32_dpp v14, v16, v14, vcc quad_perm:[0,0,1,3] row_mask:0xf bank_mask:0xf
    v_cndmask_b32_dpp v15, v17, v15, vcc quad_perm:[0,0,1,3] row_mask:0xf bank_mask:0xf
    buffer_store_dwordx4 v[12:15], v1, s[4:7], s69 offen sc1
    s_waitcnt vmcnt(0) lgkmcnt(0)
    buffer_store_dword v8, v26, s[4:7], s70 offen sc1
    buffer_store_dword v8, v26, s[4:7], s70 offen offset:2048 sc1
    s_endpgm
L_R_w2:
    ds_read_b128 v[120:123], v11 offset:24576
    ds_read_b128 v[124:127], v11 offset:25600
    ds_read_b128 v[112:115], v11 offset:16384
    ds_read_b128 v[116:119], v11 offset:17408
    ds_read_b128 v[56:59], v11 offset:8192
    ds_read_b128 v[60:63], v11 offset:9216
    ds_read_b128 v[64:67], v11 offset:0
    ds_read_b128 v[68:71], v11 offset:1024
    ds_read_b128 v[132:135], v11 offset:32768
    ds_read_b128 v[136:139], v11 offset:33792
    v_mov_b64 v[72:73], 0
    v_mov_b64 v[74:75], 0
    v_mov_b64 v[76:77], 0
    v_mov_b64 v[78:79], 0
    v_mov_b64 v[80:81], 0
    v_mov_b64 v[82:83], 0
    v_mov_b64 v[84:85], 0
    v_mov_b64 v[86:87], 0
    v_mov_b64 v[88:89], 0
    v_mov_b64 v[90:91], 0
    v_mov_b64 v[92:93], 0
    v_mov_b64 v[94:95], 0
    s_xor_b32 s66, s66, 0x40000
    s_waitcnt lgkmcnt(0)
L_Rloop_f2:
    v_cmp_eq_u32 vcc, 0, v0
    s_cbranch_vccnz L_kvspin_f2
L_kvback_f2:
    v_mov_b64 v[32:33], v[40:41]
    v_mov_b64 v[34:35], v[42:43]
    v_mov_b64 v[36:37], v[44:45]
    v_mov_b64 v[38:39], v[46:47]
    s_xor_b32 s66, s66, 0x40000
    s_cmp_lt_u32 s61, 63
    s_cselect_b32 s75, 786432, 0
    s_add_u32 s67, s67, s75
    s_cmp_lt_u32 s61, 62
    s_cselect_b32 s75, 2048, 0
    s_add_u32 s68, s68, s75
    s_cmp_ge_u32 s61, 2
    s_cselect_b32 s76, s70, 0x40000000
    s_cmp_ge_u32 s61, 1
    s_cselect_b32 s75, s69, 0x40000000
    s_add_u32 s70, s70, 2048
    s_cmp_eq_u32 s61, 61
    s_cselect_b32 s78, 0xd00000, 0
    s_add_u32 s69, s69, s78
    s_add_u32 s69, s69, 131072
    s_lshr_b32 s78, s61, 1
    s_and_b32 s78, s78, 1
    s_sub_u32 s79, s78, 1
    buffer_load_dwordx4 v[96:99], v1, s[4:7], s62 offen offset:0 sc1
    s_add_u32 s65, s64, 32768
    s_and_b32 s24, s61, 1
    s_sub_u32 s25, s24, 1
    s_nop 3
    buffer_load_dwordx4 v[100:103], v1, s[4:7], s62 offen offset:1024 sc1
    s_nop 15
    s_nop 11
    buffer_load_dwordx4 v[96:99], v1, s[4:7], s62 offen offset:0 sc1
    s_nop 7
    buffer_load_dwordx4 v[100:103], v1, s[4:7], s62 offen offset:1024 sc1
    s_mov_b32 s23, s60
L_pw_Bf2:
    s_waitcnt vmcnt(3)
    v_max3_u32 v140, v96, v97, v98
    v_max_u32 v140, v140, v99
    v_cmp_eq_u32 vcc, -1, v140
    ds_write_b128 v4, v[96:99]
    v_smfmac_f32_16x16x64_bf16 v[72:75], v[96:99], v[120:127], v18
    s_cbranch_vccnz L_poll_Bf2
L_pok_Bf2:
    v_smfmac_f32_16x16x64_bf16 v[76:79], v[96:99], v[112:119], v18
    s_waitcnt vmcnt(2)
    v_max3_u32 v140, v100, v101, v102
    v_smfmac_f32_16x16x64_bf16 v[80:83], v[96:99], v[132:139], v18
    v_max_u32 v140, v140, v103
    v_smfmac_f32_16x16x64_bf16 v[84:87], v[96:99], a[96:103], v18
    v_cmp_eq_u32 vcc, -1, v140
    v_smfmac_f32_16x16x64_bf16 v[88:91], v[96:99], a[160:167], v18
    s_cbranch_vccnz L_pol1_Bf2
L_pk1_Bf2:
    ds_write_b128 v4, v[100:103] offset:1024
    s_cmp_eq_u32 s61, 63
    v_smfmac_f32_16x16x64_bf16 v[80:83], v[100:103], a[104:111], v18
    s_cbranch_scc1 L_Rlast_f2
    v_smfmac_f32_16x16x64_bf16 v[72:75], v[100:103], v[56:63], v18
    v_smfmac_f32_16x16x64_bf16 v[76:79], v[100:103], v[64:71], v18
    v_smfmac_f32_16x16x64_bf16 v[84:87], v[100:103], a[112:119], v18
    s_waitcnt lgkmcnt(0)
    s_barrier
    ds_read_b128 v[104:107], v5 offset:0
    ds_read_b128 v[108:111], v5 offset:1024
    ds_read_b128 v[112:115], v6 offset:0
    v_smfmac_f32_16x16x64_bf16 v[92:95], v[96:99], a[168:175], v18
    ds_read_b128 v[116:119], v6 offset:1024
    v_smfmac_f32_16x16x64_bf16 v[88:91], v[100:103], a[176:183], v18
    ds_read_b128 v[120:123], v7 offset:0
    v_smfmac_f32_16x16x64_bf16 v[92:95], v[100:103], a[184:191], v18
    ds_read_b128 v[124:127], v7 offset:1024
    s_waitcnt lgkmcnt(5)
    v_smfmac_f32_16x16x64_bf16 v[72:75], v[104:107], a[0:7], v18
    ds_read_b128 v[56:59], v11 offset:40960
    s_waitcnt lgkmcnt(5)
    v_smfmac_f32_16x16x64_bf16 v[72:75], v[108:111], a[16:23], v18
    ds_read_b128 v[60:63], v11 offset:41984
    s_waitcnt lgkmcnt(5)
    v_smfmac_f32_16x16x64_bf16 v[72:75], v[112:115], a[32:39], v18
    ds_read_b128 v[64:67], v19 offset:0
    s_waitcnt lgkmcnt(5)
    v_smfmac_f32_16x16x64_bf16 v[72:75], v[116:119], a[48:55], v18
    ds_read_b128 v[68:71], v19 offset:1024
    s_waitcnt lgkmcnt(5)
    v_smfmac_f32_16x16x64_bf16 v[72:75], v[120:123], a[64:71], v18
    ds_read_b128 v[132:135], v11 offset:49152
    s_waitcnt lgkmcnt(5)
    v_smfmac_f32_16x16x64_bf16 v[72:75], v[124:127], a[80:87], v18
    ds_read_b128 v[136:139], v11 offset:50176
    v_smfmac_f32_16x16x64_bf16 v[76:79], v[104:107], a[8:15], v18
    v_smfmac_f32_16x16x64_bf16 v[76:79], v[108:111], a[24:31], v18
    s_waitcnt vmcnt(0)
    buffer_store_dwordx4 v[12:15], v1, s[4:7], s75 offen sc1
    v_smfmac_f32_16x16x64_bf16 v[76:79], v[112:115], a[40:47], v18
    v_smfmac_f32_16x16x64_bf16 v[76:79], v[116:119], a[56:63], v18
    ds_read_b128 v[96:99], v19 offset:8192
    v_add_f32 v72, v72, v74
    v_smfmac_f32_16x16x64_bf16 v[76:79], v[120:123], a[72:79], v18
    ds_read_b128 v[100:103], v19 offset:9216
    v_add_f32 v73, v73, v75
    v_smfmac_f32_16x16x64_bf16 v[76:79], v[124:127], a[88:95], v18
    buffer_load_dwordx4 v[40:43], v1, s[4:7], s67 offen offset:2048 sc1
    v_cvt_pk_bf16_f32 v74, v72, v73
    v_smfmac_f32_16x16x64_bf16 v[80:83], v[104:107], a[120:127], v18
    s_waitcnt lgkmcnt(6)
    v_smfmac_f32_16x16x64_bf16 v[84:87], v[104:107], v[56:63], v18
    ds_read_b128 v[56:59], v11 offset:57344
    v_smfmac_f32_16x16x64_bf16 v[80:83], v[108:111], a[128:135], v18
    ds_read_b128 v[60:63], v11 offset:58368
    s_waitcnt lgkmcnt(6)
    v_smfmac_f32_16x16x64_bf16 v[84:87], v[108:111], v[64:71], v18
    ds_read_b128 v[64:67], v19 offset:16384
    buffer_load_dwordx4 v[44:47], v1, s[4:7], s67 offen offset:3072 sc1
    v_add_f32 v76, v76, v78
    v_smfmac_f32_16x16x64_bf16 v[80:83], v[112:115], a[136:143], v18
    ds_read_b128 v[68:71], v19 offset:17408
    v_add_f32 v77, v77, v79
    s_waitcnt lgkmcnt(6)
    v_smfmac_f32_16x16x64_bf16 v[84:87], v[112:115], v[132:139], v18
    ds_read_b128 v[132:135], v19 offset:24576
    v_cvt_pk_bf16_f32 v75, v76, v77
    v_smfmac_f32_16x16x64_bf16 v[80:83], v[116:119], a[144:151], v18
    ds_read_b128 v[136:139], v19 offset:25600
    v_mfma_f32_16x16x16_bf16 v[76:79], v[74:75], v[28:29], 0
    buffer_store_dword v8, v26, s[4:7], s76 offen sc1
    buffer_load_dword v0, v29, s[4:7], s68 offen sc1
    v_mfma_f32_16x16x16_bf16 v[140:143], v[74:75], v[30:31], 0
    s_waitcnt lgkmcnt(6)
    v_smfmac_f32_16x16x64_bf16 v[84:87], v[116:119], v[96:103], v18
    ds_read_b128 v[96:99], v19 offset:32768
    v_smfmac_f32_16x16x64_bf16 v[80:83], v[120:123], a[152:159], v18
    ds_read_b128 v[100:103], v19 offset:33792
    s_waitcnt lgkmcnt(4)
    v_smfmac_f32_16x16x64_bf16 v[80:83], v[124:127], v[64:71], v18
    ds_read_b128 v[64:67], v19 offset:49152
    v_cvt_pk_bf16_f32 v72, v76, v77
    v_smfmac_f32_16x16x64_bf16 v[84:87], v[120:123], v[56:63], v18
    ds_read_b128 v[68:71], v19 offset:50176
    v_cvt_pk_bf16_f32 v73, v78, v79
    v_cvt_pk_bf16_f32 v74, v140, v141
    s_waitcnt lgkmcnt(4)
    v_smfmac_f32_16x16x64_bf16 v[84:87], v[124:127], v[132:139], v18
    ds_read_b128 v[56:59], v19 offset:40960
    v_cvt_pk_bf16_f32 v75, v142, v143
    ds_read_b128 v[60:63], v19 offset:41984
    v_add_f32 v80, v80, v82
    v_mfma_f32_16x16x32_bf16 v[76:79], v[48:51], v[72:75], 0
    v_add_f32 v81, v81, v83
    v_cvt_pk_bf16_f32 v82, v80, v81
    v_mfma_f32_16x16x32_bf16 v[140:143], v[52:55], v[72:75], 0
    v_add_f32 v84, v84, v86
    v_add_f32 v85, v85, v87
    v_cvt_pk_bf16_f32 v83, v84, v85
    s_nop 1
    v_mfma_f32_16x16x16_bf16 v[84:87], v[82:83], v[128:129], 0
    v_mfma_f32_16x16x16_bf16 v[132:135], v[82:83], v[130:131], 0
    v_cndmask_b32 v80, v140, v76, s[72:73]
    v_cndmask_b32 v81, v141, v77, s[72:73]
    v_cndmask_b32 v82, v142, v78, s[72:73]
    v_cndmask_b32 v83, v143, v79, s[72:73]
    v_cvt_pk_bf16_f32 v12, v84, v85
    v_cvt_pk_bf16_f32 v13, v86, v87
    s_nop 0
    v_cvt_pk_bf16_f32 v14, v132, v133
    v_cvt_pk_bf16_f32 v15, v134, v135
    s_nop 1
    v_mfma_f32_16x16x32_bf16 v[136:139], v[12:15], v[72:75], 0
    v_smfmac_f32_16x16x64_bf16 v[88:91], v[104:107], a[192:199], v18
    ds_write_b128 v4, v[80:83] offset:8192
    s_nop 2
    v_cndmask_b32 v136, v137, v136, s[72:73]
    v_smfmac_f32_16x16x64_bf16 v[92:95], v[104:107], a[200:207], v18
    ds_write_b32 v9, v136
    v_smfmac_f32_16x16x64_bf16 v[88:91], v[108:111], a[208:215], v18
    v_smfmac_f32_16x16x64_bf16 v[92:95], v[108:111], a[216:223], v18
    ds_read_b128 v[104:107], v19 offset:57344
    s_waitcnt lgkmcnt(7)
    v_smfmac_f32_16x16x64_bf16 v[88:91], v[120:123], v[96:103], v18
    ds_read_b128 v[108:111], v19 offset:58368
    buffer_load_dwordx4 v[48:51], v1, s[4:7], s67 offen offset:0 sc1
    s_waitcnt lgkmcnt(4)
    v_smfmac_f32_16x16x64_bf16 v[92:95], v[120:123], v[56:63], v18
    s_waitcnt lgkmcnt(2)
    s_barrier
    ds_read_b128 v[136:139], v5 offset:8192
    v_smfmac_f32_16x16x64_bf16 v[88:91], v[124:127], v[64:71], v18
    ds_read_b128 v[140:143], v6 offset:8192
    ds_read_b128 v[76:79], v7 offset:8192
    v_smfmac_f32_16x16x64_bf16 v[88:91], v[112:115], a[224:231], v18
    ds_read_b128 v[132:135], v8 offset:1024
    v_mov_b64 v[96:97], s[26:27]
    v_smfmac_f32_16x16x64_bf16 v[92:95], v[112:115], a[232:239], v18
    v_mov_b64 v[98:99], s[26:27]
    v_smfmac_f32_16x16x64_bf16 v[88:91], v[116:119], a[240:247], v18
    v_mov_b64 v[100:101], s[8:9]
    s_waitcnt lgkmcnt(4)
    v_smfmac_f32_16x16x64_bf16 v[92:95], v[124:127], v[104:111], v18
    buffer_load_dwordx4 v[52:55], v1, s[4:7], s67 offen offset:1024 sc1
    v_smfmac_f32_16x16x64_bf16 v[92:95], v[116:119], a[248:255], v18
    s_waitcnt lgkmcnt(3)
    v_add_f32 v80, v80, v136
    v_add_f32 v81, v81, v137
    v_add_f32 v82, v82, v138
    v_add_f32 v83, v83, v139
    s_waitcnt lgkmcnt(1)
    v_pk_add_f32 v[140:141], v[140:141], v[76:77]
    v_pk_add_f32 v[142:143], v[142:143], v[78:79]
    s_waitcnt lgkmcnt(0)
    v_pk_add_f32 v[132:133], v[132:133], v[134:135]
    v_pk_add_f32 v[80:81], v[80:81], v[140:141]
    v_pk_add_f32 v[82:83], v[82:83], v[142:143]
    v_add_f32 v132, v132, v133
    v_max3_f32 v134, v80, v81, v82
    v_max3_f32 v134, v134, v83, v132
    v_pk_add_f32 v[88:89], v[88:89], v[90:91]
    v_pk_add_f32 v[92:93], v[92:93], v[94:95]
    v_max_f32_dpp v135, v134, v134 quad_perm:[2,3,0,1] row_mask:0xf bank_mask:0xf
    v_max_f32_dpp v134, v134, v134 quad_perm:[2,3,0,1] row_mask:0xf bank_mask:0xf
    v_cvt_pk_bf16_f32 v90, v88, v89
    v_cvt_pk_bf16_f32 v91, v92, v93
    v_permlane16_swap_b32 v134, v135
    v_max_f32 v133, v134, v135
    v_max_f32 v134, v134, v135
    v_mfma_f32_16x16x16_bf16 v[92:95], v[24:25], v[90:91], 0
    ds_read_b128 v[56:59], v4 offset:16384
    v_permlane32_swap_b32 v134, v133
    v_max_f32 v134, v134, v133
    v_mul_f32 v134, s74, v134
    v_fma_f32 v80, v80, s74, -v134
    v_fma_f32 v81, v81, s74, -v134
    v_fma_f32 v82, v82, s74, -v134
    v_fma_f32 v83, v83, s74, -v134
    v_fma_f32 v132, v132, s74, -v134
    v_exp_f32 v80, v80
    v_exp_f32 v81, v81
    v_exp_f32 v82, v82
    v_exp_f32 v83, v83
    v_exp_f32 v132, v132
    v_cvt_pk_bf16_f32 v140, v80, v81
    v_cvt_pk_bf16_f32 v141, v82, v83
    v_cndmask_b32 v72, 0, v140, s[72:73]
    v_cndmask_b32 v73, 0, v141, s[72:73]
    v_cndmask_b32 v74, v140, 0, s[72:73]
    v_cndmask_b32 v75, v141, 0, s[72:73]
    v_mov_b32_dpp v133, v132 quad_perm:[2,3,0,1] row_mask:0xf bank_mask:0xf
    v_cvt_pk_bf16_f32 v16, v92, v93
    v_mfma_f32_16x16x32_bf16 v[140:143], v[96:99], v[72:75], 0
    ds_read_b128 v[60:63], v4 offset:17408
    v_cvt_pk_bf16_f32 v136, v132, v133
    v_cvt_pk_bf16_f32 v137, v133, v132
    v_mfma_f32_16x16x32_bf16 v[84:87], v[36:39], v[72:75], 0
    ds_read_b128 v[64:67], v4 offset:24576
    v_cndmask_b32 v138, 0, v136, s[72:73]
    v_cndmask_b32 v139, v137, 0, s[72:73]
    v_mfma_f32_16x16x32_bf16 v[76:79], v[32:35], v[72:75], 0
    ds_read_b128 v[68:71], v4 offset:25600
    v_cvt_pk_bf16_f32 v17, v94, v95
    v_mfma_f32_16x16x16_bf16 v[140:143], v[100:101], v[138:139], v[140:143]
    v_mov_b64 v[112:113], 0
    v_mfma_f32_16x16x16_bf16 v[76:79], v[16:17], v[138:139], v[76:79]
    v_mov_b64 v[114:115], 0
    v_mov_b64 v[116:117], 0
    v_mov_b64 v[118:119], 0
    v_mov_b64 v[120:121], 0
    v_mov_b64 v[122:123], 0
    v_add_f32_dpp v141, v140, v140 quad_perm:[2,3,0,1] row_mask:0xf bank_mask:0xf
    v_rcp_f32 v141, v141
    v_add_f32_dpp v76, v84, v76 quad_perm:[2,3,0,1] row_mask:0xf bank_mask:0xf
    v_add_f32_dpp v77, v85, v77 quad_perm:[2,3,0,1] row_mask:0xf bank_mask:0xf
    v_add_f32_dpp v78, v86, v78 quad_perm:[2,3,0,1] row_mask:0xf bank_mask:0xf
    v_add_f32_dpp v79, v87, v79 quad_perm:[2,3,0,1] row_mask:0xf bank_mask:0xf
    v_pk_mul_f32 v[76:77], v[76:77], v[140:141] op_sel:[0,1] op_sel_hi:[1,1]
    v_pk_mul_f32 v[78:79], v[78:79], v[140:141] op_sel:[0,1] op_sel_hi:[1,1]
    v_cvt_pk_bf16_f32 v132, v76, v77
    v_cvt_pk_bf16_f32 v133, v78, v79
    v_and_or_b32 v132, v132, -2, s24
    ds_write_b64 v10, v[132:133]
    s_nop 2
    v_mov_b64 v[124:125], 0
    v_mov_b64 v[126:127], 0
    s_nop 3
    ds_read_b128 v[80:83], v27 offset:0
    ds_read_b128 v[84:87], v27 offset:512
    ds_read_b128 v[88:91], v27 offset:2048
    ds_read_b128 v[92:95], v27 offset:2560
    v_mfma_f32_16x16x16_bf16 v[96:99], v[28:29], v[28:29], v[96:99]
    v_mfma_f32_16x16x16_bf16 v[96:99], v[28:29], v[28:29], v[96:99]
L_wo_f2:
    s_waitcnt lgkmcnt(3)
    v_smfmac_f32_16x16x64_bf16 v[112:115], v[80:83], v[56:63], v18
    v_bitop3_b32 v134, v80, v82, s25 bitop3:0x42
    v_smfmac_f32_16x16x64_bf16 v[116:119], v[80:83], v[64:71], v18
    s_waitcnt lgkmcnt(2)
    v_bitop3_b32 v135, v84, v86, s25 bitop3:0x42
    v_smfmac_f32_16x16x64_bf16 v[112:115], v[84:87], v[144:151], v18
    s_waitcnt lgkmcnt(1)
    v_bitop3_b32 v136, v88, v90, s25 bitop3:0x42
    v_smfmac_f32_16x16x64_bf16 v[116:119], v[84:87], v[168:175], v18
    s_waitcnt lgkmcnt(0)
    v_bitop3_b32 v137, v92, v94, s25 bitop3:0x42
    v_smfmac_f32_16x16x64_bf16 v[112:115], v[88:91], v[152:159], v18
    v_bitop3_b32 v134, v134, v135, v136 bitop3:0x80
    v_smfmac_f32_16x16x64_bf16 v[116:119], v[88:91], v[176:183], v18
    v_bitop3_b32 v134, v134, v137, 1 bitop3:0x80
    v_smfmac_f32_16x16x64_bf16 v[112:115], v[92:95], v[160:167], v18
    v_cmp_eq_u32 vcc, 0, v134
    v_smfmac_f32_16x16x64_bf16 v[116:119], v[92:95], v[184:191], v18
    v_smfmac_f32_16x16x64_bf16 v[120:123], v[80:83], v[192:199], v18
    s_cbranch_vccnz L_ofix_f2
    v_smfmac_f32_16x16x64_bf16 v[124:127], v[80:83], v[224:231], v18
    s_nop 1
    v_mov_b32 v1, v1
    v_cvt_pk_bf16_f32 v72, v112, v113
    v_cvt_pk_bf16_f32 v73, v114, v115
    v_smfmac_f32_16x16x64_bf16 v[120:123], v[84:87], v[200:207], v18
    v_cvt_pk_bf16_f32 v74, v116, v117
    v_cvt_pk_bf16_f32 v75, v118, v119
    v_smfmac_f32_16x16x64_bf16 v[124:127], v[84:87], v[232:239], v18
    v_and_or_b32 v72, v72, -2, s78
    buffer_store_dwordx4 v[72:75], v2, s[4:7], s64 offen
    v_smfmac_f32_16x16x64_bf16 v[120:123], v[88:91], v[208:215], v18
    v_smfmac_f32_16x16x64_bf16 v[124:127], v[88:91], v[240:247], v18
    v_smfmac_f32_16x16x64_bf16 v[120:123], v[92:95], v[216:223], v18
    v_smfmac_f32_16x16x64_bf16 v[124:127], v[92:95], v[248:255], v18
    s_nop 3
    v_cvt_pk_bf16_f32 v76, v120, v121
    v_cvt_pk_bf16_f32 v77, v122, v123
    v_and_or_b32 v76, v76, -2, s78
    s_nop 0
    v_cvt_pk_bf16_f32 v78, v124, v125
    v_cvt_pk_bf16_f32 v79, v126, v127
    buffer_store_dwordx4 v[76:79], v2, s[4:7], s65 offen
    s_mov_b64 vcc, s[72:73]
    v_cndmask_b32_dpp v12, v16, v12, vcc quad_perm:[0,0,0,2] row_mask:0xf bank_mask:0xf
    v_cndmask_b32_dpp v13, v17, v13, vcc quad_perm:[0,0,0,2] row_mask:0xf bank_mask:0xf
    v_cndmask_b32_dpp v14, v16, v14, vcc quad_perm:[0,0,1,3] row_mask:0xf bank_mask:0xf
    v_cndmask_b32_dpp v15, v17, v15, vcc quad_perm:[0,0,1,3] row_mask:0xf bank_mask:0xf
    s_add_u32 s61, s61, 1
    s_xor_b32 s64, s64, 0x40000
    s_and_b32 s75, s61, 3
    s_lshl_b32 s75, s75, 13
    s_andn2_b32 s63, s63, 0x6000
    s_andn2_b32 s62, s62, 0x6000
    s_or_b32 s62, s62, s75
    s_xor_b32 s71, s75, 0x4000
    s_or_b32 s71, s71, s63
    s_or_b32 s63, s63, s75
    ds_read_b128 v[120:123], v11 offset:24576
    v_mov_b64 v[72:73], 0
    ds_read_b128 v[124:127], v11 offset:25600
    v_mov_b64 v[74:75], 0
    ds_read_b128 v[112:115], v11 offset:16384
    v_mov_b64 v[76:77], 0
    ds_read_b128 v[116:119], v11 offset:17408
    v_mov_b64 v[78:79], 0
    ds_read_b128 v[56:59], v11 offset:8192
    v_mov_b64 v[80:81], 0
    ds_read_b128 v[60:63], v11 offset:9216
    v_mov_b64 v[82:83], 0
    ds_read_b128 v[64:67], v11 offset:0
    v_mov_b64 v[84:85], 0
    ds_read_b128 v[68:71], v11 offset:1024
    v_mov_b64 v[86:87], 0
    ds_read_b128 v[132:135], v11 offset:32768
    v_mov_b64 v[88:89], 0
    buffer_load_dwordx4 v[104:107], v1, s[4:7], s66 offen sc1
    buffer_load_dwordx4 v[108:111], v1, s[4:7], s66 offen offset:1024 sc1
    ds_read_b128 v[136:139], v11 offset:33792
    v_mov_b64 v[90:91], 0
    v_mov_b64 v[92:93], 0
    v_mov_b64 v[94:95], 0
    v_mov_b32 v96, -1
    s_waitcnt lgkmcnt(0)
    v_mov_b64 v[140:141], 0
    v_mov_b64 v[142:143], 0
    v_mfma_f32_16x16x16_bf16 v[36:39], v[28:29], v[28:29], v[36:39]
    v_mfma_f32_16x16x16_bf16 v[36:39], v[28:29], v[28:29], v[36:39]
    v_mfma_f32_16x16x16_bf16 v[36:39], v[28:29], v[28:29], v[36:39]
    v_mfma_f32_16x16x16_bf16 v[36:39], v[28:29], v[28:29], v[36:39]
    v_mfma_f32_16x16x16_bf16 v[36:39], v[28:29], v[28:29], v[36:39]
    buffer_load_dwordx4 v[104:107], v1, s[4:7], s66 offen sc1
    buffer_load_dwordx4 v[108:111], v1, s[4:7], s66 offen offset:1024 sc1
    s_mov_b32 s23, s60
    s_branch L_pw_Af2
L_poll_Af2:
    s_sub_u32 s23, s23, 1
    s_cbranch_scc1 L_pto_Af2
    buffer_load_dwordx4 v[104:107], v1, s[4:7], s66 offen sc1
    buffer_load_dwordx4 v[108:111], v1, s[4:7], s66 offen offset:1024 sc1
    s_nop 1
    v_mov_b32 v1, v1
    v_mov_b64 v[140:141], 0
    v_mov_b64 v[142:143], 0
L_pw_Af2:
    s_waitcnt vmcnt(2)
    v_bitop3_b32 v32, v104, v108, s79 bitop3:0x42
    v_and_b32 v32, 1, v32
    v_cmp_eq_u32 vcc, 0, v32
    v_smfmac_f32_16x16x64_bf16 v[140:143], v[20:23], v[104:111], v18 abid:1
    s_cbranch_vccnz L_poll_Af2
L_pok_Af2:
    s_nop 1
    v_mov_b32 v1, v1
    s_nop 1
    v_mov_b32 v1, v1
    s_nop 0
    v_add_f32_dpp v140, v140, v140 row_ror:8 row_mask:0xf bank_mask:0x3
    v_add_f32_dpp v141, v141, v141 row_ror:8 row_mask:0xf bank_mask:0x3
    v_add_f32_dpp v140, v142, v142 row_ror:8 row_mask:0xf bank_mask:0xc
    v_add_f32_dpp v141, v143, v143 row_ror:8 row_mask:0xf bank_mask:0xc
    s_nop 0
    v_add_f32_dpp v140, v140, v140 row_ror:12 row_mask:0xf bank_mask:0xf
    v_add_f32_dpp v141, v141, v141 row_ror:12 row_mask:0xf bank_mask:0xf
    v_cvt_pk_bf16_f32 v142, v140, v141
    buffer_store_dword v142, v3, s[4:7], s63 offen
    buffer_store_dword v96, v3, s[4:7], s71 offen
    s_branch L_Rloop_f2
L_kvspin_f2:
    s_mov_b32 s23, s60
L_sf_13:
    buffer_load_dword v0, v29, s[4:7], s68 offen sc1
    s_waitcnt vmcnt(0)
    v_cmp_ne_u32 vcc, 0, v0
    s_cbranch_vccnz L_sfok_14
    s_sleep 2
    s_sub_u32 s23, s23, 1
    s_cbranch_scc0 L_sf_13
    s_mov_b32 s60, 0x400
L_sfok_14:
    s_branch L_kvback_f2
L_pto_Af2:
    s_mov_b32 s60, 0x400
    s_waitcnt vmcnt(0)
    s_nop 7
    v_mov_b64 v[140:141], 0
    v_mov_b64 v[142:143], 0
    s_nop 1
    v_smfmac_f32_16x16x64_bf16 v[140:143], v[20:23], v[104:111], v18 abid:1
    s_nop 7
    s_branch L_pok_Af2
L_poll_Bf2:
    s_sub_u32 s23, s23, 1
    s_cbranch_scc1 L_pto_Bf2
    buffer_load_dwordx4 v[96:99], v1, s[4:7], s62 offen offset:0 sc1
    buffer_load_dwordx4 v[100:103], v1, s[4:7], s62 offen offset:1024 sc1
    s_nop 2
    v_mov_b64 v[72:73], 0
    v_mov_b64 v[74:75], 0
    s_branch L_pw_Bf2
L_pto_Bf2:
    s_mov_b32 s60, 0x400
    s_branch L_pok_Bf2
L_pol1_Bf2:
    s_waitcnt vmcnt(0)
    v_max3_u32 v140, v100, v101, v102
    v_max_u32 v140, v140, v103
    v_cmp_eq_u32 vcc, -1, v140
    s_cbranch_vccz L_pk1_Bf2
    s_sub_u32 s23, s23, 1
    s_cbranch_scc1 L_pt1_Bf2
    buffer_load_dwordx4 v[100:103], v1, s[4:7], s62 offen offset:1024 sc1
    s_branch L_pol1_Bf2
L_pt1_Bf2:
    s_mov_b32 s60, 0x400
    s_branch L_pk1_Bf2
L_ofix_f2:
    s_mov_b32 s23, s60
L_ofix2_f2:
    ds_read_b128 v[80:83], v27 offset:0
    ds_read_b128 v[84:87], v27 offset:512
    ds_read_b128 v[88:91], v27 offset:2048
    ds_read_b128 v[92:95], v27 offset:2560
    s_waitcnt lgkmcnt(0)
    v_bitop3_b32 v134, v80, v82, s25 bitop3:0x42
    v_bitop3_b32 v135, v84, v86, s25 bitop3:0x42
    v_bitop3_b32 v136, v88, v90, s25 bitop3:0x42
    v_bitop3_b32 v137, v92, v94, s25 bitop3:0x42
    v_bitop3_b32 v134, v134, v135, v136 bitop3:0x80
    v_bitop3_b32 v134, v134, v137, 1 bitop3:0x80
    v_cmp_eq_u32 vcc, 0, v134
    s_cbranch_vccz L_ofix3_f2
    s_sub_u32 s23, s23, 1
    s_cbranch_scc0 L_ofix2_f2
    s_endpgm
L_ofix3_f2:
    v_mov_b64 v[112:113], 0
    v_mov_b64 v[114:115], 0
    v_mov_b64 v[116:117], 0
    v_mov_b64 v[118:119], 0
    v_mov_b64 v[120:121], 0
    v_mov_b64 v[122:123], 0
    v_mov_b64 v[124:125], 0
    v_mov_b64 v[126:127], 0
    s_branch L_wo_f2
L_Rlast_f2:
    ds_read_b128 v[56:59], v11 offset:40960
    ds_read_b128 v[60:63], v11 offset:41984
    v_smfmac_f32_16x16x64_bf16 v[84:87], v[100:103], a[112:119], v18
    ds_read_b128 v[64:67], v19 offset:0
    ds_read_b128 v[68:71], v19 offset:1024
    v_smfmac_f32_16x16x64_bf16 v[92:95], v[96:99], a[168:175], v18
    ds_read_b128 v[132:135], v11 offset:49152
    ds_read_b128 v[136:139], v11 offset:50176
    v_smfmac_f32_16x16x64_bf16 v[88:91], v[100:103], a[176:183], v18
    v_smfmac_f32_16x16x64_bf16 v[92:95], v[100:103], a[184:191], v18
    s_waitcnt lgkmcnt(6)
    s_barrier
    ds_read_b128 v[104:107], v5 offset:0
    ds_read_b128 v[108:111], v5 offset:1024
    ds_read_b128 v[112:115], v6 offset:0
    ds_read_b128 v[116:119], v6 offset:1024
    ds_read_b128 v[120:123], v7 offset:0
    ds_read_b128 v[124:127], v7 offset:1024
    s_waitcnt vmcnt(0)
    buffer_store_dwordx4 v[12:15], v1, s[4:7], s75 offen sc1
    buffer_store_dword v8, v26, s[4:7], s76 offen sc1
    ds_read_b128 v[96:99], v19 offset:8192
    ds_read_b128 v[100:103], v19 offset:9216
    s_waitcnt lgkmcnt(7)
    v_smfmac_f32_16x16x64_bf16 v[80:83], v[104:107], a[120:127], v18
    v_smfmac_f32_16x16x64_bf16 v[84:87], v[104:107], v[56:63], v18
    ds_read_b128 v[56:59], v11 offset:57344
    ds_read_b128 v[60:63], v11 offset:58368
    s_waitcnt lgkmcnt(8)
    v_smfmac_f32_16x16x64_bf16 v[80:83], v[108:111], a[128:135], v18
    v_smfmac_f32_16x16x64_bf16 v[84:87], v[108:111], v[64:71], v18
    ds_read_b128 v[64:67], v19 offset:16384
    ds_read_b128 v[68:71], v19 offset:17408
    s_waitcnt lgkmcnt(9)
    v_smfmac_f32_16x16x64_bf16 v[80:83], v[112:115], a[136:143], v18
    v_smfmac_f32_16x16x64_bf16 v[84:87], v[112:115], v[132:139], v18
    ds_read_b128 v[132:135], v19 offset:24576
    ds_read_b128 v[136:139], v19 offset:25600
    s_waitcnt lgkmcnt(10)
    v_smfmac_f32_16x16x64_bf16 v[80:83], v[116:119], a[144:151], v18
    s_waitcnt lgkmcnt(6)
    v_smfmac_f32_16x16x64_bf16 v[84:87], v[116:119], v[96:103], v18
    ds_read_b128 v[96:99], v19 offset:32768
    ds_read_b128 v[100:103], v19 offset:33792
    v_smfmac_f32_16x16x64_bf16 v[80:83], v[120:123], a[152:159], v18
    s_waitcnt lgkmcnt(6)
    v_smfmac_f32_16x16x64_bf16 v[84:87], v[120:123], v[56:63], v18
    ds_read_b128 v[56:59], v19 offset:40960
    ds_read_b128 v[60:63], v19 offset:41984
    v_smfmac_f32_16x16x64_bf16 v[88:91], v[104:107], a[192:199], v18
    s_waitcnt lgkmcnt(6)
    v_smfmac_f32_16x16x64_bf16 v[80:83], v[124:127], v[64:71], v18
    ds_read_b128 v[64:67], v19 offset:49152
    ds_read_b128 v[68:71], v19 offset:50176
    v_smfmac_f32_16x16x64_bf16 v[92:95], v[104:107], a[200:207], v18
    s_waitcnt lgkmcnt(6)
    v_smfmac_f32_16x16x64_bf16 v[84:87], v[124:127], v[132:139], v18
    ds_read_b128 v[132:135], v19 offset:57344
    ds_read_b128 v[136:139], v19 offset:58368
    v_smfmac_f32_16x16x64_bf16 v[88:91], v[108:111], a[208:215], v18
    s_waitcnt lgkmcnt(6)
    v_smfmac_f32_16x16x64_bf16 v[88:91], v[120:123], v[96:103], v18
    v_smfmac_f32_16x16x64_bf16 v[92:95], v[108:111], a[216:223], v18
    s_waitcnt lgkmcnt(4)
    v_smfmac_f32_16x16x64_bf16 v[92:95], v[120:123], v[56:63], v18
    v_smfmac_f32_16x16x64_bf16 v[88:91], v[112:115], a[224:231], v18
    s_waitcnt lgkmcnt(2)
    v_smfmac_f32_16x16x64_bf16 v[88:91], v[124:127], v[64:71], v18
    v_smfmac_f32_16x16x64_bf16 v[92:95], v[112:115], a[232:239], v18
    s_waitcnt lgkmcnt(0)
    v_smfmac_f32_16x16x64_bf16 v[92:95], v[124:127], v[132:139], v18
    v_smfmac_f32_16x16x64_bf16 v[88:91], v[116:119], a[240:247], v18
    v_smfmac_f32_16x16x64_bf16 v[92:95], v[116:119], a[248:255], v18
    v_add_f32 v80, v80, v82
    v_add_f32 v81, v81, v83
    v_add_f32 v84, v84, v86
    v_add_f32 v85, v85, v87
    v_cvt_pk_bf16_f32 v82, v80, v81
    v_cvt_pk_bf16_f32 v83, v84, v85
    s_nop 0
    v_add_f32 v88, v88, v90
    v_add_f32 v89, v89, v91
    v_add_f32 v92, v92, v94
    v_add_f32 v93, v93, v95
    v_cvt_pk_bf16_f32 v90, v88, v89
    v_cvt_pk_bf16_f32 v91, v92, v93
    v_mfma_f32_16x16x16_bf16 v[84:87], v[82:83], v[128:129], 0
    v_mfma_f32_16x16x16_bf16 v[132:135], v[82:83], v[130:131], 0
    v_mfma_f32_16x16x16_bf16 v[92:95], v[24:25], v[90:91], 0
    s_nop 5
    v_cvt_pk_bf16_f32 v12, v84, v85
    v_cvt_pk_bf16_f32 v13, v86, v87
    v_cvt_pk_bf16_f32 v14, v132, v133
    v_cvt_pk_bf16_f32 v15, v134, v135
    v_cvt_pk_bf16_f32 v16, v92, v93
    v_cvt_pk_bf16_f32 v17, v94, v95
L_Rtail_f2:
    s_mov_b64 vcc, s[72:73]
    v_cndmask_b32_dpp v12, v16, v12, vcc quad_perm:[0,0,0,2] row_mask:0xf bank_mask:0xf
    v_cndmask_b32_dpp v13, v17, v13, vcc quad_perm:[0,0,0,2] row_mask:0xf bank_mask:0xf
    v_cndmask_b32_dpp v14, v16, v14, vcc quad_perm:[0,0,1,3] row_mask:0xf bank_mask:0xf
    v_cndmask_b32_dpp v15, v17, v15, vcc quad_perm:[0,0,1,3] row_mask:0xf bank_mask:0xf
    buffer_store_dwordx4 v[12:15], v1, s[4:7], s69 offen sc1
    s_waitcnt vmcnt(0) lgkmcnt(0)
    buffer_store_dword v8, v26, s[4:7], s70 offen sc1
    buffer_store_dword v8, v26, s[4:7], s70 offen offset:2048 sc1
    s_endpgm
L_R_w3:
    ds_read_b128 v[120:123], v11 offset:24576
    ds_read_b128 v[124:127], v11 offset:25600
    ds_read_b128 v[112:115], v11 offset:16384
    ds_read_b128 v[116:119], v11 offset:17408
    ds_read_b128 v[56:59], v11 offset:8192
    ds_read_b128 v[60:63], v11 offset:9216
    ds_read_b128 v[64:67], v11 offset:0
    ds_read_b128 v[68:71], v11 offset:1024
    ds_read_b128 v[132:135], v11 offset:32768
    ds_read_b128 v[136:139], v11 offset:33792
    v_mov_b64 v[72:73], 0
    v_mov_b64 v[74:75], 0
    v_mov_b64 v[76:77], 0
    v_mov_b64 v[78:79], 0
    v_mov_b64 v[80:81], 0
    v_mov_b64 v[82:83], 0
    v_mov_b64 v[84:85], 0
    v_mov_b64 v[86:87], 0
    v_mov_b64 v[88:89], 0
    v_mov_b64 v[90:91], 0
    v_mov_b64 v[92:93], 0
    v_mov_b64 v[94:95], 0
    s_xor_b32 s66, s66, 0x40000
    s_waitcnt lgkmcnt(0)
L_Rloop_f3:
    v_cmp_eq_u32 vcc, 0, v0
    s_cbranch_vccnz L_kvspin_f3
L_kvback_f3:
    v_mov_b64 v[32:33], v[40:41]
    v_mov_b64 v[34:35], v[42:43]
    v_mov_b64 v[36:37], v[44:45]
    v_mov_b64 v[38:39], v[46:47]
    s_xor_b32 s66, s66, 0x40000
    s_cmp_lt_u32 s61, 63
    s_cselect_b32 s75, 786432, 0
    s_add_u32 s67, s67, s75
    s_cmp_lt_u32 s61, 62
    s_cselect_b32 s75, 2048, 0
    s_add_u32 s68, s68, s75
    s_cmp_ge_u32 s61, 2
    s_cselect_b32 s76, s70, 0x40000000
    s_cmp_ge_u32 s61, 1
    s_cselect_b32 s75, s69, 0x40000000
    s_add_u32 s70, s70, 2048
    s_cmp_eq_u32 s61, 61
    s_cselect_b32 s78, 0xd00000, 0
    s_add_u32 s69, s69, s78
    s_add_u32 s69, s69, 131072
    s_lshr_b32 s78, s61, 1
    s_and_b32 s78, s78, 1
    s_sub_u32 s79, s78, 1
    buffer_load_dwordx4 v[96:99], v1, s[4:7], s62 offen offset:0 sc1
    s_add_u32 s65, s64, 32768
    s_and_b32 s24, s61, 1
    s_sub_u32 s25, s24, 1
    s_nop 3
    buffer_load_dwordx4 v[100:103], v1, s[4:7], s62 offen offset:1024 sc1
    s_nop 15
    s_nop 11
    buffer_load_dwordx4 v[96:99], v1, s[4:7], s62 offen offset:0 sc1
    s_nop 7
    buffer_load_dwordx4 v[100:103], v1, s[4:7], s62 offen offset:1024 sc1
    s_mov_b32 s23, s60
L_pw_Bf3:
    s_waitcnt vmcnt(3)
    v_max3_u32 v140, v96, v97, v98
    v_max_u32 v140, v140, v99
    v_cmp_eq_u32 vcc, -1, v140
    ds_write_b128 v4, v[96:99]
    v_smfmac_f32_16x16x64_bf16 v[72:75], v[96:99], v[120:127], v18
    s_cbranch_vccnz L_poll_Bf3
L_pok_Bf3:
    v_smfmac_f32_16x16x64_bf16 v[76:79], v[96:99], v[112:119], v18
    s_waitcnt vmcnt(2)
    v_max3_u32 v140, v100, v101, v102
    v_smfmac_f32_16x16x64_bf16 v[80:83], v[96:99], v[132:139], v18
    v_max_u32 v140, v140, v103
    v_smfmac_f32_16x16x64_bf16 v[84:87], v[96:99], a[96:103], v18
    v_cmp_eq_u32 vcc, -1, v140
    v_smfmac_f32_16x16x64_bf16 v[88:91], v[96:99], a[160:167], v18
    s_cbranch_vccnz L_pol1_Bf3
L_pk1_Bf3:
    ds_write_b128 v4, v[100:103] offset:1024
    s_cmp_eq_u32 s61, 63
    v_smfmac_f32_16x16x64_bf16 v[80:83], v[100:103], a[104:111], v18
    s_cbranch_scc1 L_Rlast_f3
    v_smfmac_f32_16x16x64_bf16 v[72:75], v[100:103], v[56:63], v18
    v_smfmac_f32_16x16x64_bf16 v[76:79], v[100:103], v[64:71], v18
    v_smfmac_f32_16x16x64_bf16 v[84:87], v[100:103], a[112:119], v18
    s_waitcnt lgkmcnt(0)
    s_barrier
    ds_read_b128 v[104:107], v5 offset:0
    ds_read_b128 v[108:111], v5 offset:1024
    ds_read_b128 v[112:115], v6 offset:0
    v_smfmac_f32_16x16x64_bf16 v[92:95], v[96:99], a[168:175], v18
    ds_read_b128 v[116:119], v6 offset:1024
    v_smfmac_f32_16x16x64_bf16 v[88:91], v[100:103], a[176:183], v18
    ds_read_b128 v[120:123], v7 offset:0
    v_smfmac_f32_16x16x64_bf16 v[92:95], v[100:103], a[184:191], v18
    ds_read_b128 v[124:127], v7 offset:1024
    s_waitcnt lgkmcnt(5)
    v_smfmac_f32_16x16x64_bf16 v[72:75], v[104:107], a[0:7], v18
    ds_read_b128 v[56:59], v11 offset:40960
    s_waitcnt lgkmcnt(5)
    v_smfmac_f32_16x16x64_bf16 v[72:75], v[108:111], a[16:23], v18
    ds_read_b128 v[60:63], v11 offset:41984
    s_waitcnt lgkmcnt(5)
    v_smfmac_f32_16x16x64_bf16 v[72:75], v[112:115], a[32:39], v18
    ds_read_b128 v[64:67], v19 offset:0
    s_waitcnt lgkmcnt(5)
    v_smfmac_f32_16x16x64_bf16 v[72:75], v[116:119], a[48:55], v18
    ds_read_b128 v[68:71], v19 offset:1024
    s_waitcnt lgkmcnt(5)
    v_smfmac_f32_16x16x64_bf16 v[72:75], v[120:123], a[64:71], v18
    ds_read_b128 v[132:135], v11 offset:49152
    s_waitcnt lgkmcnt(5)
    v_smfmac_f32_16x16x64_bf16 v[72:75], v[124:127], a[80:87], v18
    ds_read_b128 v[136:139], v11 offset:50176
    v_smfmac_f32_16x16x64_bf16 v[76:79], v[104:107], a[8:15], v18
    v_smfmac_f32_16x16x64_bf16 v[76:79], v[108:111], a[24:31], v18
    v_smfmac_f32_16x16x64_bf16 v[76:79], v[112:115], a[40:47], v18
    s_waitcnt vmcnt(0)
    buffer_store_dwordx4 v[12:15], v1, s[4:7], s75 offen sc1
    v_smfmac_f32_16x16x64_bf16 v[76:79], v[116:119], a[56:63], v18
    ds_read_b128 v[96:99], v19 offset:8192
    v_add_f32 v72, v72, v74
    v_smfmac_f32_16x16x64_bf16 v[76:79], v[120:123], a[72:79], v18
    ds_read_b128 v[100:103], v19 offset:9216
    v_add_f32 v73, v73, v75
    v_smfmac_f32_16x16x64_bf16 v[76:79], v[124:127], a[88:95], v18
    v_cvt_pk_bf16_f32 v74, v72, v73
    v_smfmac_f32_16x16x64_bf16 v[80:83], v[104:107], a[120:127], v18
    buffer_load_dwordx4 v[40:43], v1, s[4:7], s67 offen offset:2048 sc1
    s_waitcnt lgkmcnt(6)
    v_smfmac_f32_16x16x64_bf16 v[84:87], v[104:107], v[56:63], v18
    ds_read_b128 v[56:59], v11 offset:57344
    v_smfmac_f32_16x16x64_bf16 v[80:83], v[108:111], a[128:135], v18
    ds_read_b128 v[60:63], v11 offset:58368
    s_waitcnt lgkmcnt(6)
    v_smfmac_f32_16x16x64_bf16 v[84:87], v[108:111], v[64:71], v18
    ds_read_b128 v[64:67], v19 offset:16384
    v_add_f32 v76, v76, v78
    v_smfmac_f32_16x16x64_bf16 v[80:83], v[112:115], a[136:143], v18
    ds_read_b128 v[68:71], v19 offset:17408
    buffer_load_dwordx4 v[44:47], v1, s[4:7], s67 offen offset:3072 sc1
    v_add_f32 v77, v77, v79
    s_waitcnt lgkmcnt(6)
    v_smfmac_f32_16x16x64_bf16 v[84:87], v[112:115], v[132:139], v18
    ds_read_b128 v[132:135], v19 offset:24576
    v_cvt_pk_bf16_f32 v75, v76, v77
    v_smfmac_f32_16x16x64_bf16 v[80:83], v[116:119], a[144:151], v18
    ds_read_b128 v[136:139], v19 offset:25600
    v_mfma_f32_16x16x16_bf16 v[76:79], v[74:75], v[28:29], 0
    v_mfma_f32_16x16x16_bf16 v[140:143], v[74:75], v[30:31], 0
    buffer_store_dword v8, v26, s[4:7], s76 offen sc1
    buffer_load_dword v0, v29, s[4:7], s68 offen sc1
    s_waitcnt lgkmcnt(6)
    v_smfmac_f32_16x16x64_bf16 v[84:87], v[116:119], v[96:103], v18
    ds_read_b128 v[96:99], v19 offset:32768
    v_smfmac_f32_16x16x64_bf16 v[80:83], v[120:123], a[152:159], v18
    ds_read_b128 v[100:103], v19 offset:33792
    s_waitcnt lgkmcnt(4)
    v_smfmac_f32_16x16x64_bf16 v[80:83], v[124:127], v[64:71], v18
    ds_read_b128 v[64:67], v19 offset:49152
    v_cvt_pk_bf16_f32 v72, v76, v77
    v_smfmac_f32_16x16x64_bf16 v[84:87], v[120:123], v[56:63], v18
    ds_read_b128 v[68:71], v19 offset:50176
    v_cvt_pk_bf16_f32 v73, v78, v79
    v_cvt_pk_bf16_f32 v74, v140, v141
    s_waitcnt lgkmcnt(4)
    v_smfmac_f32_16x16x64_bf16 v[84:87], v[124:127], v[132:139], v18
    ds_read_b128 v[56:59], v19 offset:40960
    v_cvt_pk_bf16_f32 v75, v142, v143
    ds_read_b128 v[60:63], v19 offset:41984
    v_add_f32 v80, v80, v82
    v_mfma_f32_16x16x32_bf16 v[76:79], v[48:51], v[72:75], 0
    v_add_f32 v81, v81, v83
    v_cvt_pk_bf16_f32 v82, v80, v81
    v_mfma_f32_16x16x32_bf16 v[140:143], v[52:55], v[72:75], 0
    v_add_f32 v84, v84, v86
    v_add_f32 v85, v85, v87
    v_cvt_pk_bf16_f32 v83, v84, v85
    s_nop 1
    v_mfma_f32_16x16x16_bf16 v[84:87], v[82:83], v[128:129], 0
    v_mfma_f32_16x16x16_bf16 v[132:135], v[82:83], v[130:131], 0
    v_cndmask_b32 v80, v140, v76, s[72:73]
    v_cndmask_b32 v81, v141, v77, s[72:73]
    v_cndmask_b32 v82, v142, v78, s[72:73]
    v_cndmask_b32 v83, v143, v79, s[72:73]
    v_cvt_pk_bf16_f32 v12, v84, v85
    v_cvt_pk_bf16_f32 v13, v86, v87
    s_nop 0
    v_cvt_pk_bf16_f32 v14, v132, v133
    v_cvt_pk_bf16_f32 v15, v134, v135
    s_nop 1
    v_mfma_f32_16x16x32_bf16 v[136:139], v[12:15], v[72:75], 0
    v_smfmac_f32_16x16x64_bf16 v[88:91], v[104:107], a[192:199], v18
    ds_write_b128 v4, v[80:83] offset:8192
    s_nop 2
    v_cndmask_b32 v136, v137, v136, s[72:73]
    v_smfmac_f32_16x16x64_bf16 v[92:95], v[104:107], a[200:207], v18
    ds_write_b32 v9, v136
    v_smfmac_f32_16x16x64_bf16 v[88:91], v[108:111], a[208:215], v18
    v_smfmac_f32_16x16x64_bf16 v[92:95], v[108:111], a[216:223], v18
    ds_read_b128 v[104:107], v19 offset:57344
    s_waitcnt lgkmcnt(7)
    v_smfmac_f32_16x16x64_bf16 v[88:91], v[120:123], v[96:103], v18
    ds_read_b128 v[108:111], v19 offset:58368
    s_waitcnt lgkmcnt(4)
    v_smfmac_f32_16x16x64_bf16 v[92:95], v[120:123], v[56:63], v18
    buffer_load_dwordx4 v[48:51], v1, s[4:7], s67 offen offset:0 sc1
    s_waitcnt lgkmcnt(2)
    s_barrier
    ds_read_b128 v[136:139], v5 offset:8192
    v_smfmac_f32_16x16x64_bf16 v[88:91], v[124:127], v[64:71], v18
    ds_read_b128 v[140:143], v6 offset:8192
    ds_read_b128 v[76:79], v7 offset:8192
    v_smfmac_f32_16x16x64_bf16 v[88:91], v[112:115], a[224:231], v18
    ds_read_b128 v[132:135], v8 offset:1024
    v_mov_b64 v[96:97], s[26:27]
    v_smfmac_f32_16x16x64_bf16 v[92:95], v[112:115], a[232:239], v18
    v_mov_b64 v[98:99], s[26:27]
    v_smfmac_f32_16x16x64_bf16 v[88:91], v[116:119], a[240:247], v18
    v_mov_b64 v[100:101], s[8:9]
    s_waitcnt lgkmcnt(4)
    v_smfmac_f32_16x16x64_bf16 v[92:95], v[124:127], v[104:111], v18
    v_smfmac_f32_16x16x64_bf16 v[92:95], v[116:119], a[248:255], v18
    buffer_load_dwordx4 v[52:55], v1, s[4:7], s67 offen offset:1024 sc1
    s_waitcnt lgkmcnt(3)
    v_add_f32 v80, v80, v136
    v_add_f32 v81, v81, v137
    v_add_f32 v82, v82, v138
    v_add_f32 v83, v83, v139
    s_waitcnt lgkmcnt(1)
    v_pk_add_f32 v[140:141], v[140:141], v[76:77]
    v_pk_add_f32 v[142:143], v[142:143], v[78:79]
    s_waitcnt lgkmcnt(0)
    v_pk_add_f32 v[132:133], v[132:133], v[134:135]
    v_pk_add_f32 v[80:81], v[80:81], v[140:141]
    v_pk_add_f32 v[82:83], v[82:83], v[142:143]
    v_add_f32 v132, v132, v133
    v_max3_f32 v134, v80, v81, v82
    v_max3_f32 v134, v134, v83, v132
    v_pk_add_f32 v[88:89], v[88:89], v[90:91]
    v_pk_add_f32 v[92:93], v[92:93], v[94:95]
    v_max_f32_dpp v135, v134, v134 quad_perm:[2,3,0,1] row_mask:0xf bank_mask:0xf
    v_max_f32_dpp v134, v134, v134 quad_perm:[2,3,0,1] row_mask:0xf bank_mask:0xf
    v_cvt_pk_bf16_f32 v90, v88, v89
    v_cvt_pk_bf16_f32 v91, v92, v93
    v_permlane16_swap_b32 v134, v135
    v_max_f32 v133, v134, v135
    v_max_f32 v134, v134, v135
    v_mfma_f32_16x16x16_bf16 v[92:95], v[24:25], v[90:91], 0
    ds_read_b128 v[56:59], v4 offset:16384
    v_permlane32_swap_b32 v134, v133
    v_max_f32 v134, v134, v133
    v_mul_f32 v134, s74, v134
    v_fma_f32 v80, v80, s74, -v134
    v_fma_f32 v81, v81, s74, -v134
    v_fma_f32 v82, v82, s74, -v134
    v_fma_f32 v83, v83, s74, -v134
    v_fma_f32 v132, v132, s74, -v134
    v_exp_f32 v80, v80
    v_exp_f32 v81, v81
    v_exp_f32 v82, v82
    v_exp_f32 v83, v83
    v_exp_f32 v132, v132
    v_cvt_pk_bf16_f32 v140, v80, v81
    v_cvt_pk_bf16_f32 v141, v82, v83
    v_cndmask_b32 v72, 0, v140, s[72:73]
    v_cndmask_b32 v73, 0, v141, s[72:73]
    v_cndmask_b32 v74, v140, 0, s[72:73]
    v_cndmask_b32 v75, v141, 0, s[72:73]
    v_mov_b32_dpp v133, v132 quad_perm:[2,3,0,1] row_mask:0xf bank_mask:0xf
    v_cvt_pk_bf16_f32 v16, v92, v93
    v_mfma_f32_16x16x32_bf16 v[140:143], v[96:99], v[72:75], 0
    ds_read_b128 v[60:63], v4 offset:17408
    v_cvt_pk_bf16_f32 v136, v132, v133
    v_cvt_pk_bf16_f32 v137, v133, v132
    v_mfma_f32_16x16x32_bf16 v[84:87], v[36:39], v[72:75], 0
    ds_read_b128 v[64:67], v4 offset:24576
    v_cndmask_b32 v138, 0, v136, s[72:73]
    v_cndmask_b32 v139, v137, 0, s[72:73]
    v_mfma_f32_16x16x32_bf16 v[76:79], v[32:35], v[72:75], 0
    ds_read_b128 v[68:71], v4 offset:25600
    v_cvt_pk_bf16_f32 v17, v94, v95
    v_mfma_f32_16x16x16_bf16 v[140:143], v[100:101], v[138:139], v[140:143]
    v_mov_b64 v[112:113], 0
    v_mfma_f32_16x16x16_bf16 v[76:79], v[16:17], v[138:139], v[76:79]
    v_mov_b64 v[114:115], 0
    v_mov_b64 v[116:117], 0
    v_mov_b64 v[118:119], 0
    v_mov_b64 v[120:121], 0
    v_mov_b64 v[122:123], 0
    v_add_f32_dpp v141, v140, v140 quad_perm:[2,3,0,1] row_mask:0xf bank_mask:0xf
    v_rcp_f32 v141, v141
    v_add_f32_dpp v76, v84, v76 quad_perm:[2,3,0,1] row_mask:0xf bank_mask:0xf
    v_add_f32_dpp v77, v85, v77 quad_perm:[2,3,0,1] row_mask:0xf bank_mask:0xf
    v_add_f32_dpp v78, v86, v78 quad_perm:[2,3,0,1] row_mask:0xf bank_mask:0xf
    v_add_f32_dpp v79, v87, v79 quad_perm:[2,3,0,1] row_mask:0xf bank_mask:0xf
    v_pk_mul_f32 v[76:77], v[76:77], v[140:141] op_sel:[0,1] op_sel_hi:[1,1]
    v_pk_mul_f32 v[78:79], v[78:79], v[140:141] op_sel:[0,1] op_sel_hi:[1,1]
    v_cvt_pk_bf16_f32 v132, v76, v77
    v_cvt_pk_bf16_f32 v133, v78, v79
    v_and_or_b32 v132, v132, -2, s24
    ds_write_b64 v10, v[132:133]
    s_nop 2
    v_mov_b64 v[124:125], 0
    v_mov_b64 v[126:127], 0
    s_nop 3
    ds_read_b128 v[80:83], v27 offset:0
    ds_read_b128 v[84:87], v27 offset:512
    ds_read_b128 v[88:91], v27 offset:2048
    ds_read_b128 v[92:95], v27 offset:2560
    v_mfma_f32_16x16x16_bf16 v[96:99], v[28:29], v[28:29], v[96:99]
    v_mfma_f32_16x16x16_bf16 v[96:99], v[28:29], v[28:29], v[96:99]
L_wo_f3:
    s_waitcnt lgkmcnt(3)
    v_smfmac_f32_16x16x64_bf16 v[112:115], v[80:83], v[56:63], v18
    v_bitop3_b32 v134, v80, v82, s25 bitop3:0x42
    v_smfmac_f32_16x16x64_bf16 v[116:119], v[80:83], v[64:71], v18
    s_waitcnt lgkmcnt(2)
    v_bitop3_b32 v135, v84, v86, s25 bitop3:0x42
    v_smfmac_f32_16x16x64_bf16 v[112:115], v[84:87], v[144:151], v18
    s_waitcnt lgkmcnt(1)
    v_bitop3_b32 v136, v88, v90, s25 bitop3:0x42
    v_smfmac_f32_16x16x64_bf16 v[116:119], v[84:87], v[168:175], v18
    s_waitcnt lgkmcnt(0)
    v_bitop3_b32 v137, v92, v94, s25 bitop3:0x42
    v_smfmac_f32_16x16x64_bf16 v[112:115], v[88:91], v[152:159], v18
    v_bitop3_b32 v134, v134, v135, v136 bitop3:0x80
    v_smfmac_f32_16x16x64_bf16 v[116:119], v[88:91], v[176:183], v18
    v_bitop3_b32 v134, v134, v137, 1 bitop3:0x80
    v_smfmac_f32_16x16x64_bf16 v[112:115], v[92:95], v[160:167], v18
    v_cmp_eq_u32 vcc, 0, v134
    v_smfmac_f32_16x16x64_bf16 v[116:119], v[92:95], v[184:191], v18
    v_smfmac_f32_16x16x64_bf16 v[120:123], v[80:83], v[192:199], v18
    s_cbranch_vccnz L_ofix_f3
    v_smfmac_f32_16x16x64_bf16 v[124:127], v[80:83], v[224:231], v18
    s_nop 1
    v_mov_b32 v1, v1
    v_cvt_pk_bf16_f32 v72, v112, v113
    v_cvt_pk_bf16_f32 v73, v114, v115
    v_smfmac_f32_16x16x64_bf16 v[120:123], v[84:87], v[200:207], v18
    v_cvt_pk_bf16_f32 v74, v116, v117
    v_cvt_pk_bf16_f32 v75, v118, v119
    v_smfmac_f32_16x16x64_bf16 v[124:127], v[84:87], v[232:239], v18
    v_and_or_b32 v72, v72, -2, s78
    buffer_store_dwordx4 v[72:75], v2, s[4:7], s64 offen
    v_smfmac_f32_16x16x64_bf16 v[120:123], v[88:91], v[208:215], v18
    v_smfmac_f32_16x16x64_bf16 v[124:127], v[88:91], v[240:247], v18
    v_smfmac_f32_16x16x64_bf16 v[120:123], v[92:95], v[216:223], v18
    v_smfmac_f32_16x16x64_bf16 v[124:127], v[92:95], v[248:255], v18
    s_nop 3
    v_cvt_pk_bf16_f32 v76, v120, v121
    v_cvt_pk_bf16_f32 v77, v122, v123
    v_and_or_b32 v76, v76, -2, s78
    s_nop 0
    v_cvt_pk_bf16_f32 v78, v124, v125
    v_cvt_pk_bf16_f32 v79, v126, v127
    buffer_store_dwordx4 v[76:79], v2, s[4:7], s65 offen
    s_mov_b64 vcc, s[72:73]
    v_cndmask_b32_dpp v12, v16, v12, vcc quad_perm:[0,0,0,2] row_mask:0xf bank_mask:0xf
    v_cndmask_b32_dpp v13, v17, v13, vcc quad_perm:[0,0,0,2] row_mask:0xf bank_mask:0xf
    v_cndmask_b32_dpp v14, v16, v14, vcc quad_perm:[0,0,1,3] row_mask:0xf bank_mask:0xf
    v_cndmask_b32_dpp v15, v17, v15, vcc quad_perm:[0,0,1,3] row_mask:0xf bank_mask:0xf
    s_add_u32 s61, s61, 1
    s_xor_b32 s64, s64, 0x40000
    s_and_b32 s75, s61, 3
    s_lshl_b32 s75, s75, 13
    s_andn2_b32 s63, s63, 0x6000
    s_andn2_b32 s62, s62, 0x6000
    s_or_b32 s62, s62, s75
    s_xor_b32 s71, s75, 0x4000
    s_or_b32 s71, s71, s63
    s_or_b32 s63, s63, s75
    ds_read_b128 v[120:123], v11 offset:24576
    v_mov_b64 v[72:73], 0
    ds_read_b128 v[124:127], v11 offset:25600
    v_mov_b64 v[74:75], 0
    ds_read_b128 v[112:115], v11 offset:16384
    v_mov_b64 v[76:77], 0
    ds_read_b128 v[116:119], v11 offset:17408
    v_mov_b64 v[78:79], 0
    ds_read_b128 v[56:59], v11 offset:8192
    v_mov_b64 v[80:81], 0
    ds_read_b128 v[60:63], v11 offset:9216
    v_mov_b64 v[82:83], 0
    ds_read_b128 v[64:67], v11 offset:0
    v_mov_b64 v[84:85], 0
    ds_read_b128 v[68:71], v11 offset:1024
    v_mov_b64 v[86:87], 0
    ds_read_b128 v[132:135], v11 offset:32768
    v_mov_b64 v[88:89], 0
    buffer_load_dwordx4 v[104:107], v1, s[4:7], s66 offen sc1
    buffer_load_dwordx4 v[108:111], v1, s[4:7], s66 offen offset:1024 sc1
    ds_read_b128 v[136:139], v11 offset:33792
    v_mov_b64 v[90:91], 0
    v_mov_b64 v[92:93], 0
    v_mov_b64 v[94:95], 0
    v_mov_b32 v96, -1
    s_waitcnt lgkmcnt(0)
    v_mov_b64 v[140:141], 0
    v_mov_b64 v[142:143], 0
    v_mfma_f32_16x16x16_bf16 v[36:39], v[28:29], v[28:29], v[36:39]
    v_mfma_f32_16x16x16_bf16 v[36:39], v[28:29], v[28:29], v[36:39]
    v_mfma_f32_16x16x16_bf16 v[36:39], v[28:29], v[28:29], v[36:39]
    v_mfma_f32_16x16x16_bf16 v[36:39], v[28:29], v[28:29], v[36:39]
    v_mfma_f32_16x16x16_bf16 v[36:39], v[28:29], v[28:29], v[36:39]
    buffer_load_dwordx4 v[104:107], v1, s[4:7], s66 offen sc1
    buffer_load_dwordx4 v[108:111], v1, s[4:7], s66 offen offset:1024 sc1
    s_mov_b32 s23, s60
    s_branch L_pw_Af3
L_poll_Af3:
    s_sub_u32 s23, s23, 1
    s_cbranch_scc1 L_pto_Af3
    buffer_load_dwordx4 v[104:107], v1, s[4:7], s66 offen sc1
    buffer_load_dwordx4 v[108:111], v1, s[4:7], s66 offen offset:1024 sc1
    s_nop 1
    v_mov_b32 v1, v1
    v_mov_b64 v[140:141], 0
    v_mov_b64 v[142:143], 0
L_pw_Af3:
    s_waitcnt vmcnt(2)
    v_bitop3_b32 v32, v104, v108, s79 bitop3:0x42
    v_and_b32 v32, 1, v32
    v_cmp_eq_u32 vcc, 0, v32
    v_smfmac_f32_16x16x64_bf16 v[140:143], v[20:23], v[104:111], v18 abid:1
    s_cbranch_vccnz L_poll_Af3
L_pok_Af3:
    s_nop 1
    v_mov_b32 v1, v1
    s_nop 1
    v_mov_b32 v1, v1
    s_nop 0
    v_add_f32_dpp v140, v140, v140 row_ror:8 row_mask:0xf bank_mask:0x3
    v_add_f32_dpp v141, v141, v141 row_ror:8 row_mask:0xf bank_mask:0x3
    v_add_f32_dpp v140, v142, v142 row_ror:8 row_mask:0xf bank_mask:0xc
    v_add_f32_dpp v141, v143, v143 row_ror:8 row_mask:0xf bank_mask:0xc
    s_nop 0
    v_add_f32_dpp v140, v140, v140 row_ror:12 row_mask:0xf bank_mask:0xf
    v_add_f32_dpp v141, v141, v141 row_ror:12 row_mask:0xf bank_mask:0xf
    v_cvt_pk_bf16_f32 v142, v140, v141
    buffer_store_dword v142, v3, s[4:7], s63 offen
    buffer_store_dword v96, v3, s[4:7], s71 offen
    s_branch L_Rloop_f3
L_kvspin_f3:
    s_mov_b32 s23, s60
L_sf_15:
    buffer_load_dword v0, v29, s[4:7], s68 offen sc1
    s_waitcnt vmcnt(0)
    v_cmp_ne_u32 vcc, 0, v0
    s_cbranch_vccnz L_sfok_16
    s_sleep 2
    s_sub_u32 s23, s23, 1
    s_cbranch_scc0 L_sf_15
    s_mov_b32 s60, 0x400
L_sfok_16:
    s_branch L_kvback_f3
L_pto_Af3:
    s_mov_b32 s60, 0x400
    s_waitcnt vmcnt(0)
    s_nop 7
    v_mov_b64 v[140:141], 0
    v_mov_b64 v[142:143], 0
    s_nop 1
    v_smfmac_f32_16x16x64_bf16 v[140:143], v[20:23], v[104:111], v18 abid:1
    s_nop 7
    s_branch L_pok_Af3
L_poll_Bf3:
    s_sub_u32 s23, s23, 1
    s_cbranch_scc1 L_pto_Bf3
    buffer_load_dwordx4 v[96:99], v1, s[4:7], s62 offen offset:0 sc1
    buffer_load_dwordx4 v[100:103], v1, s[4:7], s62 offen offset:1024 sc1
    s_nop 2
    v_mov_b64 v[72:73], 0
    v_mov_b64 v[74:75], 0
    s_branch L_pw_Bf3
L_pto_Bf3:
    s_mov_b32 s60, 0x400
    s_branch L_pok_Bf3
L_pol1_Bf3:
    s_waitcnt vmcnt(0)
    v_max3_u32 v140, v100, v101, v102
    v_max_u32 v140, v140, v103
    v_cmp_eq_u32 vcc, -1, v140
    s_cbranch_vccz L_pk1_Bf3
    s_sub_u32 s23, s23, 1
    s_cbranch_scc1 L_pt1_Bf3
    buffer_load_dwordx4 v[100:103], v1, s[4:7], s62 offen offset:1024 sc1
    s_branch L_pol1_Bf3
L_pt1_Bf3:
    s_mov_b32 s60, 0x400
    s_branch L_pk1_Bf3
L_ofix_f3:
    s_mov_b32 s23, s60
L_ofix2_f3:
    ds_read_b128 v[80:83], v27 offset:0
    ds_read_b128 v[84:87], v27 offset:512
    ds_read_b128 v[88:91], v27 offset:2048
    ds_read_b128 v[92:95], v27 offset:2560
    s_waitcnt lgkmcnt(0)
    v_bitop3_b32 v134, v80, v82, s25 bitop3:0x42
    v_bitop3_b32 v135, v84, v86, s25 bitop3:0x42
    v_bitop3_b32 v136, v88, v90, s25 bitop3:0x42
    v_bitop3_b32 v137, v92, v94, s25 bitop3:0x42
    v_bitop3_b32 v134, v134, v135, v136 bitop3:0x80
    v_bitop3_b32 v134, v134, v137, 1 bitop3:0x80
    v_cmp_eq_u32 vcc, 0, v134
    s_cbranch_vccz L_ofix3_f3
    s_sub_u32 s23, s23, 1
    s_cbranch_scc0 L_ofix2_f3
    s_endpgm
L_ofix3_f3:
    v_mov_b64 v[112:113], 0
    v_mov_b64 v[114:115], 0
    v_mov_b64 v[116:117], 0
    v_mov_b64 v[118:119], 0
    v_mov_b64 v[120:121], 0
    v_mov_b64 v[122:123], 0
    v_mov_b64 v[124:125], 0
    v_mov_b64 v[126:127], 0
    s_branch L_wo_f3
L_Rlast_f3:
    ds_read_b128 v[56:59], v11 offset:40960
    ds_read_b128 v[60:63], v11 offset:41984
    v_smfmac_f32_16x16x64_bf16 v[84:87], v[100:103], a[112:119], v18
    ds_read_b128 v[64:67], v19 offset:0
    ds_read_b128 v[68:71], v19 offset:1024
    v_smfmac_f32_16x16x64_bf16 v[92:95], v[96:99], a[168:175], v18
    ds_read_b128 v[132:135], v11 offset:49152
    ds_read_b128 v[136:139], v11 offset:50176
    v_smfmac_f32_16x16x64_bf16 v[88:91], v[100:103], a[176:183], v18
    v_smfmac_f32_16x16x64_bf16 v[92:95], v[100:103], a[184:191], v18
    s_waitcnt lgkmcnt(6)
    s_barrier
    ds_read_b128 v[104:107], v5 offset:0
    ds_read_b128 v[108:111], v5 offset:1024
    ds_read_b128 v[112:115], v6 offset:0
    ds_read_b128 v[116:119], v6 offset:1024
    ds_read_b128 v[120:123], v7 offset:0
    ds_read_b128 v[124:127], v7 offset:1024
    s_waitcnt vmcnt(0)
    buffer_store_dwordx4 v[12:15], v1, s[4:7], s75 offen sc1
    buffer_store_dword v8, v26, s[4:7], s76 offen sc1
    ds_read_b128 v[96:99], v19 offset:8192
    ds_read_b128 v[100:103], v19 offset:9216
    s_waitcnt lgkmcnt(7)
    v_smfmac_f32_16x16x64_bf16 v[80:83], v[104:107], a[120:127], v18
    v_smfmac_f32_16x16x64_bf16 v[84:87], v[104:107], v[56:63], v18
    ds_read_b128 v[56:59], v11 offset:57344
    ds_read_b128 v[60:63], v11 offset:58368
    s_waitcnt lgkmcnt(8)
    v_smfmac_f32_16x16x64_bf16 v[80:83], v[108:111], a[128:135], v18
    v_smfmac_f32_16x16x64_bf16 v[84:87], v[108:111], v[64:71], v18
    ds_read_b128 v[64:67], v19 offset:16384
    ds_read_b128 v[68:71], v19 offset:17408
    s_waitcnt lgkmcnt(9)
    v_smfmac_f32_16x16x64_bf16 v[80:83], v[112:115], a[136:143], v18
    v_smfmac_f32_16x16x64_bf16 v[84:87], v[112:115], v[132:139], v18
    ds_read_b128 v[132:135], v19 offset:24576
    ds_read_b128 v[136:139], v19 offset:25600
    s_waitcnt lgkmcnt(10)
    v_smfmac_f32_16x16x64_bf16 v[80:83], v[116:119], a[144:151], v18
    s_waitcnt lgkmcnt(6)
    v_smfmac_f32_16x16x64_bf16 v[84:87], v[116:119], v[96:103], v18
    ds_read_b128 v[96:99], v19 offset:32768
    ds_read_b128 v[100:103], v19 offset:33792
    v_smfmac_f32_16x16x64_bf16 v[80:83], v[120:123], a[152:159], v18
    s_waitcnt lgkmcnt(6)
    v_smfmac_f32_16x16x64_bf16 v[84:87], v[120:123], v[56:63], v18
    ds_read_b128 v[56:59], v19 offset:40960
    ds_read_b128 v[60:63], v19 offset:41984
    v_smfmac_f32_16x16x64_bf16 v[88:91], v[104:107], a[192:199], v18
    s_waitcnt lgkmcnt(6)
    v_smfmac_f32_16x16x64_bf16 v[80:83], v[124:127], v[64:71], v18
    ds_read_b128 v[64:67], v19 offset:49152
    ds_read_b128 v[68:71], v19 offset:50176
    v_smfmac_f32_16x16x64_bf16 v[92:95], v[104:107], a[200:207], v18
    s_waitcnt lgkmcnt(6)
    v_smfmac_f32_16x16x64_bf16 v[84:87], v[124:127], v[132:139], v18
    ds_read_b128 v[132:135], v19 offset:57344
    ds_read_b128 v[136:139], v19 offset:58368
    v_smfmac_f32_16x16x64_bf16 v[88:91], v[108:111], a[208:215], v18
    s_waitcnt lgkmcnt(6)
    v_smfmac_f32_16x16x64_bf16 v[88:91], v[120:123], v[96:103], v18
    v_smfmac_f32_16x16x64_bf16 v[92:95], v[108:111], a[216:223], v18
    s_waitcnt lgkmcnt(4)
    v_smfmac_f32_16x16x64_bf16 v[92:95], v[120:123], v[56:63], v18
    v_smfmac_f32_16x16x64_bf16 v[88:91], v[112:115], a[224:231], v18
    s_waitcnt lgkmcnt(2)
    v_smfmac_f32_16x16x64_bf16 v[88:91], v[124:127], v[64:71], v18
    v_smfmac_f32_16x16x64_bf16 v[92:95], v[112:115], a[232:239], v18
    s_waitcnt lgkmcnt(0)
    v_smfmac_f32_16x16x64_bf16 v[92:95], v[124:127], v[132:139], v18
    v_smfmac_f32_16x16x64_bf16 v[88:91], v[116:119], a[240:247], v18
    v_smfmac_f32_16x16x64_bf16 v[92:95], v[116:119], a[248:255], v18
    v_add_f32 v80, v80, v82
    v_add_f32 v81, v81, v83
    v_add_f32 v84, v84, v86
    v_add_f32 v85, v85, v87
    v_cvt_pk_bf16_f32 v82, v80, v81
    v_cvt_pk_bf16_f32 v83, v84, v85
    s_nop 0
    v_add_f32 v88, v88, v90
    v_add_f32 v89, v89, v91
    v_add_f32 v92, v92, v94
    v_add_f32 v93, v93, v95
    v_cvt_pk_bf16_f32 v90, v88, v89
    v_cvt_pk_bf16_f32 v91, v92, v93
    v_mfma_f32_16x16x16_bf16 v[84:87], v[82:83], v[128:129], 0
    v_mfma_f32_16x16x16_bf16 v[132:135], v[82:83], v[130:131], 0
    v_mfma_f32_16x16x16_bf16 v[92:95], v[24:25], v[90:91], 0
    s_nop 5
    v_cvt_pk_bf16_f32 v12, v84, v85
    v_cvt_pk_bf16_f32 v13, v86, v87
    v_cvt_pk_bf16_f32 v14, v132, v133
    v_cvt_pk_bf16_f32 v15, v134, v135
    v_cvt_pk_bf16_f32 v16, v92, v93
    v_cvt_pk_bf16_f32 v17, v94, v95
L_Rtail_f3:
    s_mov_b64 vcc, s[72:73]
    v_cndmask_b32_dpp v12, v16, v12, vcc quad_perm:[0,0,0,2] row_mask:0xf bank_mask:0xf
    v_cndmask_b32_dpp v13, v17, v13, vcc quad_perm:[0,0,0,2] row_mask:0xf bank_mask:0xf
    v_cndmask_b32_dpp v14, v16, v14, vcc quad_perm:[0,0,1,3] row_mask:0xf bank_mask:0xf
    v_cndmask_b32_dpp v15, v17, v15, vcc quad_perm:[0,0,1,3] row_mask:0xf bank_mask:0xf
    buffer_store_dwordx4 v[12:15], v1, s[4:7], s69 offen sc1
    s_waitcnt vmcnt(0) lgkmcnt(0)
    buffer_store_dword v8, v26, s[4:7], s70 offen sc1
    buffer_store_dword v8, v26, s[4:7], s70 offen offset:2048 sc1
    s_endpgm
L_R_slow:
    ds_read_b128 v[120:123], v11 offset:24576
    ds_read_b128 v[124:127], v11 offset:25600
    ds_read_b128 v[112:115], v11 offset:16384
    ds_read_b128 v[116:119], v11 offset:17408
    ds_read_b128 v[56:59], v11 offset:8192
    ds_read_b128 v[60:63], v11 offset:9216
    ds_read_b128 v[64:67], v11 offset:0
    ds_read_b128 v[68:71], v11 offset:1024
    ds_read_b128 v[132:135], v11 offset:32768
    ds_read_b128 v[136:139], v11 offset:33792
    v_mov_b64 v[72:73], 0
    v_mov_b64 v[74:75], 0
    v_mov_b64 v[76:77], 0
    v_mov_b64 v[78:79], 0
    v_mov_b64 v[80:81], 0
    v_mov_b64 v[82:83], 0
    v_mov_b64 v[84:85], 0
    v_mov_b64 v[86:87], 0
    v_mov_b64 v[88:89], 0
    v_mov_b64 v[90:91], 0
    v_mov_b64 v[92:93], 0
    v_mov_b64 v[94:95], 0
    s_xor_b32 s66, s66, 0x40000
    s_waitcnt lgkmcnt(0)
L_Rloop_s:
    v_cmp_eq_u32 vcc, 0, v0
    s_cbranch_vccnz L_kvspin_s
L_kvback_s:
    v_mov_b64 v[32:33], v[40:41]
    v_mov_b64 v[34:35], v[42:43]
    v_mov_b64 v[36:37], v[44:45]
    v_mov_b64 v[38:39], v[46:47]
    s_xor_b32 s66, s66, 0x40000
    s_cmp_lt_u32 s61, 63
    s_cselect_b32 s75, 786432, 0
    s_add_u32 s67, s67, s75
    s_cmp_lt_u32 s61, 62
    s_cselect_b32 s75, 2048, 0
    s_add_u32 s68, s68, s75
    s_cmp_ge_u32 s61, 2
    s_cselect_b32 s76, s70, 0x40000000
    s_cmp_ge_u32 s61, 1
    s_cselect_b32 s75, s69, 0x40000000
    s_add_u32 s70, s70, 2048
    s_cmp_eq_u32 s61, 61
    s_cselect_b32 s78, 0xd00000, 0
    s_add_u32 s69, s69, s78
    s_add_u32 s69, s69, 131072
    s_lshr_b32 s78, s61, 1
    s_and_b32 s78, s78, 1
    s_sub_u32 s79, s78, 1
    buffer_load_dwordx4 v[96:99], v1, s[4:7], s62 offen offset:0 sc1
    s_add_u32 s65, s64, 32768
    s_and_b32 s24, s61, 1
    s_sub_u32 s25, s24, 1
    s_nop 3
    buffer_load_dwordx4 v[100:103], v1, s[4:7], s62 offen offset:1024 sc1
    s_nop 15
    s_nop 11
    buffer_load_dwordx4 v[96:99], v1, s[4:7], s62 offen offset:0 sc1
    s_nop 7
    buffer_load_dwordx4 v[100:103], v1, s[4:7], s62 offen offset:1024 sc1
    s_mov_b32 s23, s60
L_pw_Bs:
    s_waitcnt vmcnt(3)
    v_max3_u32 v140, v96, v97, v98
    v_max_u32 v140, v140, v99
    v_cmp_eq_u32 vcc, -1, v140
    ds_write_b128 v4, v[96:99]
    v_smfmac_f32_16x16x64_bf16 v[72:75], v[96:99], v[120:127], v18
    s_cbranch_vccnz L_poll_Bs
L_pok_Bs:
    v_smfmac_f32_16x16x64_bf16 v[76:79], v[96:99], v[112:119], v18
    s_waitcnt vmcnt(2)
    v_max3_u32 v140, v100, v101, v102
    v_smfmac_f32_16x16x64_bf16 v[80:83], v[96:99], v[132:139], v18
    v_max_u32 v140, v140, v103
    v_smfmac_f32_16x16x64_bf16 v[84:87], v[96:99], a[96:103], v18
    v_cmp_eq_u32 vcc, -1, v140
    v_smfmac_f32_16x16x64_bf16 v[88:91], v[96:99], a[160:167], v18
    s_cbranch_vccnz L_pol1_Bs
L_pk1_Bs:
    ds_write_b128 v4, v[100:103] offset:1024
    s_cmp_eq_u32 s61, 63
    v_smfmac_f32_16x16x64_bf16 v[80:83], v[100:103], a[104:111], v18
    s_cbranch_scc1 L_Rlast_s
    v_smfmac_f32_16x16x64_bf16 v[72:75], v[100:103], v[56:63], v18
    v_smfmac_f32_16x16x64_bf16 v[76:79], v[100:103], v[64:71], v18
    v_smfmac_f32_16x16x64_bf16 v[84:87], v[100:103], a[112:119], v18
    s_waitcnt lgkmcnt(0)
    s_barrier
    ds_read_b128 v[104:107], v5 offset:0
    ds_read_b128 v[108:111], v5 offset:1024
    ds_read_b128 v[112:115], v6 offset:0
    v_smfmac_f32_16x16x64_bf16 v[92:95], v[96:99], a[168:175], v18
    ds_read_b128 v[116:119], v6 offset:1024
    v_smfmac_f32_16x16x64_bf16 v[88:91], v[100:103], a[176:183], v18
    ds_read_b128 v[120:123], v7 offset:0
    v_smfmac_f32_16x16x64_bf16 v[92:95], v[100:103], a[184:191], v18
    ds_read_b128 v[124:127], v7 offset:1024
    s_waitcnt lgkmcnt(5)
    v_smfmac_f32_16x16x64_bf16 v[72:75], v[104:107], a[0:7], v18
    ds_read_b128 v[56:59], v11 offset:40960
    s_waitcnt lgkmcnt(5)
    v_smfmac_f32_16x16x64_bf16 v[72:75], v[108:111], a[16:23], v18
    ds_read_b128 v[60:63], v11 offset:41984
    s_waitcnt lgkmcnt(5)
    v_smfmac_f32_16x16x64_bf16 v[72:75], v[112:115], a[32:39], v18
    ds_read_b128 v[64:67], v19 offset:0
    s_waitcnt lgkmcnt(5)
    v_smfmac_f32_16x16x64_bf16 v[72:75], v[116:119], a[48:55], v18
    ds_read_b128 v[68:71], v19 offset:1024
    s_waitcnt lgkmcnt(5)
    v_smfmac_f32_16x16x64_bf16 v[72:75], v[120:123], a[64:71], v18
    ds_read_b128 v[132:135], v11 offset:49152
    s_waitcnt lgkmcnt(5)
    v_smfmac_f32_16x16x64_bf16 v[72:75], v[124:127], a[80:87], v18
    ds_read_b128 v[136:139], v11 offset:50176
    s_waitcnt vmcnt(0)
    buffer_store_dwordx4 v[12:15], v1, s[4:7], s75 offen sc1
    v_smfmac_f32_16x16x64_bf16 v[76:79], v[104:107], a[8:15], v18
    v_smfmac_f32_16x16x64_bf16 v[76:79], v[108:111], a[24:31], v18
    v_smfmac_f32_16x16x64_bf16 v[76:79], v[112:115], a[40:47], v18
    v_smfmac_f32_16x16x64_bf16 v[76:79], v[116:119], a[56:63], v18
    ds_read_b128 v[96:99], v19 offset:8192
    buffer_load_dwordx4 v[40:43], v1, s[4:7], s67 offen offset:2048 sc1
    v_add_f32 v72, v72, v74
    v_smfmac_f32_16x16x64_bf16 v[76:79], v[120:123], a[72:79], v18
    ds_read_b128 v[100:103], v19 offset:9216
    v_add_f32 v73, v73, v75
    v_smfmac_f32_16x16x64_bf16 v[76:79], v[124:127], a[88:95], v18
    v_cvt_pk_bf16_f32 v74, v72, v73
    v_smfmac_f32_16x16x64_bf16 v[80:83], v[104:107], a[120:127], v18
    s_waitcnt lgkmcnt(6)
    v_smfmac_f32_16x16x64_bf16 v[84:87], v[104:107], v[56:63], v18
    ds_read_b128 v[56:59], v11 offset:57344
    buffer_load_dwordx4 v[44:47], v1, s[4:7], s67 offen offset:3072 sc1
    v_smfmac_f32_16x16x64_bf16 v[80:83], v[108:111], a[128:135], v18
    ds_read_b128 v[60:63], v11 offset:58368
    s_waitcnt lgkmcnt(6)
    v_smfmac_f32_16x16x64_bf16 v[84:87], v[108:111], v[64:71], v18
    ds_read_b128 v[64:67], v19 offset:16384
    v_add_f32 v76, v76, v78
    v_smfmac_f32_16x16x64_bf16 v[80:83], v[112:115], a[136:143], v18
    ds_read_b128 v[68:71], v19 offset:17408
    v_add_f32 v77, v77, v79
    s_waitcnt lgkmcnt(6)
    v_smfmac_f32_16x16x64_bf16 v[84:87], v[112:115], v[132:139], v18
    ds_read_b128 v[132:135], v19 offset:24576
    buffer_store_dword v8, v26, s[4:7], s76 offen sc1
    buffer_load_dword v0, v29, s[4:7], s68 offen sc1
    v_cvt_pk_bf16_f32 v75, v76, v77
    v_smfmac_f32_16x16x64_bf16 v[80:83], v[116:119], a[144:151], v18
    ds_read_b128 v[136:139], v19 offset:25600
    v_mfma_f32_16x16x16_bf16 v[76:79], v[74:75], v[28:29], 0
    v_mfma_f32_16x16x16_bf16 v[140:143], v[74:75], v[30:31], 0
    s_waitcnt lgkmcnt(6)
    v_smfmac_f32_16x16x64_bf16 v[84:87], v[116:119], v[96:103], v18
    ds_read_b128 v[96:99], v19 offset:32768
    v_smfmac_f32_16x16x64_bf16 v[80:83], v[120:123], a[152:159], v18
    ds_read_b128 v[100:103], v19 offset:33792
    s_waitcnt lgkmcnt(4)
    v_smfmac_f32_16x16x64_bf16 v[80:83], v[124:127], v[64:71], v18
    ds_read_b128 v[64:67], v19 offset:49152
    v_cvt_pk_bf16_f32 v72, v76, v77
    v_smfmac_f32_16x16x64_bf16 v[84:87], v[120:123], v[56:63], v18
    ds_read_b128 v[68:71], v19 offset:50176
    v_cvt_pk_bf16_f32 v73, v78, v79
    v_cvt_pk_bf16_f32 v74, v140, v141
    s_waitcnt lgkmcnt(4)
    v_smfmac_f32_16x16x64_bf16 v[84:87], v[124:127], v[132:139], v18
    ds_read_b128 v[56:59], v19 offset:40960
    v_cvt_pk_bf16_f32 v75, v142, v143
    ds_read_b128 v[60:63], v19 offset:41984
    v_add_f32 v80, v80, v82
    v_mfma_f32_16x16x32_bf16 v[76:79], v[48:51], v[72:75], 0
    v_add_f32 v81, v81, v83
    v_cvt_pk_bf16_f32 v82, v80, v81
    v_mfma_f32_16x16x32_bf16 v[140:143], v[52:55], v[72:75], 0
    v_add_f32 v84, v84, v86
    v_add_f32 v85, v85, v87
    v_cvt_pk_bf16_f32 v83, v84, v85
    s_nop 1
    v_mfma_f32_16x16x16_bf16 v[84:87], v[82:83], v[128:129], 0
    v_mfma_f32_16x16x16_bf16 v[132:135], v[82:83], v[130:131], 0
    v_cndmask_b32 v80, v140, v76, s[72:73]
    v_cndmask_b32 v81, v141, v77, s[72:73]
    v_cndmask_b32 v82, v142, v78, s[72:73]
    v_cndmask_b32 v83, v143, v79, s[72:73]
    v_cvt_pk_bf16_f32 v12, v84, v85
    v_cvt_pk_bf16_f32 v13, v86, v87
    s_nop 0
    v_cvt_pk_bf16_f32 v14, v132, v133
    v_cvt_pk_bf16_f32 v15, v134, v135
    s_nop 1
    v_mfma_f32_16x16x32_bf16 v[136:139], v[12:15], v[72:75], 0
    v_smfmac_f32_16x16x64_bf16 v[88:91], v[104:107], a[192:199], v18
    ds_write_b128 v4, v[80:83] offset:8192
    s_nop 2
    v_cndmask_b32 v136, v137, v136, s[72:73]
    v_smfmac_f32_16x16x64_bf16 v[92:95], v[104:107], a[200:207], v18
    ds_write_b32 v9, v136
    v_smfmac_f32_16x16x64_bf16 v[88:91], v[108:111], a[208:215], v18
    buffer_load_dwordx4 v[48:51], v1, s[4:7], s67 offen offset:0 sc1
    v_smfmac_f32_16x16x64_bf16 v[92:95], v[108:111], a[216:223], v18
    ds_read_b128 v[104:107], v19 offset:57344
    s_waitcnt lgkmcnt(7)
    v_smfmac_f32_16x16x64_bf16 v[88:91], v[120:123], v[96:103], v18
    ds_read_b128 v[108:111], v19 offset:58368
    s_waitcnt lgkmcnt(4)
    v_smfmac_f32_16x16x64_bf16 v[92:95], v[120:123], v[56:63], v18
    s_waitcnt lgkmcnt(2)
    s_barrier
    ds_read_b128 v[136:139], v5 offset:8192
    v_smfmac_f32_16x16x64_bf16 v[88:91], v[124:127], v[64:71], v18
    ds_read_b128 v[140:143], v6 offset:8192
    ds_read_b128 v[76:79], v7 offset:8192
    v_smfmac_f32_16x16x64_bf16 v[88:91], v[112:115], a[224:231], v18
    ds_read_b128 v[132:135], v8 offset:1024
    v_mov_b64 v[96:97], s[26:27]
    v_smfmac_f32_16x16x64_bf16 v[92:95], v[112:115], a[232:239], v18
    buffer_load_dwordx4 v[52:55], v1, s[4:7], s67 offen offset:1024 sc1
    v_mov_b64 v[98:99], s[26:27]
    v_smfmac_f32_16x16x64_bf16 v[88:91], v[116:119], a[240:247], v18
    v_mov_b64 v[100:101], s[8:9]
    s_waitcnt lgkmcnt(4)
    v_smfmac_f32_16x16x64_bf16 v[92:95], v[124:127], v[104:111], v18
    v_smfmac_f32_16x16x64_bf16 v[92:95], v[116:119], a[248:255], v18
    s_waitcnt lgkmcnt(3)
    v_add_f32 v80, v80, v136
    v_add_f32 v81, v81, v137
    v_add_f32 v82, v82, v138
    v_add_f32 v83, v83, v139
    s_waitcnt lgkmcnt(1)
    v_pk_add_f32 v[140:141], v[140:141], v[76:77]
    v_pk_add_f32 v[142:143], v[142:143], v[78:79]
    s_waitcnt lgkmcnt(0)
    v_pk_add_f32 v[132:133], v[132:133], v[134:135]
    v_pk_add_f32 v[80:81], v[80:81], v[140:141]
    v_pk_add_f32 v[82:83], v[82:83], v[142:143]
    v_add_f32 v132, v132, v133
    v_max3_f32 v134, v80, v81, v82
    v_max3_f32 v134, v134, v83, v132
    v_pk_add_f32 v[88:89], v[88:89], v[90:91]
    v_pk_add_f32 v[92:93], v[92:93], v[94:95]
    v_max_f32_dpp v135, v134, v134 quad_perm:[2,3,0,1] row_mask:0xf bank_mask:0xf
    v_max_f32_dpp v134, v134, v134 quad_perm:[2,3,0,1] row_mask:0xf bank_mask:0xf
    v_cvt_pk_bf16_f32 v90, v88, v89
    v_cvt_pk_bf16_f32 v91, v92, v93
    v_permlane16_swap_b32 v134, v135
    v_max_f32 v133, v134, v135
    v_max_f32 v134, v134, v135
    v_mfma_f32_16x16x16_bf16 v[92:95], v[24:25], v[90:91], 0
    ds_read_b128 v[56:59], v4 offset:16384
    v_permlane32_swap_b32 v134, v133
    v_max_f32 v134, v134, v133
    v_mul_f32 v134, s74, v134
    v_fma_f32 v80, v80, s74, -v134
    v_fma_f32 v81, v81, s74, -v134
    v_fma_f32 v82, v82, s74, -v134
    v_fma_f32 v83, v83, s74, -v134
    v_fma_f32 v132, v132, s74, -v134
    v_exp_f32 v80, v80
    v_exp_f32 v81, v81
    v_exp_f32 v82, v82
    v_exp_f32 v83, v83
    v_exp_f32 v132, v132
    v_cvt_pk_bf16_f32 v140, v80, v81
    v_cvt_pk_bf16_f32 v141, v82, v83
    v_cndmask_b32 v72, 0, v140, s[72:73]
    v_cndmask_b32 v73, 0, v141, s[72:73]
    v_cndmask_b32 v74, v140, 0, s[72:73]
    v_cndmask_b32 v75, v141, 0, s[72:73]
    v_mov_b32_dpp v133, v132 quad_perm:[2,3,0,1] row_mask:0xf bank_mask:0xf
    v_cvt_pk_bf16_f32 v16, v92, v93
    v_mfma_f32_16x16x32_bf16 v[140:143], v[96:99], v[72:75], 0
    ds_read_b128 v[60:63], v4 offset:17408
    v_cvt_pk_bf16_f32 v136, v132, v133
    v_cvt_pk_bf16_f32 v137, v133, v132
    v_mfma_f32_16x16x32_bf16 v[84:87], v[36:39], v[72:75], 0
    ds_read_b128 v[64:67], v4 offset:24576
    v_cndmask_b32 v138, 0, v136, s[72:73]
    v_cndmask_b32 v139, v137, 0, s[72:73]
    v_mfma_f32_16x16x32_bf16 v[76:79], v[32:35], v[72:75], 0
    ds_read_b128 v[68:71], v4 offset:25600
    v_cvt_pk_bf16_f32 v17, v94, v95
    v_mfma_f32_16x16x16_bf16 v[140:143], v[100:101], v[138:139], v[140:143]
    v_mov_b64 v[112:113], 0
    v_mfma_f32_16x16x16_bf16 v[76:79], v[16:17], v[138:139], v[76:79]
    v_mov_b64 v[114:115], 0
    v_mov_b64 v[116:117], 0
    v_mov_b64 v[118:119], 0
    v_mov_b64 v[120:121], 0
    v_mov_b64 v[122:123], 0
    v_add_f32_dpp v141, v140, v140 quad_perm:[2,3,0,1] row_mask:0xf bank_mask:0xf
    v_rcp_f32 v141, v141
    v_add_f32_dpp v76, v84, v76 quad_perm:[2,3,0,1] row_mask:0xf bank_mask:0xf
    v_add_f32_dpp v77, v85, v77 quad_perm:[2,3,0,1] row_mask:0xf bank_mask:0xf
    v_add_f32_dpp v78, v86, v78 quad_perm:[2,3,0,1] row_mask:0xf bank_mask:0xf
    v_add_f32_dpp v79, v87, v79 quad_perm:[2,3,0,1] row_mask:0xf bank_mask:0xf
    v_pk_mul_f32 v[76:77], v[76:77], v[140:141] op_sel:[0,1] op_sel_hi:[1,1]
    v_pk_mul_f32 v[78:79], v[78:79], v[140:141] op_sel:[0,1] op_sel_hi:[1,1]
    v_cvt_pk_bf16_f32 v132, v76, v77
    v_cvt_pk_bf16_f32 v133, v78, v79
    v_and_or_b32 v132, v132, -2, s24
    ds_write_b64 v10, v[132:133]
    s_nop 2
    v_mov_b64 v[124:125], 0
    v_mov_b64 v[126:127], 0
    s_nop 3
    ds_read_b128 v[80:83], v27 offset:0
    ds_read_b128 v[84:87], v27 offset:512
    ds_read_b128 v[88:91], v27 offset:2048
    ds_read_b128 v[92:95], v27 offset:2560
    v_mfma_f32_16x16x16_bf16 v[96:99], v[28:29], v[28:29], v[96:99]
    v_mfma_f32_16x16x16_bf16 v[96:99], v[28:29], v[28:29], v[96:99]
L_wo_s:
    s_waitcnt lgkmcnt(3)
    v_smfmac_f32_16x16x64_bf16 v[112:115], v[80:83], v[56:63], v18
    v_bitop3_b32 v134, v80, v82, s25 bitop3:0x42
    v_smfmac_f32_16x16x64_bf16 v[116:119], v[80:83], v[64:71], v18
    s_waitcnt lgkmcnt(2)
    v_bitop3_b32 v135, v84, v86, s25 bitop3:0x42
    v_smfmac_f32_16x16x64_bf16 v[112:115], v[84:87], v[144:151], v18
    s_waitcnt lgkmcnt(1)
    v_bitop3_b32 v136, v88, v90, s25 bitop3:0x42
    v_smfmac_f32_16x16x64_bf16 v[116:119], v[84:87], v[168:175], v18
    s_waitcnt lgkmcnt(0)
    v_bitop3_b32 v137, v92, v94, s25 bitop3:0x42
    v_smfmac_f32_16x16x64_bf16 v[112:115], v[88:91], v[152:159], v18
    v_bitop3_b32 v134, v134, v135, v136 bitop3:0x80
    v_smfmac_f32_16x16x64_bf16 v[116:119], v[88:91], v[176:183], v18
    v_bitop3_b32 v134, v134, v137, 1 bitop3:0x80
    v_smfmac_f32_16x16x64_bf16 v[112:115], v[92:95], v[160:167], v18
    v_cmp_eq_u32 vcc, 0, v134
    v_smfmac_f32_16x16x64_bf16 v[116:119], v[92:95], v[184:191], v18
    v_smfmac_f32_16x16x64_bf16 v[120:123], v[80:83], v[192:199], v18
    s_cbranch_vccnz L_ofix_s
    v_smfmac_f32_16x16x64_bf16 v[124:127], v[80:83], v[224:231], v18
    s_nop 1
    v_mov_b32 v1, v1
    v_cvt_pk_bf16_f32 v72, v112, v113
    v_cvt_pk_bf16_f32 v73, v114, v115
    v_smfmac_f32_16x16x64_bf16 v[120:123], v[84:87], v[200:207], v18
    v_cvt_pk_bf16_f32 v74, v116, v117
    v_cvt_pk_bf16_f32 v75, v118, v119
    v_smfmac_f32_16x16x64_bf16 v[124:127], v[84:87], v[232:239], v18
    v_and_or_b32 v72, v72, -2, s78
    buffer_store_dwordx4 v[72:75], v2, s[4:7], s64 offen sc1
    v_smfmac_f32_16x16x64_bf16 v[120:123], v[88:91], v[208:215], v18
    v_smfmac_f32_16x16x64_bf16 v[124:127], v[88:91], v[240:247], v18
    v_smfmac_f32_16x16x64_bf16 v[120:123], v[92:95], v[216:223], v18
    v_smfmac_f32_16x16x64_bf16 v[124:127], v[92:95], v[248:255], v18
    s_nop 3
    v_cvt_pk_bf16_f32 v76, v120, v121
    v_cvt_pk_bf16_f32 v77, v122, v123
    v_and_or_b32 v76, v76, -2, s78
    s_nop 0
    v_cvt_pk_bf16_f32 v78, v124, v125
    v_cvt_pk_bf16_f32 v79, v126, v127
    buffer_store_dwordx4 v[76:79], v2, s[4:7], s65 offen sc1
    s_mov_b64 vcc, s[72:73]
    v_cndmask_b32_dpp v12, v16, v12, vcc quad_perm:[0,0,0,2] row_mask:0xf bank_mask:0xf
    v_cndmask_b32_dpp v13, v17, v13, vcc quad_perm:[0,0,0,2] row_mask:0xf bank_mask:0xf
    v_cndmask_b32_dpp v14, v16, v14, vcc quad_perm:[0,0,1,3] row_mask:0xf bank_mask:0xf
    v_cndmask_b32_dpp v15, v17, v15, vcc quad_perm:[0,0,1,3] row_mask:0xf bank_mask:0xf
    s_add_u32 s61, s61, 1
    s_xor_b32 s64, s64, 0x40000
    s_and_b32 s75, s61, 3
    s_lshl_b32 s75, s75, 13
    s_andn2_b32 s63, s63, 0x6000
    s_andn2_b32 s62, s62, 0x6000
    s_or_b32 s62, s62, s75
    s_xor_b32 s71, s75, 0x4000
    s_or_b32 s71, s71, s63
    s_or_b32 s63, s63, s75
    ds_read_b128 v[120:123], v11 offset:24576
    v_mov_b64 v[72:73], 0
    ds_read_b128 v[124:127], v11 offset:25600
    v_mov_b64 v[74:75], 0
    ds_read_b128 v[112:115], v11 offset:16384
    v_mov_b64 v[76:77], 0
    ds_read_b128 v[116:119], v11 offset:17408
    v_mov_b64 v[78:79], 0
    ds_read_b128 v[56:59], v11 offset:8192
    v_mov_b64 v[80:81], 0
    ds_read_b128 v[60:63], v11 offset:9216
    v_mov_b64 v[82:83], 0
    ds_read_b128 v[64:67], v11 offset:0
    v_mov_b64 v[84:85], 0
    ds_read_b128 v[68:71], v11 offset:1024
    v_mov_b64 v[86:87], 0
    ds_read_b128 v[132:135], v11 offset:32768
    v_mov_b64 v[88:89], 0
    buffer_load_dwordx4 v[104:107], v1, s[4:7], s66 offen sc1
    buffer_load_dwordx4 v[108:111], v1, s[4:7], s66 offen offset:1024 sc1
    ds_read_b128 v[136:139], v11 offset:33792
    v_mov_b64 v[90:91], 0
    v_mov_b64 v[92:93], 0
    v_mov_b64 v[94:95], 0
    v_mov_b32 v96, -1
    s_waitcnt lgkmcnt(0)
    v_mov_b64 v[140:141], 0
    v_mov_b64 v[142:143], 0
    v_mfma_f32_16x16x16_bf16 v[36:39], v[28:29], v[28:29], v[36:39]
    v_mfma_f32_16x16x16_bf16 v[36:39], v[28:29], v[28:29], v[36:39]
    v_mfma_f32_16x16x16_bf16 v[36:39], v[28:29], v[28:29], v[36:39]
    v_mfma_f32_16x16x16_bf16 v[36:39], v[28:29], v[28:29], v[36:39]
    v_mfma_f32_16x16x16_bf16 v[36:39], v[28:29], v[28:29], v[36:39]
    buffer_load_dwordx4 v[104:107], v1, s[4:7], s66 offen sc1
    buffer_load_dwordx4 v[108:111], v1, s[4:7], s66 offen offset:1024 sc1
    s_mov_b32 s23, s60
    s_branch L_pw_As
L_poll_As:
    s_sub_u32 s23, s23, 1
    s_cbranch_scc1 L_pto_As
    buffer_load_dwordx4 v[104:107], v1, s[4:7], s66 offen sc1
    buffer_load_dwordx4 v[108:111], v1, s[4:7], s66 offen offset:1024 sc1
    s_nop 1
    v_mov_b32 v1, v1
    v_mov_b64 v[140:141], 0
    v_mov_b64 v[142:143], 0
L_pw_As:
    s_waitcnt vmcnt(2)
    v_bitop3_b32 v32, v104, v108, s79 bitop3:0x42
    v_and_b32 v32, 1, v32
    v_cmp_eq_u32 vcc, 0, v32
    v_smfmac_f32_16x16x64_bf16 v[140:143], v[20:23], v[104:111], v18 abid:1
    s_cbranch_vccnz L_poll_As
L_pok_As:
    s_nop 1
    v_mov_b32 v1, v1
    s_nop 1
    v_mov_b32 v1, v1
    s_nop 0
    v_add_f32_dpp v140, v140, v140 row_ror:8 row_mask:0xf bank_mask:0x3
    v_add_f32_dpp v141, v141, v141 row_ror:8 row_mask:0xf bank_mask:0x3
    v_add_f32_dpp v140, v142, v142 row_ror:8 row_mask:0xf bank_mask:0xc
    v_add_f32_dpp v141, v143, v143 row_ror:8 row_mask:0xf bank_mask:0xc
    s_nop 0
    v_add_f32_dpp v140, v140, v140 row_ror:12 row_mask:0xf bank_mask:0xf
    v_add_f32_dpp v141, v141, v141 row_ror:12 row_mask:0xf bank_mask:0xf
    v_cvt_pk_bf16_f32 v142, v140, v141
    buffer_store_dword v142, v3, s[4:7], s63 offen sc1
    buffer_store_dword v96, v3, s[4:7], s71 offen sc1
    s_branch L_Rloop_s
L_kvspin_s:
    s_mov_b32 s23, s60
L_sf_17:
    buffer_load_dword v0, v29, s[4:7], s68 offen sc1
    s_waitcnt vmcnt(0)
    v_cmp_ne_u32 vcc, 0, v0
    s_cbranch_vccnz L_sfok_18
    s_sleep 2
    s_sub_u32 s23, s23, 1
    s_cbranch_scc0 L_sf_17
    s_mov_b32 s60, 0x400
L_sfok_18:
    s_branch L_kvback_s
L_pto_As:
    s_mov_b32 s60, 0x400
    s_waitcnt vmcnt(0)
    s_nop 7
    v_mov_b64 v[140:141], 0
    v_mov_b64 v[142:143], 0
    s_nop 1
    v_smfmac_f32_16x16x64_bf16 v[140:143], v[20:23], v[104:111], v18 abid:1
    s_nop 7
    s_branch L_pok_As
L_poll_Bs:
    s_sub_u32 s23, s23, 1
    s_cbranch_scc1 L_pto_Bs
    buffer_load_dwordx4 v[96:99], v1, s[4:7], s62 offen offset:0 sc1
    buffer_load_dwordx4 v[100:103], v1, s[4:7], s62 offen offset:1024 sc1
    s_nop 2
    v_mov_b64 v[72:73], 0
    v_mov_b64 v[74:75], 0
    s_branch L_pw_Bs
L_pto_Bs:
    s_mov_b32 s60, 0x400
    s_branch L_pok_Bs
L_pol1_Bs:
    s_waitcnt vmcnt(0)
    v_max3_u32 v140, v100, v101, v102
    v_max_u32 v140, v140, v103
    v_cmp_eq_u32 vcc, -1, v140
    s_cbranch_vccz L_pk1_Bs
    s_sub_u32 s23, s23, 1
    s_cbranch_scc1 L_pt1_Bs
    buffer_load_dwordx4 v[100:103], v1, s[4:7], s62 offen offset:1024 sc1
    s_branch L_pol1_Bs
L_pt1_Bs:
    s_mov_b32 s60, 0x400
    s_branch L_pk1_Bs
L_ofix_s:
    s_mov_b32 s23, s60
L_ofix2_s:
    ds_read_b128 v[80:83], v27 offset:0
    ds_read_b128 v[84:87], v27 offset:512
    ds_read_b128 v[88:91], v27 offset:2048
    ds_read_b128 v[92:95], v27 offset:2560
    s_waitcnt lgkmcnt(0)
    v_bitop3_b32 v134, v80, v82, s25 bitop3:0x42
    v_bitop3_b32 v135, v84, v86, s25 bitop3:0x42
    v_bitop3_b32 v136, v88, v90, s25 bitop3:0x42
    v_bitop3_b32 v137, v92, v94, s25 bitop3:0x42
    v_bitop3_b32 v134, v134, v135, v136 bitop3:0x80
    v_bitop3_b32 v134, v134, v137, 1 bitop3:0x80
    v_cmp_eq_u32 vcc, 0, v134
    s_cbranch_vccz L_ofix3_s
    s_sub_u32 s23, s23, 1
    s_cbranch_scc0 L_ofix2_s
    s_endpgm
L_ofix3_s:
    v_mov_b64 v[112:113], 0
    v_mov_b64 v[114:115], 0
    v_mov_b64 v[116:117], 0
    v_mov_b64 v[118:119], 0
    v_mov_b64 v[120:121], 0
    v_mov_b64 v[122:123], 0
    v_mov_b64 v[124:125], 0
    v_mov_b64 v[126:127], 0
    s_branch L_wo_s
L_Rlast_s:
    ds_read_b128 v[56:59], v11 offset:40960
    ds_read_b128 v[60:63], v11 offset:41984
    v_smfmac_f32_16x16x64_bf16 v[84:87], v[100:103], a[112:119], v18
    ds_read_b128 v[64:67], v19 offset:0
    ds_read_b128 v[68:71], v19 offset:1024
    v_smfmac_f32_16x16x64_bf16 v[92:95], v[96:99], a[168:175], v18
    ds_read_b128 v[132:135], v11 offset:49152
    ds_read_b128 v[136:139], v11 offset:50176
    v_smfmac_f32_16x16x64_bf16 v[88:91], v[100:103], a[176:183], v18
    v_smfmac_f32_16x16x64_bf16 v[92:95], v[100:103], a[184:191], v18
    s_waitcnt lgkmcnt(6)
    s_barrier
    ds_read_b128 v[104:107], v5 offset:0
    ds_read_b128 v[108:111], v5 offset:1024
    ds_read_b128 v[112:115], v6 offset:0
    ds_read_b128 v[116:119], v6 offset:1024
    ds_read_b128 v[120:123], v7 offset:0
    ds_read_b128 v[124:127], v7 offset:1024
    s_waitcnt vmcnt(0)
    buffer_store_dwordx4 v[12:15], v1, s[4:7], s75 offen sc1
    buffer_store_dword v8, v26, s[4:7], s76 offen sc1
    ds_read_b128 v[96:99], v19 offset:8192
    ds_read_b128 v[100:103], v19 offset:9216
    s_waitcnt lgkmcnt(7)
    v_smfmac_f32_16x16x64_bf16 v[80:83], v[104:107], a[120:127], v18
    v_smfmac_f32_16x16x64_bf16 v[84:87], v[104:107], v[56:63], v18
    ds_read_b128 v[56:59], v11 offset:57344
    ds_read_b128 v[60:63], v11 offset:58368
    s_waitcnt lgkmcnt(8)
    v_smfmac_f32_16x16x64_bf16 v[80:83], v[108:111], a[128:135], v18
    v_smfmac_f32_16x16x64_bf16 v[84:87], v[108:111], v[64:71], v18
    ds_read_b128 v[64:67], v19 offset:16384
    ds_read_b128 v[68:71], v19 offset:17408
    s_waitcnt lgkmcnt(9)
    v_smfmac_f32_16x16x64_bf16 v[80:83], v[112:115], a[136:143], v18
    v_smfmac_f32_16x16x64_bf16 v[84:87], v[112:115], v[132:139], v18
    ds_read_b128 v[132:135], v19 offset:24576
    ds_read_b128 v[136:139], v19 offset:25600
    s_waitcnt lgkmcnt(10)
    v_smfmac_f32_16x16x64_bf16 v[80:83], v[116:119], a[144:151], v18
    s_waitcnt lgkmcnt(6)
    v_smfmac_f32_16x16x64_bf16 v[84:87], v[116:119], v[96:103], v18
    ds_read_b128 v[96:99], v19 offset:32768
    ds_read_b128 v[100:103], v19 offset:33792
    v_smfmac_f32_16x16x64_bf16 v[80:83], v[120:123], a[152:159], v18
    s_waitcnt lgkmcnt(6)
    v_smfmac_f32_16x16x64_bf16 v[84:87], v[120:123], v[56:63], v18
    ds_read_b128 v[56:59], v19 offset:40960
    ds_read_b128 v[60:63], v19 offset:41984
    v_smfmac_f32_16x16x64_bf16 v[88:91], v[104:107], a[192:199], v18
    s_waitcnt lgkmcnt(6)
    v_smfmac_f32_16x16x64_bf16 v[80:83], v[124:127], v[64:71], v18
    ds_read_b128 v[64:67], v19 offset:49152
    ds_read_b128 v[68:71], v19 offset:50176
    v_smfmac_f32_16x16x64_bf16 v[92:95], v[104:107], a[200:207], v18
    s_waitcnt lgkmcnt(6)
    v_smfmac_f32_16x16x64_bf16 v[84:87], v[124:127], v[132:139], v18
    ds_read_b128 v[132:135], v19 offset:57344
    ds_read_b128 v[136:139], v19 offset:58368
    v_smfmac_f32_16x16x64_bf16 v[88:91], v[108:111], a[208:215], v18
    s_waitcnt lgkmcnt(6)
    v_smfmac_f32_16x16x64_bf16 v[88:91], v[120:123], v[96:103], v18
    v_smfmac_f32_16x16x64_bf16 v[92:95], v[108:111], a[216:223], v18
    s_waitcnt lgkmcnt(4)
    v_smfmac_f32_16x16x64_bf16 v[92:95], v[120:123], v[56:63], v18
    v_smfmac_f32_16x16x64_bf16 v[88:91], v[112:115], a[224:231], v18
    s_waitcnt lgkmcnt(2)
    v_smfmac_f32_16x16x64_bf16 v[88:91], v[124:127], v[64:71], v18
    v_smfmac_f32_16x16x64_bf16 v[92:95], v[112:115], a[232:239], v18
    s_waitcnt lgkmcnt(0)
    v_smfmac_f32_16x16x64_bf16 v[92:95], v[124:127], v[132:139], v18
    v_smfmac_f32_16x16x64_bf16 v[88:91], v[116:119], a[240:247], v18
    v_smfmac_f32_16x16x64_bf16 v[92:95], v[116:119], a[248:255], v18
    v_add_f32 v80, v80, v82
    v_add_f32 v81, v81, v83
    v_add_f32 v84, v84, v86
    v_add_f32 v85, v85, v87
    v_cvt_pk_bf16_f32 v82, v80, v81
    v_cvt_pk_bf16_f32 v83, v84, v85
    s_nop 0
    v_add_f32 v88, v88, v90
    v_add_f32 v89, v89, v91
    v_add_f32 v92, v92, v94
    v_add_f32 v93, v93, v95
    v_cvt_pk_bf16_f32 v90, v88, v89
    v_cvt_pk_bf16_f32 v91, v92, v93
    v_mfma_f32_16x16x16_bf16 v[84:87], v[82:83], v[128:129], 0
    v_mfma_f32_16x16x16_bf16 v[132:135], v[82:83], v[130:131], 0
    v_mfma_f32_16x16x16_bf16 v[92:95], v[24:25], v[90:91], 0
    s_nop 5
    v_cvt_pk_bf16_f32 v12, v84, v85
    v_cvt_pk_bf16_f32 v13, v86, v87
    v_cvt_pk_bf16_f32 v14, v132, v133
    v_cvt_pk_bf16_f32 v15, v134, v135
    v_cvt_pk_bf16_f32 v16, v92, v93
    v_cvt_pk_bf16_f32 v17, v94, v95
L_Rtail_s:
    s_mov_b64 vcc, s[72:73]
    v_cndmask_b32_dpp v12, v16, v12, vcc quad_perm:[0,0,0,2] row_mask:0xf bank_mask:0xf
    v_cndmask_b32_dpp v13, v17, v13, vcc quad_perm:[0,0,0,2] row_mask:0xf bank_mask:0xf
    v_cndmask_b32_dpp v14, v16, v14, vcc quad_perm:[0,0,1,3] row_mask:0xf bank_mask:0xf
    v_cndmask_b32_dpp v15, v17, v15, vcc quad_perm:[0,0,1,3] row_mask:0xf bank_mask:0xf
    buffer_store_dwordx4 v[12:15], v1, s[4:7], s69 offen sc1
    s_waitcnt vmcnt(0) lgkmcnt(0)
    buffer_store_dword v8, v26, s[4:7], s70 offen sc1
    buffer_store_dword v8, v26, s[4:7], s70 offen offset:2048 sc1
    s_endpgm
L_worker:
    s_cmp_lg_u32 s16, 1
    s_cbranch_scc1 L_w_go
    s_cmp_eq_u32 s19, 1
    s_cbranch_scc1 L_cf_19
    v_mov_b32 v62, 163808
    s_cmp_lg_u32 s18, 0
    s_cbranch_scc1 L_cfs_20
    s_waitcnt vmcnt(5)
    v_readfirstlane_b32 s21, v63
    s_nop 1
    v_mov_b32 v63, s21
    ds_write_b32 v62, v63
    s_waitcnt lgkmcnt(0)
L_cfs_20:
    s_barrier
    ds_read_b32 v61, v62
    s_waitcnt lgkmcnt(0)
    v_readfirstlane_b32 s21, v61
    s_mov_b32 s19, 1
    s_and_b32 s22, s21, s28
    s_cbranch_scc1 L_reclaim
L_cf_19:
    v_mov_b32 v20, 0
    v_mov_b32 v21, 0
    s_waitcnt vmcnt(2)
    v_dot2c_f32_bf16 v20, v8, v16
    v_dot2c_f32_bf16 v21, v12, v16
    v_dot2c_f32_bf16 v20, v9, v17
    v_dot2c_f32_bf16 v21, v13, v17
    v_dot2c_f32_bf16 v20, v10, v18
    v_dot2c_f32_bf16 v21, v14, v18
    v_dot2c_f32_bf16 v20, v11, v19
    v_dot2c_f32_bf16 v21, v15, v19
    s_nop 2
    v_permlane32_swap_b32 v20, v21
    v_add_f32 v20, v20, v21
    v_mov_b32 v21, v20
    s_nop 1
    v_permlane16_swap_b32 v20, v21
    v_add_f32 v20, v20, v21
    s_nop 1
    v_add_f32_dpp v20, v20, v20 row_ror:8 row_mask:0xf bank_mask:0xf
    s_nop 1
    v_add_f32_dpp v20, v20, v20 row_ror:4 row_mask:0xf bank_mask:0xf
    s_nop 1
    v_add_f32_dpp v20, v20, v20 row_ror:2 row_mask:0xf bank_mask:0xf
    s_nop 1
    v_add_f32_dpp v20, v20, v20 row_ror:1 row_mask:0xf bank_mask:0xf
    v_mul_f32 v20, 0xbfb8aa3b, v20
    v_exp_f32 v20, v20
    s_nop 0
    v_add_f32 v20, 1.0, v20
    v_rcp_f32 v20, v20
    v_and_b32 v21, 63, v0
    v_lshrrev_b32 v22, 5, v21
    v_lshlrev_b32 v22, 2, v22
    v_and_b32 v21, 31, v21
    v_cmp_ne_u32 vcc, 0, v21
    v_mov_b32 v23, 0x40000000
    s_nop 0
    v_cndmask_b32 v22, v22, v23, vcc
    s_lshl_b32 s22, s2, 5
    s_lshl_b32 s23, s18, 3
    s_add_u32 s22, s22, s23
    s_add_u32 s22, s22, 0x4200000
    buffer_store_dword v20, v22, s[4:7], s22 offen sc1
    s_waitcnt vmcnt(0)
    s_mov_b32 s12, s56
    s_mov_b32 s13, s57
    s_mov_b32 s14, 0x100
    s_mov_b32 s15, 0x20000
    s_barrier
    s_cmp_lg_u32 s18, 0
    s_cbranch_scc1 L_sig_21
    s_and_b32 s21, s2, 3
    s_lshl_b32 s21, s21, 6
    s_add_u32 s21, s21, 60
    v_mov_b32 v20, s21
    v_mov_b32 v21, 1
    v_mov_b32 v22, 0x40000000
    v_and_b32 v23, 63, v0
    v_cmp_ne_u32 vcc, 0, v23
    s_nop 1
    v_cndmask_b32 v20, v20, v22, vcc
    buffer_atomic_add v21, v20, s[12:15], 0 offen
L_sig_21:
    s_endpgm
L_w_go:
    s_sub_u32 s21, s16, 2
    s_lshl_b32 s21, s21, 5
    s_add_u32 s21, s21, s17
    s_cmp_ge_u32 s21, 160
    s_cselect_b32 s61, 1, 0
    s_cbranch_scc1 L_w_B
    s_mul_i32 s72, s21, 52429
    s_lshr_b32 s72, s72, 18
    s_mul_i32 s22, s72, 5
    s_sub_u32 s62, s21, s22
    s_mov_b32 s63, 64
    s_mov_b32 s64, 5
    s_mov_b32 s73, 0
    s_movk_i32 s66, 8192
    s_mov_b32 s75, 4194304
    s_branch L_w_dec
L_w_B:
    s_sub_u32 s21, s21, 160
    s_lshr_b32 s72, s21, 3
    s_and_b32 s21, s21, 7
    s_lshl_b32 s73, s21, 3
    s_add_u32 s63, s73, 8
    s_max_u32 s62, s73, 1
    s_sub_u32 s62, s62, 1
    s_mov_b32 s64, 1
    s_movk_i32 s66, 3072
    s_mov_b32 s75, 1572864
L_w_dec:
    v_and_b32 v1, 63, v0
    v_lshrrev_b32 v2, 4, v1
    v_and_b32 v3, 15, v1
    v_lshlrev_b32 v3, 4, v3
    s_lshl_b32 s79, s66, 4
    v_mul_lo_u32 v2, v2, s79
    v_add_u32 v28, v2, v3
    s_mul_i32 s78, s18, 16896
    s_lshl_b32 s77, s72, 8
    s_lshl_b32 s79, s66, 6
    s_cmp_eq_u32 s61, 1
    s_cselect_b32 s8, s48, s38
    s_cselect_b32 s9, s49, s39
    s_mov_b32 s10, s75
    s_mov_b32 s11, 0x20000
    s_cselect_b32 s76, 1024, 0
    s_add_u32 s76, s76, s77
    s_add_u32 m0, s78, 0
    s_add_u32 s21, s18, 0
    s_mul_i32 s21, s21, s79
    s_add_u32 s21, s21, s76
    buffer_load_dwordx4 v28, s[8:11], s21 offen lds
    s_add_u32 m0, m0, 1056
    s_add_u32 s21, s21, s66
    buffer_load_dwordx4 v28, s[8:11], s21 offen lds
    s_add_u32 m0, m0, 1056
    s_add_u32 s21, s21, s66
    buffer_load_dwordx4 v28, s[8:11], s21 offen lds
    s_add_u32 m0, m0, 1056
    s_add_u32 s21, s21, s66
    buffer_load_dwordx4 v28, s[8:11], s21 offen lds
    s_add_u32 m0, m0, 1056
    s_add_u32 s21, s21, s66
    buffer_load_dwordx4 v28, s[8:11], s21 offen lds
    s_add_u32 m0, m0, 1056
    s_add_u32 s21, s21, s66
    buffer_load_dwordx4 v28, s[8:11], s21 offen lds
    s_add_u32 m0, m0, 1056
    s_add_u32 s21, s21, s66
    buffer_load_dwordx4 v28, s[8:11], s21 offen lds
    s_add_u32 m0, m0, 1056
    s_add_u32 s21, s21, s66
    buffer_load_dwordx4 v28, s[8:11], s21 offen lds
    s_add_u32 m0, m0, 1056
    s_add_u32 s21, s21, s66
    buffer_load_dwordx4 v28, s[8:11], s21 offen lds
    s_add_u32 m0, m0, 1056
    s_add_u32 s21, s21, s66
    buffer_load_dwordx4 v28, s[8:11], s21 offen lds
    s_add_u32 m0, m0, 1056
    s_add_u32 s21, s21, s66
    buffer_load_dwordx4 v28, s[8:11], s21 offen lds
    s_add_u32 m0, m0, 1056
    s_add_u32 s21, s21, s66
    buffer_load_dwordx4 v28, s[8:11], s21 offen lds
    s_add_u32 m0, m0, 1056
    s_add_u32 s21, s21, s66
    buffer_load_dwordx4 v28, s[8:11], s21 offen lds
    s_add_u32 m0, m0, 1056
    s_add_u32 s21, s21, s66
    buffer_load_dwordx4 v28, s[8:11], s21 offen lds
    s_add_u32 m0, m0, 1056
    s_add_u32 s21, s21, s66
    buffer_load_dwordx4 v28, s[8:11], s21 offen lds
    s_add_u32 m0, m0, 1056
    s_add_u32 s21, s21, s66
    buffer_load_dwordx4 v28, s[8:11], s21 offen lds
    s_getpc_b64 s[12:13]
L_pc_22:
    s_add_u32 s12, s12, T_W-L_pc_22
    s_addc_u32 s13, s13, 0
    s_mov_b32 s14, 24576
    s_mov_b32 s15, 0x20000
    v_mul_u32_u24 v7, 96, v0
    buffer_load_dwordx4 v[96:99], v7, s[12:15], 0 offen offset:0
    buffer_load_dwordx4 v[100:103], v7, s[12:15], 0 offen offset:16
    buffer_load_dwordx4 v[104:107], v7, s[12:15], 0 offen offset:32
    buffer_load_dwordx4 v[108:111], v7, s[12:15], 0 offen offset:48
    buffer_load_dwordx4 v[112:115], v7, s[12:15], 0 offen offset:64
    buffer_load_dwordx4 v[116:119], v7, s[12:15], 0 offen offset:80
    s_cmp_eq_u32 s19, 1
    s_cbranch_scc1 L_cf_23
    v_mov_b32 v62, 163808
    s_cmp_lg_u32 s18, 0
    s_cbranch_scc1 L_cfs_24
    s_waitcnt vmcnt(27)
    v_readfirstlane_b32 s21, v63
    s_nop 1
    v_mov_b32 v63, s21
    ds_write_b32 v62, v63
    s_waitcnt lgkmcnt(0)
L_cfs_24:
    s_barrier
    ds_read_b32 v61, v62
    s_waitcnt lgkmcnt(0)
    v_readfirstlane_b32 s21, v61
    s_mov_b32 s19, 1
    s_and_b32 s22, s21, s28
    s_cbranch_scc1 L_reclaim
L_cf_23:
    s_sub_u32 s21, s16, 2
    s_lshl_b32 s21, s21, 5
    s_add_u32 s21, s21, s17
    s_lshl_b32 s21, s21, 2
    s_add_u32 s21, s21, s18
    s_mul_i32 s21, s21, 6144
    s_mov_b32 s24, s36
    s_mov_b32 s25, s37
    s_mov_b32 s26, 0x400000
    s_mov_b32 s27, 0x20000
    v_lshlrev_b32 v29, 4, v1
    buffer_load_dwordx4 v[32:35], v29, s[24:27], s21 offen
    s_add_u32 s21, s21, 1024
    s_waitcnt vmcnt(0)
    buffer_load_dwordx4 v[32:35], v29, s[24:27], s21 offen
    s_add_u32 s21, s21, 1024
    s_waitcnt vmcnt(0)
    buffer_load_dwordx4 v[32:35], v29, s[24:27], s21 offen
    s_add_u32 s21, s21, 1024
    s_waitcnt vmcnt(0)
    buffer_load_dwordx4 v[32:35], v29, s[24:27], s21 offen
    s_add_u32 s21, s21, 1024
    s_waitcnt vmcnt(0)
    buffer_load_dwordx4 v[32:35], v29, s[24:27], s21 offen
    s_add_u32 s21, s21, 1024
    s_waitcnt vmcnt(0)
    buffer_load_dwordx4 v[32:35], v29, s[24:27], s21 offen
    s_add_u32 s21, s21, 1024
    s_add_u32 m0, s78, 67584
    s_add_u32 s21, s18, 4
    s_mul_i32 s21, s21, s79
    s_add_u32 s21, s21, s76
    buffer_load_dwordx4 v28, s[8:11], s21 offen lds
    s_add_u32 m0, m0, 1056
    s_add_u32 s21, s21, s66
    buffer_load_dwordx4 v28, s[8:11], s21 offen lds
    s_add_u32 m0, m0, 1056
    s_add_u32 s21, s21, s66
    buffer_load_dwordx4 v28, s[8:11], s21 offen lds
    s_add_u32 m0, m0, 1056
    s_add_u32 s21, s21, s66
    buffer_load_dwordx4 v28, s[8:11], s21 offen lds
    s_add_u32 m0, m0, 1056
    s_add_u32 s21, s21, s66
    buffer_load_dwordx4 v28, s[8:11], s21 offen lds
    s_add_u32 m0, m0, 1056
    s_add_u32 s21, s21, s66
    buffer_load_dwordx4 v28, s[8:11], s21 offen lds
    s_add_u32 m0, m0, 1056
    s_add_u32 s21, s21, s66
    buffer_load_dwordx4 v28, s[8:11], s21 offen lds
    s_add_u32 m0, m0, 1056
    s_add_u32 s21, s21, s66
    buffer_load_dwordx4 v28, s[8:11], s21 offen lds
    s_add_u32 m0, m0, 1056
    s_add_u32 s21, s21, s66
    buffer_load_dwordx4 v28, s[8:11], s21 offen lds
    s_add_u32 m0, m0, 1056
    s_add_u32 s21, s21, s66
    buffer_load_dwordx4 v28, s[8:11], s21 offen lds
    s_add_u32 m0, m0, 1056
    s_add_u32 s21, s21, s66
    buffer_load_dwordx4 v28, s[8:11], s21 offen lds
    s_add_u32 m0, m0, 1056
    s_add_u32 s21, s21, s66
    buffer_load_dwordx4 v28, s[8:11], s21 offen lds
    s_add_u32 m0, m0, 1056
    s_add_u32 s21, s21, s66
    buffer_load_dwordx4 v28, s[8:11], s21 offen lds
    s_add_u32 m0, m0, 1056
    s_add_u32 s21, s21, s66
    buffer_load_dwordx4 v28, s[8:11], s21 offen lds
    s_add_u32 m0, m0, 1056
    s_add_u32 s21, s21, s66
    buffer_load_dwordx4 v28, s[8:11], s21 offen lds
    s_add_u32 m0, m0, 1056
    s_add_u32 s21, s21, s66
    buffer_load_dwordx4 v28, s[8:11], s21 offen lds
    v_mov_b32 v20, 0
    v_mov_b32 v21, 0
    v_dot2c_f32_bf16 v20, v8, v16
    v_dot2c_f32_bf16 v21, v12, v16
    v_dot2c_f32_bf16 v20, v9, v17
    v_dot2c_f32_bf16 v21, v13, v17
    v_dot2c_f32_bf16 v20, v10, v18
    v_dot2c_f32_bf16 v21, v14, v18
    v_dot2c_f32_bf16 v20, v11, v19
    v_dot2c_f32_bf16 v21, v15, v19
    s_nop 2
    v_permlane32_swap_b32 v20, v21
    v_add_f32 v20, v20, v21
    v_mov_b32 v21, v20
    s_nop 1
    v_permlane16_swap_b32 v20, v21
    v_add_f32 v20, v20, v21
    s_nop 1
    v_add_f32_dpp v20, v20, v20 row_ror:8 row_mask:0xf bank_mask:0xf
    s_nop 1
    v_add_f32_dpp v20, v20, v20 row_ror:4 row_mask:0xf bank_mask:0xf
    s_nop 1
    v_add_f32_dpp v20, v20, v20 row_ror:2 row_mask:0xf bank_mask:0xf
    s_nop 1
    v_add_f32_dpp v20, v20, v20 row_ror:1 row_mask:0xf bank_mask:0xf
    v_mul_f32 v20, 0xbfb8aa3b, v20
    v_exp_f32 v20, v20
    s_nop 0
    v_add_f32 v20, 1.0, v20
    v_rcp_f32 v20, v20
    v_and_b32 v21, 63, v0
    v_lshrrev_b32 v22, 5, v21
    v_lshlrev_b32 v22, 2, v22
    v_and_b32 v21, 31, v21
    v_cmp_ne_u32 vcc, 0, v21
    v_mov_b32 v23, 0x40000000
    s_nop 0
    v_cndmask_b32 v22, v22, v23, vcc
    s_lshl_b32 s22, s2, 5
    s_lshl_b32 s23, s18, 3
    s_add_u32 s22, s22, s23
    s_add_u32 s22, s22, 0x4200000
    buffer_store_dword v20, v22, s[4:7], s22 offen sc1
    v_mov_b32 v24, v0
    v_mov_b32 v0, v96
    v_mov_b32 v1, v97
    v_mov_b32 v2, v98
    v_mov_b32 v3, v99
    v_mov_b32 v4, v100
    v_mov_b32 v5, v101
    v_mov_b32 v6, v102
    v_mov_b32 v7, v103
    v_mov_b32 v8, v104
    v_mov_b32 v9, v105
    v_mov_b32 v10, v106
    v_mov_b32 v11, v107
    v_mov_b32 v12, v108
    v_mov_b32 v13, v109
    v_mov_b32 v14, v110
    v_mov_b32 v15, v111
    v_mov_b32 v16, v112
    v_mov_b32 v17, v113
    v_mov_b32 v18, v114
    v_mov_b32 v19, v115
    v_mov_b32 v20, v116
    v_mov_b32 v21, v117
    v_mov_b32 v22, v118
    v_mov_b32 v23, v119
    v_add_u32 v29, 67584, v2
    s_lshl_b32 s74, s62, 5
    s_add_u32 s74, s74, s72
    s_lshl_b32 s74, s74, 6
    s_lshl_b32 s21, s18, 2
    s_add_u32 s74, s74, s21
    s_add_u32 s74, s74, 0x4210000
    s_cmp_lt_u32 s62, 2
    s_cselect_b32 s74, s74, 0x40000000
    s_cmp_eq_u32 s61, 1
    s_cselect_b32 s74, 0x40000000, s74
    buffer_load_dword v30, v1, s[4:7], s74 offen sc1
    s_mov_b32 s24, s32
    s_mov_b32 s25, s33
    s_mov_b32 s26, 0x200000
    s_mov_b32 s27, 0x20000
    s_mov_b32 s67, 0
    s_mov_b32 s70, s62
    s_waitcnt vmcnt(18)
    s_barrier
    ds_read_b64_tr_b16 a[128:129], v2 offset:0
    ds_read_b64_tr_b16 a[130:131], v2 offset:4224
    ds_read_b64_tr_b16 a[132:133], v2 offset:512
    ds_read_b64_tr_b16 a[134:135], v2 offset:4736
    ds_read_b64_tr_b16 a[136:137], v2 offset:32
    ds_read_b64_tr_b16 a[138:139], v2 offset:4256
    ds_read_b64_tr_b16 a[140:141], v2 offset:544
    ds_read_b64_tr_b16 a[142:143], v2 offset:4768
    ds_read_b64_tr_b16 a[144:145], v2 offset:16896
    ds_read_b64_tr_b16 a[146:147], v2 offset:21120
    ds_read_b64_tr_b16 a[148:149], v2 offset:17408
    ds_read_b64_tr_b16 a[150:151], v2 offset:21632
    ds_read_b64_tr_b16 a[152:153], v2 offset:16928
    ds_read_b64_tr_b16 a[154:155], v2 offset:21152
    ds_read_b64_tr_b16 a[156:157], v2 offset:17440
    ds_read_b64_tr_b16 a[158:159], v2 offset:21664
    ds_read_b64_tr_b16 a[160:161], v2 offset:33792
    ds_read_b64_tr_b16 a[162:163], v2 offset:38016
    ds_read_b64_tr_b16 a[164:165], v2 offset:34304
    ds_read_b64_tr_b16 a[166:167], v2 offset:38528
    ds_read_b64_tr_b16 a[168:169], v2 offset:33824
    ds_read_b64_tr_b16 a[170:171], v2 offset:38048
    ds_read_b64_tr_b16 a[172:173], v2 offset:34336
    ds_read_b64_tr_b16 a[174:175], v2 offset:38560
    ds_read_b64_tr_b16 a[176:177], v2 offset:50688
    ds_read_b64_tr_b16 a[178:179], v2 offset:54912
    ds_read_b64_tr_b16 a[180:181], v2 offset:51200
    ds_read_b64_tr_b16 a[182:183], v2 offset:55424
    ds_read_b64_tr_b16 a[184:185], v2 offset:50720
    ds_read_b64_tr_b16 a[186:187], v2 offset:54944
    ds_read_b64_tr_b16 a[188:189], v2 offset:51232
    ds_read_b64_tr_b16 a[190:191], v2 offset:55456
    s_waitcnt lgkmcnt(0)
    s_barrier
    s_cmp_eq_u32 s61, 1
    s_cselect_b32 s8, s48, s40
    s_cselect_b32 s9, s49, s41
    s_mov_b32 s10, s75
    s_mov_b32 s11, 0x20000
    s_cselect_b32 s76, 2048, 0
    s_add_u32 s76, s76, s77
    s_add_u32 m0, s78, 0
    s_add_u32 s21, s18, 0
    s_mul_i32 s21, s21, s79
    s_add_u32 s21, s21, s76
    buffer_load_dwordx4 v28, s[8:11], s21 offen lds
    s_add_u32 m0, m0, 1056
    s_add_u32 s21, s21, s66
    buffer_load_dwordx4 v28, s[8:11], s21 offen lds
    s_add_u32 m0, m0, 1056
    s_add_u32 s21, s21, s66
    buffer_load_dwordx4 v28, s[8:11], s21 offen lds
    s_add_u32 m0, m0, 1056
    s_add_u32 s21, s21, s66
    buffer_load_dwordx4 v28, s[8:11], s21 offen lds
    s_add_u32 m0, m0, 1056
    s_add_u32 s21, s21, s66
    buffer_load_dwordx4 v28, s[8:11], s21 offen lds
    s_add_u32 m0, m0, 1056
    s_add_u32 s21, s21, s66
    buffer_load_dwordx4 v28, s[8:11], s21 offen lds
    s_add_u32 m0, m0, 1056
    s_add_u32 s21, s21, s66
    buffer_load_dwordx4 v28, s[8:11], s21 offen lds
    s_add_u32 m0, m0, 1056
    s_add_u32 s21, s21, s66
    buffer_load_dwordx4 v28, s[8:11], s21 offen lds
    s_add_u32 m0, m0, 1056
    s_add_u32 s21, s21, s66
    buffer_load_dwordx4 v28, s[8:11], s21 offen lds
    s_add_u32 m0, m0, 1056
    s_add_u32 s21, s21, s66
    buffer_load_dwordx4 v28, s[8:11], s21 offen lds
    s_add_u32 m0, m0, 1056
    s_add_u32 s21, s21, s66
    buffer_load_dwordx4 v28, s[8:11], s21 offen lds
    s_add_u32 m0, m0, 1056
    s_add_u32 s21, s21, s66
    buffer_load_dwordx4 v28, s[8:11], s21 offen lds
    s_add_u32 m0, m0, 1056
    s_add_u32 s21, s21, s66
    buffer_load_dwordx4 v28, s[8:11], s21 offen lds
    s_add_u32 m0, m0, 1056
    s_add_u32 s21, s21, s66
    buffer_load_dwordx4 v28, s[8:11], s21 offen lds
    s_add_u32 m0, m0, 1056
    s_add_u32 s21, s21, s66
    buffer_load_dwordx4 v28, s[8:11], s21 offen lds
    s_add_u32 m0, m0, 1056
    s_add_u32 s21, s21, s66
    buffer_load_dwordx4 v28, s[8:11], s21 offen lds
    s_waitcnt vmcnt(17)
    s_barrier
    ds_read_b64_tr_b16 a[192:193], v29 offset:0
    ds_read_b64_tr_b16 a[194:195], v29 offset:4224
    ds_read_b64_tr_b16 a[196:197], v29 offset:512
    ds_read_b64_tr_b16 a[198:199], v29 offset:4736
    ds_read_b64_tr_b16 a[200:201], v29 offset:32
    ds_read_b64_tr_b16 a[202:203], v29 offset:4256
    ds_read_b64_tr_b16 a[204:205], v29 offset:544
    ds_read_b64_tr_b16 a[206:207], v29 offset:4768
    ds_read_b64_tr_b16 a[208:209], v29 offset:16896
    ds_read_b64_tr_b16 a[210:211], v29 offset:21120
    ds_read_b64_tr_b16 a[212:213], v29 offset:17408
    ds_read_b64_tr_b16 a[214:215], v29 offset:21632
    ds_read_b64_tr_b16 a[216:217], v29 offset:16928
    ds_read_b64_tr_b16 a[218:219], v29 offset:21152
    ds_read_b64_tr_b16 a[220:221], v29 offset:17440
    ds_read_b64_tr_b16 a[222:223], v29 offset:21664
    ds_read_b64_tr_b16 a[224:225], v29 offset:33792
    ds_read_b64_tr_b16 a[226:227], v29 offset:38016
    ds_read_b64_tr_b16 a[228:229], v29 offset:34304
    ds_read_b64_tr_b16 a[230:231], v29 offset:38528
    ds_read_b64_tr_b16 a[232:233], v29 offset:33824
    ds_read_b64_tr_b16 a[234:235], v29 offset:38048
    ds_read_b64_tr_b16 a[236:237], v29 offset:34336
    ds_read_b64_tr_b16 a[238:239], v29 offset:38560
    ds_read_b64_tr_b16 a[240:241], v29 offset:50688
    ds_read_b64_tr_b16 a[242:243], v29 offset:54912
    ds_read_b64_tr_b16 a[244:245], v29 offset:51200
    ds_read_b64_tr_b16 a[246:247], v29 offset:55424
    ds_read_b64_tr_b16 a[248:249], v29 offset:50720
    ds_read_b64_tr_b16 a[250:251], v29 offset:54944
    ds_read_b64_tr_b16 a[252:253], v29 offset:51232
    ds_read_b64_tr_b16 a[254:255], v29 offset:55456
    s_waitcnt lgkmcnt(0)
    s_barrier
    s_add_u32 m0, s78, 67584
    s_add_u32 s21, s18, 4
    s_mul_i32 s21, s21, s79
    s_add_u32 s21, s21, s76
    buffer_load_dwordx4 v28, s[8:11], s21 offen lds
    s_add_u32 m0, m0, 1056
    s_add_u32 s21, s21, s66
    buffer_load_dwordx4 v28, s[8:11], s21 offen lds
    s_add_u32 m0, m0, 1056
    s_add_u32 s21, s21, s66
    buffer_load_dwordx4 v28, s[8:11], s21 offen lds
    s_add_u32 m0, m0, 1056
    s_add_u32 s21, s21, s66
    buffer_load_dwordx4 v28, s[8:11], s21 offen lds
    s_add_u32 m0, m0, 1056
    s_add_u32 s21, s21, s66
    buffer_load_dwordx4 v28, s[8:11], s21 offen lds
    s_add_u32 m0, m0, 1056
    s_add_u32 s21, s21, s66
    buffer_load_dwordx4 v28, s[8:11], s21 offen lds
    s_add_u32 m0, m0, 1056
    s_add_u32 s21, s21, s66
    buffer_load_dwordx4 v28, s[8:11], s21 offen lds
    s_add_u32 m0, m0, 1056
    s_add_u32 s21, s21, s66
    buffer_load_dwordx4 v28, s[8:11], s21 offen lds
    s_add_u32 m0, m0, 1056
    s_add_u32 s21, s21, s66
    buffer_load_dwordx4 v28, s[8:11], s21 offen lds
    s_add_u32 m0, m0, 1056
    s_add_u32 s21, s21, s66
    buffer_load_dwordx4 v28, s[8:11], s21 offen lds
    s_add_u32 m0, m0, 1056
    s_add_u32 s21, s21, s66
    buffer_load_dwordx4 v28, s[8:11], s21 offen lds
    s_add_u32 m0, m0, 1056
    s_add_u32 s21, s21, s66
    buffer_load_dwordx4 v28, s[8:11], s21 offen lds
    s_add_u32 m0, m0, 1056
    s_add_u32 s21, s21, s66
    buffer_load_dwordx4 v28, s[8:11], s21 offen lds
    s_add_u32 m0, m0, 1056
    s_add_u32 s21, s21, s66
    buffer_load_dwordx4 v28, s[8:11], s21 offen lds
    s_add_u32 m0, m0, 1056
    s_add_u32 s21, s21, s66
    buffer_load_dwordx4 v28, s[8:11], s21 offen lds
    s_add_u32 m0, m0, 1056
    s_add_u32 s21, s21, s66
    buffer_load_dwordx4 v28, s[8:11], s21 offen lds
    s_mov_b32 s12, s56
    s_mov_b32 s13, s57
    s_mov_b32 s14, 0x100
    s_mov_b32 s15, 0x20000
    s_cmp_lg_u32 s18, 0
    s_cbranch_scc1 L_sig_25
    s_and_b32 s21, s2, 3
    s_lshl_b32 s21, s21, 6
    s_add_u32 s21, s21, 60
    v_mov_b32 v40, s21
    v_mov_b32 v41, 1
    v_mov_b32 v42, 0x40000000
    v_and_b32 v43, 63, v24
    v_cmp_ne_u32 vcc, 0, v43
    s_nop 1
    v_cndmask_b32 v40, v40, v42, vcc
    buffer_atomic_add v41, v40, s[12:15], 0 offen
L_sig_25:
    s_waitcnt vmcnt(16)
    s_barrier
    ds_read_b64_tr_b16 v[128:129], v2 offset:0
    ds_read_b64_tr_b16 v[130:131], v2 offset:4224
    ds_read_b64_tr_b16 v[132:133], v2 offset:512
    ds_read_b64_tr_b16 v[134:135], v2 offset:4736
    ds_read_b64_tr_b16 v[136:137], v2 offset:32
    ds_read_b64_tr_b16 v[138:139], v2 offset:4256
    ds_read_b64_tr_b16 v[140:141], v2 offset:544
    ds_read_b64_tr_b16 v[142:143], v2 offset:4768
    ds_read_b64_tr_b16 v[144:145], v2 offset:16896
    ds_read_b64_tr_b16 v[146:147], v2 offset:21120
    ds_read_b64_tr_b16 v[148:149], v2 offset:17408
    ds_read_b64_tr_b16 v[150:151], v2 offset:21632
    ds_read_b64_tr_b16 v[152:153], v2 offset:16928
    ds_read_b64_tr_b16 v[154:155], v2 offset:21152
    ds_read_b64_tr_b16 v[156:157], v2 offset:17440
    ds_read_b64_tr_b16 v[158:159], v2 offset:21664
    ds_read_b64_tr_b16 v[160:161], v2 offset:33792
    ds_read_b64_tr_b16 v[162:163], v2 offset:38016
    ds_read_b64_tr_b16 v[164:165], v2 offset:34304
    ds_read_b64_tr_b16 v[166:167], v2 offset:38528
    ds_read_b64_tr_b16 v[168:169], v2 offset:33824
    ds_read_b64_tr_b16 v[170:171], v2 offset:38048
    ds_read_b64_tr_b16 v[172:173], v2 offset:34336
    ds_read_b64_tr_b16 v[174:175], v2 offset:38560
    ds_read_b64_tr_b16 v[176:177], v2 offset:50688
    ds_read_b64_tr_b16 v[178:179], v2 offset:54912
    ds_read_b64_tr_b16 v[180:181], v2 offset:51200
    ds_read_b64_tr_b16 v[182:183], v2 offset:55424
    ds_read_b64_tr_b16 v[184:185], v2 offset:50720
    ds_read_b64_tr_b16 v[186:187], v2 offset:54944
    ds_read_b64_tr_b16 v[188:189], v2 offset:51232
    ds_read_b64_tr_b16 v[190:191], v2 offset:55456
    s_waitcnt lgkmcnt(0)
    s_barrier
    s_cmp_eq_u32 s61, 1
    s_cbranch_scc1 L_w_Bload
    s_lshl_b32 s21, s70, 15
    s_lshl_b32 s22, s18, 8
    s_add_u32 s21, s21, s22
    s_lshl_b32 s22, s18, 13
    s_add_u32 m0, s22, s67
    s_nop 0
    buffer_load_dwordx4 v3, s[24:27], s21 offen lds
    s_add_u32 m0, m0, 1024
    s_add_u32 s21, s21, 16384
    buffer_load_dwordx4 v3, s[24:27], s21 offen lds
    s_add_u32 m0, m0, 1024
    s_add_u32 s21, s21, 0xffffc040
    buffer_load_dwordx4 v3, s[24:27], s21 offen lds
    s_add_u32 m0, m0, 1024
    s_add_u32 s21, s21, 16384
    buffer_load_dwordx4 v3, s[24:27], s21 offen lds
    s_add_u32 m0, m0, 1024
    s_add_u32 s21, s21, 0xffffc040
    buffer_load_dwordx4 v3, s[24:27], s21 offen lds
    s_add_u32 m0, m0, 1024
    s_add_u32 s21, s21, 16384
    buffer_load_dwordx4 v3, s[24:27], s21 offen lds
    s_add_u32 m0, m0, 1024
    s_add_u32 s21, s21, 0xffffc040
    buffer_load_dwordx4 v3, s[24:27], s21 offen lds
    s_add_u32 m0, m0, 1024
    s_add_u32 s21, s21, 16384
    buffer_load_dwordx4 v3, s[24:27], s21 offen lds
    s_add_u32 m0, m0, 1024
    s_add_u32 s21, s21, 0xffffc040
    s_waitcnt vmcnt(8)
    s_barrier
    ds_read_b64_tr_b16 v[192:193], v29 offset:0
    ds_read_b64_tr_b16 v[194:195], v29 offset:4224
    ds_read_b64_tr_b16 v[196:197], v29 offset:512
    ds_read_b64_tr_b16 v[198:199], v29 offset:4736
    ds_read_b64_tr_b16 v[200:201], v29 offset:32
    ds_read_b64_tr_b16 v[202:203], v29 offset:4256
    ds_read_b64_tr_b16 v[204:205], v29 offset:544
    ds_read_b64_tr_b16 v[206:207], v29 offset:4768
    ds_read_b64_tr_b16 v[208:209], v29 offset:16896
    ds_read_b64_tr_b16 v[210:211], v29 offset:21120
    ds_read_b64_tr_b16 v[212:213], v29 offset:17408
    ds_read_b64_tr_b16 v[214:215], v29 offset:21632
    ds_read_b64_tr_b16 v[216:217], v29 offset:16928
    ds_read_b64_tr_b16 v[218:219], v29 offset:21152
    ds_read_b64_tr_b16 v[220:221], v29 offset:17440
    ds_read_b64_tr_b16 v[222:223], v29 offset:21664
    ds_read_b64_tr_b16 v[224:225], v29 offset:33792
    ds_read_b64_tr_b16 v[226:227], v29 offset:38016
    ds_read_b64_tr_b16 v[228:229], v29 offset:34304
    ds_read_b64_tr_b16 v[230:231], v29 offset:38528
    ds_read_b64_tr_b16 v[232:233], v29 offset:33824
    ds_read_b64_tr_b16 v[234:235], v29 offset:38048
    ds_read_b64_tr_b16 v[236:237], v29 offset:34336
    ds_read_b64_tr_b16 v[238:239], v29 offset:38560
    ds_read_b64_tr_b16 v[240:241], v29 offset:50688
    ds_read_b64_tr_b16 v[242:243], v29 offset:54912
    ds_read_b64_tr_b16 v[244:245], v29 offset:51200
    ds_read_b64_tr_b16 v[246:247], v29 offset:55424
    ds_read_b64_tr_b16 v[248:249], v29 offset:50720
    ds_read_b64_tr_b16 v[250:251], v29 offset:54944
    ds_read_b64_tr_b16 v[252:253], v29 offset:51232
    ds_read_b64_tr_b16 v[254:255], v29 offset:55456
    s_waitcnt lgkmcnt(0)
    s_barrier
    s_waitcnt vmcnt(0)
    s_mov_b32 s73, s62
    s_mov_b32 s68, 0x40000000
    v_mov_b32 v25, v12
L_P_kv:
    s_waitcnt vmcnt(5)
    s_barrier
    s_add_u32 s70, s62, s64
    s_min_u32 s70, s70, 63
    s_xor_b32 s67, s67, 32768
    s_lshl_b32 s21, s70, 15
    s_lshl_b32 s22, s18, 8
    s_add_u32 s21, s21, s22
    s_lshl_b32 s22, s18, 13
    s_add_u32 m0, s22, s67
    ds_read_b128 v[48:51], v25 offset:0
    ds_read_b128 v[52:55], v25 offset:1024
    ds_read_b128 v[56:59], v25 offset:2048
    ds_read_b128 v[60:63], v25 offset:3072
    s_waitcnt lgkmcnt(3)
    v_mfma_f32_16x16x32_bf16 v[80:83], a[128:131], v[48:51], 0
    buffer_load_dwordx4 v3, s[24:27], s21 offen lds
    s_add_u32 m0, m0, 1024
    s_add_u32 s21, s21, 16384
    s_waitcnt lgkmcnt(2)
    v_mfma_f32_16x16x32_bf16 v[84:87], a[128:131], v[52:55], 0
    v_mfma_f32_16x16x32_bf16 v[88:91], a[136:139], v[48:51], 0
    v_mfma_f32_16x16x32_bf16 v[92:95], a[136:139], v[52:55], 0
    v_mfma_f32_16x16x32_bf16 v[96:99], v[48:51], v[128:131], 0
    v_mfma_f32_16x16x32_bf16 v[100:103], v[52:55], v[128:131], 0
    v_mfma_f32_16x16x32_bf16 v[104:107], v[48:51], v[136:139], 0
    v_mfma_f32_16x16x32_bf16 v[108:111], v[52:55], v[136:139], 0
    ds_read_b128 v[48:51], v25 offset:4096
    ds_read_b128 v[52:55], v25 offset:5120
    s_waitcnt lgkmcnt(3)
    v_mfma_f32_16x16x32_bf16 v[80:83], a[132:135], v[56:59], v[80:83]
    buffer_load_dwordx4 v3, s[24:27], s21 offen lds
    s_add_u32 m0, m0, 1024
    s_add_u32 s21, s21, 0xffffc040
    s_waitcnt lgkmcnt(2)
    v_mfma_f32_16x16x32_bf16 v[84:87], a[132:135], v[60:63], v[84:87]
    v_mfma_f32_16x16x32_bf16 v[88:91], a[140:143], v[56:59], v[88:91]
    v_mfma_f32_16x16x32_bf16 v[92:95], a[140:143], v[60:63], v[92:95]
    v_mfma_f32_16x16x32_bf16 v[96:99], v[56:59], v[132:135], v[96:99]
    v_mfma_f32_16x16x32_bf16 v[100:103], v[60:63], v[132:135], v[100:103]
    v_mfma_f32_16x16x32_bf16 v[104:107], v[56:59], v[140:143], v[104:107]
    v_mfma_f32_16x16x32_bf16 v[108:111], v[60:63], v[140:143], v[108:111]
    ds_read_b128 v[56:59], v25 offset:6144
    ds_read_b128 v[60:63], v25 offset:7168
    s_waitcnt lgkmcnt(3)
    v_mfma_f32_16x16x32_bf16 v[80:83], a[144:147], v[48:51], v[80:83]
    buffer_load_dwordx4 v3, s[24:27], s21 offen lds
    s_add_u32 m0, m0, 1024
    s_add_u32 s21, s21, 16384
    s_waitcnt lgkmcnt(2)
    v_mfma_f32_16x16x32_bf16 v[84:87], a[144:147], v[52:55], v[84:87]
    v_mfma_f32_16x16x32_bf16 v[88:91], a[152:155], v[48:51], v[88:91]
    v_mfma_f32_16x16x32_bf16 v[92:95], a[152:155], v[52:55], v[92:95]
    v_mfma_f32_16x16x32_bf16 v[96:99], v[48:51], v[144:147], v[96:99]
    v_mfma_f32_16x16x32_bf16 v[100:103], v[52:55], v[144:147], v[100:103]
    v_mfma_f32_16x16x32_bf16 v[104:107], v[48:51], v[152:155], v[104:107]
    v_mfma_f32_16x16x32_bf16 v[108:111], v[52:55], v[152:155], v[108:111]
    ds_read_b128 v[48:51], v25 offset:8192
    ds_read_b128 v[52:55], v25 offset:9216
    s_waitcnt lgkmcnt(3)
    v_mfma_f32_16x16x32_bf16 v[80:83], a[148:151], v[56:59], v[80:83]
    buffer_load_dwordx4 v3, s[24:27], s21 offen lds
    s_add_u32 m0, m0, 1024
    s_add_u32 s21, s21, 0xffffc040
    s_waitcnt lgkmcnt(2)
    v_mfma_f32_16x16x32_bf16 v[84:87], a[148:151], v[60:63], v[84:87]
    v_mfma_f32_16x16x32_bf16 v[88:91], a[156:159], v[56:59], v[88:91]
    v_mfma_f32_16x16x32_bf16 v[92:95], a[156:159], v[60:63], v[92:95]
    v_mfma_f32_16x16x32_bf16 v[96:99], v[56:59], v[148:151], v[96:99]
    v_mfma_f32_16x16x32_bf16 v[100:103], v[60:63], v[148:151], v[100:103]
    v_mfma_f32_16x16x32_bf16 v[104:107], v[56:59], v[156:159], v[104:107]
    v_mfma_f32_16x16x32_bf16 v[108:111], v[60:63], v[156:159], v[108:111]
    ds_read_b128 v[56:59], v25 offset:10240
    ds_read_b128 v[60:63], v25 offset:11264
    s_waitcnt lgkmcnt(3)
    v_mfma_f32_16x16x32_bf16 v[80:83], a[160:163], v[48:51], v[80:83]
    buffer_load_dwordx4 v3, s[24:27], s21 offen lds
    s_add_u32 m0, m0, 1024
    s_add_u32 s21, s21, 16384
    s_waitcnt lgkmcnt(2)
    v_mfma_f32_16x16x32_bf16 v[84:87], a[160:163], v[52:55], v[84:87]
    v_mfma_f32_16x16x32_bf16 v[88:91], a[168:171], v[48:51], v[88:91]
    v_mfma_f32_16x16x32_bf16 v[92:95], a[168:171], v[52:55], v[92:95]
    v_mfma_f32_16x16x32_bf16 v[96:99], v[48:51], v[160:163], v[96:99]
    v_mfma_f32_16x16x32_bf16 v[100:103], v[52:55], v[160:163], v[100:103]
    v_mfma_f32_16x16x32_bf16 v[104:107], v[48:51], v[168:171], v[104:107]
    v_mfma_f32_16x16x32_bf16 v[108:111], v[52:55], v[168:171], v[108:111]
    ds_read_b128 v[48:51], v25 offset:12288
    ds_read_b128 v[52:55], v25 offset:13312
    s_waitcnt lgkmcnt(3)
    v_mfma_f32_16x16x32_bf16 v[80:83], a[164:167], v[56:59], v[80:83]
    buffer_load_dwordx4 v3, s[24:27], s21 offen lds
    s_add_u32 m0, m0, 1024
    s_add_u32 s21, s21, 0xffffc040
    s_waitcnt lgkmcnt(2)
    v_mfma_f32_16x16x32_bf16 v[84:87], a[164:167], v[60:63], v[84:87]
    v_mfma_f32_16x16x32_bf16 v[88:91], a[172:175], v[56:59], v[88:91]
    v_mfma_f32_16x16x32_bf16 v[92:95], a[172:175], v[60:63], v[92:95]
    v_mfma_f32_16x16x32_bf16 v[96:99], v[56:59], v[164:167], v[96:99]
    v_mfma_f32_16x16x32_bf16 v[100:103], v[60:63], v[164:167], v[100:103]
    v_mfma_f32_16x16x32_bf16 v[104:107], v[56:59], v[172:175], v[104:107]
    v_mfma_f32_16x16x32_bf16 v[108:111], v[60:63], v[172:175], v[108:111]
    ds_read_b128 v[56:59], v25 offset:14336
    ds_read_b128 v[60:63], v25 offset:15360
    s_waitcnt lgkmcnt(3)
    v_mfma_f32_16x16x32_bf16 v[80:83], a[176:179], v[48:51], v[80:83]
    buffer_load_dwordx4 v3, s[24:27], s21 offen lds
    s_add_u32 m0, m0, 1024
    s_add_u32 s21, s21, 16384
    s_waitcnt lgkmcnt(2)
    v_mfma_f32_16x16x32_bf16 v[84:87], a[176:179], v[52:55], v[84:87]
    v_mfma_f32_16x16x32_bf16 v[88:91], a[184:187], v[48:51], v[88:91]
    v_mfma_f32_16x16x32_bf16 v[92:95], a[184:187], v[52:55], v[92:95]
    v_mfma_f32_16x16x32_bf16 v[96:99], v[48:51], v[176:179], v[96:99]
    v_mfma_f32_16x16x32_bf16 v[100:103], v[52:55], v[176:179], v[100:103]
    v_mfma_f32_16x16x32_bf16 v[104:107], v[48:51], v[184:187], v[104:107]
    v_mfma_f32_16x16x32_bf16 v[108:111], v[52:55], v[184:187], v[108:111]
    ds_read_b128 v[48:51], v25 offset:16384
    ds_read_b128 v[52:55], v25 offset:17408
    s_waitcnt lgkmcnt(3)
    v_mfma_f32_16x16x32_bf16 v[80:83], a[180:183], v[56:59], v[80:83]
    buffer_load_dwordx4 v3, s[24:27], s21 offen lds
    s_add_u32 m0, m0, 1024
    s_add_u32 s21, s21, 0xffffc040
    s_waitcnt lgkmcnt(2)
    v_mfma_f32_16x16x32_bf16 v[84:87], a[180:183], v[60:63], v[84:87]
    v_mfma_f32_16x16x32_bf16 v[88:91], a[188:191], v[56:59], v[88:91]
    v_mfma_f32_16x16x32_bf16 v[92:95], a[188:191], v[60:63], v[92:95]
    v_mfma_f32_16x16x32_bf16 v[96:99], v[56:59], v[180:183], v[96:99]
    v_mfma_f32_16x16x32_bf16 v[100:103], v[60:63], v[180:183], v[100:103]
    v_mfma_f32_16x16x32_bf16 v[104:107], v[56:59], v[188:191], v[104:107]
    v_mfma_f32_16x16x32_bf16 v[108:111], v[60:63], v[188:191], v[108:111]
    ds_read_b128 v[56:59], v25 offset:18432
    ds_read_b128 v[60:63], v25 offset:19456
    s_waitcnt lgkmcnt(3)
    v_mfma_f32_16x16x32_bf16 v[80:83], a[192:195], v[48:51], v[80:83]
    s_waitcnt lgkmcnt(2)
    v_mfma_f32_16x16x32_bf16 v[84:87], a[192:195], v[52:55], v[84:87]
    v_mfma_f32_16x16x32_bf16 v[88:91], a[200:203], v[48:51], v[88:91]
    v_mfma_f32_16x16x32_bf16 v[92:95], a[200:203], v[52:55], v[92:95]
    v_mfma_f32_16x16x32_bf16 v[96:99], v[48:51], v[192:195], v[96:99]
    v_mfma_f32_16x16x32_bf16 v[100:103], v[52:55], v[192:195], v[100:103]
    v_mfma_f32_16x16x32_bf16 v[104:107], v[48:51], v[200:203], v[104:107]
    v_mfma_f32_16x16x32_bf16 v[108:111], v[52:55], v[200:203], v[108:111]
    ds_read_b128 v[48:51], v25 offset:20480
    ds_read_b128 v[52:55], v25 offset:21504
    s_waitcnt vmcnt(8)
    buffer_store_dword v21, v1, s[4:7], s68 offen sc1
    s_waitcnt lgkmcnt(3)
    v_mfma_f32_16x16x32_bf16 v[80:83], a[196:199], v[56:59], v[80:83]
    s_waitcnt lgkmcnt(2)
    v_mfma_f32_16x16x32_bf16 v[84:87], a[196:199], v[60:63], v[84:87]
    v_mfma_f32_16x16x32_bf16 v[88:91], a[204:207], v[56:59], v[88:91]
    v_mfma_f32_16x16x32_bf16 v[92:95], a[204:207], v[60:63], v[92:95]
    v_mfma_f32_16x16x32_bf16 v[96:99], v[56:59], v[196:199], v[96:99]
    v_mfma_f32_16x16x32_bf16 v[100:103], v[60:63], v[196:199], v[100:103]
    v_mfma_f32_16x16x32_bf16 v[104:107], v[56:59], v[204:207], v[104:107]
    v_mfma_f32_16x16x32_bf16 v[108:111], v[60:63], v[204:207], v[108:111]
    ds_read_b128 v[56:59], v25 offset:22528
    ds_read_b128 v[60:63], v25 offset:23552
    s_waitcnt lgkmcnt(3)
    v_mfma_f32_16x16x32_bf16 v[80:83], a[208:211], v[48:51], v[80:83]
    s_waitcnt lgkmcnt(2)
    v_mfma_f32_16x16x32_bf16 v[84:87], a[208:211], v[52:55], v[84:87]
    v_mfma_f32_16x16x32_bf16 v[88:91], a[216:219], v[48:51], v[88:91]
    v_mfma_f32_16x16x32_bf16 v[92:95], a[216:219], v[52:55], v[92:95]
    v_mfma_f32_16x16x32_bf16 v[96:99], v[48:51], v[208:211], v[96:99]
    v_mfma_f32_16x16x32_bf16 v[100:103], v[52:55], v[208:211], v[100:103]
    v_mfma_f32_16x16x32_bf16 v[104:107], v[48:51], v[216:219], v[104:107]
    v_mfma_f32_16x16x32_bf16 v[108:111], v[52:55], v[216:219], v[108:111]
    ds_read_b128 v[48:51], v25 offset:24576
    ds_read_b128 v[52:55], v25 offset:25600
    s_waitcnt lgkmcnt(3)
    v_mfma_f32_16x16x32_bf16 v[80:83], a[212:215], v[56:59], v[80:83]
    s_waitcnt lgkmcnt(2)
    v_mfma_f32_16x16x32_bf16 v[84:87], a[212:215], v[60:63], v[84:87]
    v_mfma_f32_16x16x32_bf16 v[88:91], a[220:223], v[56:59], v[88:91]
    v_mfma_f32_16x16x32_bf16 v[92:95], a[220:223], v[60:63], v[92:95]
    v_mfma_f32_16x16x32_bf16 v[96:99], v[56:59], v[212:215], v[96:99]
    v_mfma_f32_16x16x32_bf16 v[100:103], v[60:63], v[212:215], v[100:103]
    v_mfma_f32_16x16x32_bf16 v[104:107], v[56:59], v[220:223], v[104:107]
    v_mfma_f32_16x16x32_bf16 v[108:111], v[60:63], v[220:223], v[108:111]
    ds_read_b128 v[56:59], v25 offset:26624
    ds_read_b128 v[60:63], v25 offset:27648
    s_waitcnt lgkmcnt(3)
    v_mfma_f32_16x16x32_bf16 v[80:83], a[224:227], v[48:51], v[80:83]
    s_waitcnt lgkmcnt(2)
    v_mfma_f32_16x16x32_bf16 v[84:87], a[224:227], v[52:55], v[84:87]
    v_mfma_f32_16x16x32_bf16 v[88:91], a[232:235], v[48:51], v[88:91]
    v_mfma_f32_16x16x32_bf16 v[92:95], a[232:235], v[52:55], v[92:95]
    v_mfma_f32_16x16x32_bf16 v[96:99], v[48:51], v[224:227], v[96:99]
    v_mfma_f32_16x16x32_bf16 v[100:103], v[52:55], v[224:227], v[100:103]
    v_mfma_f32_16x16x32_bf16 v[104:107], v[48:51], v[232:235], v[104:107]
    v_mfma_f32_16x16x32_bf16 v[108:111], v[52:55], v[232:235], v[108:111]
    ds_read_b128 v[48:51], v25 offset:28672
    ds_read_b128 v[52:55], v25 offset:29696
    s_waitcnt lgkmcnt(3)
    v_mfma_f32_16x16x32_bf16 v[80:83], a[228:231], v[56:59], v[80:83]
    s_waitcnt lgkmcnt(2)
    v_mfma_f32_16x16x32_bf16 v[84:87], a[228:231], v[60:63], v[84:87]
    v_mfma_f32_16x16x32_bf16 v[88:91], a[236:239], v[56:59], v[88:91]
    v_mfma_f32_16x16x32_bf16 v[92:95], a[236:239], v[60:63], v[92:95]
    v_mfma_f32_16x16x32_bf16 v[96:99], v[56:59], v[228:231], v[96:99]
    v_mfma_f32_16x16x32_bf16 v[100:103], v[60:63], v[228:231], v[100:103]
    v_mfma_f32_16x16x32_bf16 v[104:107], v[56:59], v[236:239], v[104:107]
    v_mfma_f32_16x16x32_bf16 v[108:111], v[60:63], v[236:239], v[108:111]
    ds_read_b128 v[56:59], v25 offset:30720
    ds_read_b128 v[60:63], v25 offset:31744
    s_waitcnt lgkmcnt(3)
    v_mfma_f32_16x16x32_bf16 v[80:83], a[240:243], v[48:51], v[80:83]
    s_waitcnt lgkmcnt(2)
    v_mfma_f32_16x16x32_bf16 v[84:87], a[240:243], v[52:55], v[84:87]
    v_mfma_f32_16x16x32_bf16 v[88:91], a[248:251], v[48:51], v[88:91]
    v_mfma_f32_16x16x32_bf16 v[92:95], a[248:251], v[52:55], v[92:95]
    v_mfma_f32_16x16x32_bf16 v[96:99], v[48:51], v[240:243], v[96:99]
    v_mfma_f32_16x16x32_bf16 v[100:103], v[52:55], v[240:243], v[100:103]
    v_mfma_f32_16x16x32_bf16 v[104:107], v[48:51], v[248:251], v[104:107]
    v_mfma_f32_16x16x32_bf16 v[108:111], v[52:55], v[248:251], v[108:111]
    s_waitcnt lgkmcnt(1)
    v_mfma_f32_16x16x32_bf16 v[80:83], a[244:247], v[56:59], v[80:83]
    s_waitcnt lgkmcnt(0)
    v_mfma_f32_16x16x32_bf16 v[84:87], a[244:247], v[60:63], v[84:87]
    v_mfma_f32_16x16x32_bf16 v[88:91], a[252:255], v[56:59], v[88:91]
    v_mfma_f32_16x16x32_bf16 v[92:95], a[252:255], v[60:63], v[92:95]
    v_mfma_f32_16x16x32_bf16 v[96:99], v[56:59], v[244:247], v[96:99]
    v_mfma_f32_16x16x32_bf16 v[100:103], v[60:63], v[244:247], v[100:103]
    v_mfma_f32_16x16x32_bf16 v[104:107], v[56:59], v[252:255], v[104:107]
    v_mfma_f32_16x16x32_bf16 v[108:111], v[60:63], v[252:255], v[108:111]
    v_xor_b32 v25, 32768, v25
    s_lshl_b32 s21, s62, 5
    s_add_u32 s21, s21, s72
    s_lshl_b32 s68, s21, 6
    s_mul_i32 s21, s21, 24576
    s_mul_i32 s22, s18, 6144
    s_add_u32 s21, s21, s22
    s_add_u32 s21, s21, 0
    s_lshl_b32 s23, s18, 2
    s_add_u32 s68, s68, s23
    s_add_u32 s68, s68, 0x4300000
    v_cvt_pk_bf16_f32 v32, v80, v81
    v_cvt_pk_bf16_f32 v33, v82, v83
    v_cvt_pk_bf16_f32 v34, v88, v89
    v_cvt_pk_bf16_f32 v35, v90, v91
    buffer_store_dwordx4 v[32:35], v0, s[4:7], s21 offen offset:0 sc1
    v_cvt_pk_bf16_f32 v36, v84, v85
    v_cvt_pk_bf16_f32 v37, v86, v87
    v_cvt_pk_bf16_f32 v38, v92, v93
    v_cvt_pk_bf16_f32 v39, v94, v95
    buffer_store_dwordx4 v[36:39], v0, s[4:7], s21 offen offset:1024 sc1
    v_cvt_pk_bf16_f32 v40, v96, v97
    v_cvt_pk_bf16_f32 v41, v98, v99
    v_cvt_pk_bf16_f32 v42, v108, v109
    v_cvt_pk_bf16_f32 v43, v110, v111
    buffer_store_dwordx4 v[40:43], v0, s[4:7], s21 offen offset:2048 sc1
    v_cvt_pk_bf16_f32 v44, v104, v105
    v_cvt_pk_bf16_f32 v45, v106, v107
    v_cvt_pk_bf16_f32 v46, v100, v101
    v_cvt_pk_bf16_f32 v47, v102, v103
    buffer_store_dwordx4 v[44:47], v0, s[4:7], s21 offen offset:3072 sc1
    s_cmp_lg_u32 s62, s73
    s_cbranch_scc1 L_nf_26
    v_mov_b32 v52, 163824
    s_cmp_lg_u32 s18, 0
    s_cbranch_scc1 L_wz_27
    s_mov_b32 s12, s56
    s_mov_b32 s13, s57
    s_mov_b32 s14, 0x100
    s_mov_b32 s15, 0x20000
    v_and_b32 v48, 3, v24
    v_lshlrev_b32 v48, 6, v48
    v_add_u32 v48, 60, v48
    s_mul_i32 s21, s16, 24
    s_add_u32 s21, s21, 40
    s_cmp_eq_u32 s16, 0
    s_cselect_b32 s21, 0, s21
    v_and_b32 v50, 1, v24
    v_lshl_add_u32 v50, v50, 3, s21
    s_mov_b32 s23, s60
L_wi_28:
    buffer_load_dword v49, v48, s[12:15], 0 offen sc1
    buffer_load_dword v51, v50, s[12:15], 0 offen sc1
    s_waitcnt vmcnt(0)
    v_readlane_b32 s22, v51, 1
    v_readlane_b32 s84, v49, 0
    v_readlane_b32 s85, v49, 1
    v_readlane_b32 s86, v49, 2
    v_readlane_b32 s87, v49, 3
    v_readlane_b32 s21, v51, 0
    s_nop 1
    s_bcnt1_i32_b32 s21, s21
    s_add_u32 s21, s21, s22
    s_add_u32 s84, s84, s85
    s_add_u32 s86, s86, s87
    s_add_u32 s84, s84, s86
    s_cmp_ge_u32 s84, 256
    s_cbranch_scc1 L_wiok_29
    s_sleep 16
    s_sub_u32 s23, s23, 1
    s_cbranch_scc0 L_wi_28
L_wiok_29:
    v_mov_b32 v53, s21
    ds_write_b32 v52, v53
    s_waitcnt lgkmcnt(0)
L_wz_27:
    s_waitcnt vmcnt(0)
    s_barrier
    ds_read_b32 v53, v52
    s_waitcnt lgkmcnt(0)
    v_readfirstlane_b32 s21, v53
    s_nop 0
    s_cmp_ge_u32 s21, 32
    s_cselect_b32 s89, 1, 0
    v_add_u32 v30, 1, v30
    buffer_store_dword v30, v1, s[4:7], s74 offen sc1
    buffer_store_dword v21, v1, s[4:7], s68 offen sc1
L_nf_26:
    s_add_u32 s62, s62, s64
    s_cmp_lt_u32 s62, s63
    s_cbranch_scc1 L_P_kv
    s_waitcnt vmcnt(0)
    buffer_store_dword v21, v1, s[4:7], s68 offen sc1
    s_barrier
    s_cmp_eq_u32 s61, 1
    s_cselect_b32 s8, s48, s36
    s_cselect_b32 s9, s49, s37
    s_mov_b32 s10, s75
    s_mov_b32 s11, 0x20000
    s_cselect_b32 s76, 0, 0
    s_add_u32 s76, s76, s77
    s_add_u32 m0, s78, 0
    s_add_u32 s21, s18, 0
    s_mul_i32 s21, s21, s79
    s_add_u32 s21, s21, s76
    buffer_load_dwordx4 v28, s[8:11], s21 offen lds
    s_add_u32 m0, m0, 1056
    s_add_u32 s21, s21, s66
    buffer_load_dwordx4 v28, s[8:11], s21 offen lds
    s_add_u32 m0, m0, 1056
    s_add_u32 s21, s21, s66
    buffer_load_dwordx4 v28, s[8:11], s21 offen lds
    s_add_u32 m0, m0, 1056
    s_add_u32 s21, s21, s66
    buffer_load_dwordx4 v28, s[8:11], s21 offen lds
    s_add_u32 m0, m0, 1056
    s_add_u32 s21, s21, s66
    buffer_load_dwordx4 v28, s[8:11], s21 offen lds
    s_add_u32 m0, m0, 1056
    s_add_u32 s21, s21, s66
    buffer_load_dwordx4 v28, s[8:11], s21 offen lds
    s_add_u32 m0, m0, 1056
    s_add_u32 s21, s21, s66
    buffer_load_dwordx4 v28, s[8:11], s21 offen lds
    s_add_u32 m0, m0, 1056
    s_add_u32 s21, s21, s66
    buffer_load_dwordx4 v28, s[8:11], s21 offen lds
    s_add_u32 m0, m0, 1056
    s_add_u32 s21, s21, s66
    buffer_load_dwordx4 v28, s[8:11], s21 offen lds
    s_add_u32 m0, m0, 1056
    s_add_u32 s21, s21, s66
    buffer_load_dwordx4 v28, s[8:11], s21 offen lds
    s_add_u32 m0, m0, 1056
    s_add_u32 s21, s21, s66
    buffer_load_dwordx4 v28, s[8:11], s21 offen lds
    s_add_u32 m0, m0, 1056
    s_add_u32 s21, s21, s66
    buffer_load_dwordx4 v28, s[8:11], s21 offen lds
    s_add_u32 m0, m0, 1056
    s_add_u32 s21, s21, s66
    buffer_load_dwordx4 v28, s[8:11], s21 offen lds
    s_add_u32 m0, m0, 1056
    s_add_u32 s21, s21, s66
    buffer_load_dwordx4 v28, s[8:11], s21 offen lds
    s_add_u32 m0, m0, 1056
    s_add_u32 s21, s21, s66
    buffer_load_dwordx4 v28, s[8:11], s21 offen lds
    s_add_u32 m0, m0, 1056
    s_add_u32 s21, s21, s66
    buffer_load_dwordx4 v28, s[8:11], s21 offen lds
    s_add_u32 m0, s78, 67584
    s_add_u32 s21, s18, 4
    s_mul_i32 s21, s21, s79
    s_add_u32 s21, s21, s76
    buffer_load_dwordx4 v28, s[8:11], s21 offen lds
    s_add_u32 m0, m0, 1056
    s_add_u32 s21, s21, s66
    buffer_load_dwordx4 v28, s[8:11], s21 offen lds
    s_add_u32 m0, m0, 1056
    s_add_u32 s21, s21, s66
    buffer_load_dwordx4 v28, s[8:11], s21 offen lds
    s_add_u32 m0, m0, 1056
    s_add_u32 s21, s21, s66
    buffer_load_dwordx4 v28, s[8:11], s21 offen lds
    s_add_u32 m0, m0, 1056
    s_add_u32 s21, s21, s66
    buffer_load_dwordx4 v28, s[8:11], s21 offen lds
    s_add_u32 m0, m0, 1056
    s_add_u32 s21, s21, s66
    buffer_load_dwordx4 v28, s[8:11], s21 offen lds
    s_add_u32 m0, m0, 1056
    s_add_u32 s21, s21, s66
    buffer_load_dwordx4 v28, s[8:11], s21 offen lds
    s_add_u32 m0, m0, 1056
    s_add_u32 s21, s21, s66
    buffer_load_dwordx4 v28, s[8:11], s21 offen lds
    s_add_u32 m0, m0, 1056
    s_add_u32 s21, s21, s66
    buffer_load_dwordx4 v28, s[8:11], s21 offen lds
    s_add_u32 m0, m0, 1056
    s_add_u32 s21, s21, s66
    buffer_load_dwordx4 v28, s[8:11], s21 offen lds
    s_add_u32 m0, m0, 1056
    s_add_u32 s21, s21, s66
    buffer_load_dwordx4 v28, s[8:11], s21 offen lds
    s_add_u32 m0, m0, 1056
    s_add_u32 s21, s21, s66
    buffer_load_dwordx4 v28, s[8:11], s21 offen lds
    s_add_u32 m0, m0, 1056
    s_add_u32 s21, s21, s66
    buffer_load_dwordx4 v28, s[8:11], s21 offen lds
    s_add_u32 m0, m0, 1056
    s_add_u32 s21, s21, s66
    buffer_load_dwordx4 v28, s[8:11], s21 offen lds
    s_add_u32 m0, m0, 1056
    s_add_u32 s21, s21, s66
    buffer_load_dwordx4 v28, s[8:11], s21 offen lds
    s_add_u32 m0, m0, 1056
    s_add_u32 s21, s21, s66
    buffer_load_dwordx4 v28, s[8:11], s21 offen lds
    s_waitcnt vmcnt(16)
    s_barrier
    ds_read_b64_tr_b16 a[0:1], v2 offset:0
    ds_read_b64_tr_b16 a[2:3], v2 offset:4224
    ds_read_b64_tr_b16 a[4:5], v2 offset:512
    ds_read_b64_tr_b16 a[6:7], v2 offset:4736
    ds_read_b64_tr_b16 a[8:9], v2 offset:32
    ds_read_b64_tr_b16 a[10:11], v2 offset:4256
    ds_read_b64_tr_b16 a[12:13], v2 offset:544
    ds_read_b64_tr_b16 a[14:15], v2 offset:4768
    ds_read_b64_tr_b16 a[16:17], v2 offset:16896
    ds_read_b64_tr_b16 a[18:19], v2 offset:21120
    ds_read_b64_tr_b16 a[20:21], v2 offset:17408
    ds_read_b64_tr_b16 a[22:23], v2 offset:21632
    ds_read_b64_tr_b16 a[24:25], v2 offset:16928
    ds_read_b64_tr_b16 a[26:27], v2 offset:21152
    ds_read_b64_tr_b16 a[28:29], v2 offset:17440
    ds_read_b64_tr_b16 a[30:31], v2 offset:21664
    ds_read_b64_tr_b16 a[32:33], v2 offset:33792
    ds_read_b64_tr_b16 a[34:35], v2 offset:38016
    ds_read_b64_tr_b16 a[36:37], v2 offset:34304
    ds_read_b64_tr_b16 a[38:39], v2 offset:38528
    ds_read_b64_tr_b16 a[40:41], v2 offset:33824
    ds_read_b64_tr_b16 a[42:43], v2 offset:38048
    ds_read_b64_tr_b16 a[44:45], v2 offset:34336
    ds_read_b64_tr_b16 a[46:47], v2 offset:38560
    ds_read_b64_tr_b16 a[48:49], v2 offset:50688
    ds_read_b64_tr_b16 a[50:51], v2 offset:54912
    ds_read_b64_tr_b16 a[52:53], v2 offset:51200
    ds_read_b64_tr_b16 a[54:55], v2 offset:55424
    ds_read_b64_tr_b16 a[56:57], v2 offset:50720
    ds_read_b64_tr_b16 a[58:59], v2 offset:54944
    ds_read_b64_tr_b16 a[60:61], v2 offset:51232
    ds_read_b64_tr_b16 a[62:63], v2 offset:55456
    s_waitcnt lgkmcnt(0)
    s_barrier
    s_mov_b32 s62, s73
    s_mov_b32 s67, 0
    s_mov_b32 s70, s62
    s_lshl_b32 s21, s70, 15
    s_lshl_b32 s22, s18, 8
    s_add_u32 s21, s21, s22
    s_lshl_b32 s22, s18, 13
    s_add_u32 m0, s22, s67
    s_nop 0
    buffer_load_dwordx4 v3, s[24:27], s21 offen lds
    s_add_u32 m0, m0, 1024
    s_add_u32 s21, s21, 16384
    buffer_load_dwordx4 v3, s[24:27], s21 offen lds
    s_add_u32 m0, m0, 1024
    s_add_u32 s21, s21, 0xffffc040
    buffer_load_dwordx4 v3, s[24:27], s21 offen lds
    s_add_u32 m0, m0, 1024
    s_add_u32 s21, s21, 16384
    buffer_load_dwordx4 v3, s[24:27], s21 offen lds
    s_add_u32 m0, m0, 1024
    s_add_u32 s21, s21, 0xffffc040
    buffer_load_dwordx4 v3, s[24:27], s21 offen lds
    s_add_u32 m0, m0, 1024
    s_add_u32 s21, s21, 16384
    buffer_load_dwordx4 v3, s[24:27], s21 offen lds
    s_add_u32 m0, m0, 1024
    s_add_u32 s21, s21, 0xffffc040
    buffer_load_dwordx4 v3, s[24:27], s21 offen lds
    s_add_u32 m0, m0, 1024
    s_add_u32 s21, s21, 16384
    buffer_load_dwordx4 v3, s[24:27], s21 offen lds
    s_add_u32 m0, m0, 1024
    s_add_u32 s21, s21, 0xffffc040
    s_waitcnt vmcnt(8)
    s_barrier
    ds_read_b64_tr_b16 a[64:65], v29 offset:0
    ds_read_b64_tr_b16 a[66:67], v29 offset:4224
    ds_read_b64_tr_b16 a[68:69], v29 offset:512
    ds_read_b64_tr_b16 a[70:71], v29 offset:4736
    ds_read_b64_tr_b16 a[72:73], v29 offset:32
    ds_read_b64_tr_b16 a[74:75], v29 offset:4256
    ds_read_b64_tr_b16 a[76:77], v29 offset:544
    ds_read_b64_tr_b16 a[78:79], v29 offset:4768
    ds_read_b64_tr_b16 a[80:81], v29 offset:16896
    ds_read_b64_tr_b16 a[82:83], v29 offset:21120
    ds_read_b64_tr_b16 a[84:85], v29 offset:17408
    ds_read_b64_tr_b16 a[86:87], v29 offset:21632
    ds_read_b64_tr_b16 a[88:89], v29 offset:16928
    ds_read_b64_tr_b16 a[90:91], v29 offset:21152
    ds_read_b64_tr_b16 a[92:93], v29 offset:17440
    ds_read_b64_tr_b16 a[94:95], v29 offset:21664
    ds_read_b64_tr_b16 a[96:97], v29 offset:33792
    ds_read_b64_tr_b16 a[98:99], v29 offset:38016
    ds_read_b64_tr_b16 a[100:101], v29 offset:34304
    ds_read_b64_tr_b16 a[102:103], v29 offset:38528
    ds_read_b64_tr_b16 a[104:105], v29 offset:33824
    ds_read_b64_tr_b16 a[106:107], v29 offset:38048
    ds_read_b64_tr_b16 a[108:109], v29 offset:34336
    ds_read_b64_tr_b16 a[110:111], v29 offset:38560
    ds_read_b64_tr_b16 a[112:113], v29 offset:50688
    ds_read_b64_tr_b16 a[114:115], v29 offset:54912
    ds_read_b64_tr_b16 a[116:117], v29 offset:51200
    ds_read_b64_tr_b16 a[118:119], v29 offset:55424
    ds_read_b64_tr_b16 a[120:121], v29 offset:50720
    ds_read_b64_tr_b16 a[122:123], v29 offset:54944
    ds_read_b64_tr_b16 a[124:125], v29 offset:51232
    ds_read_b64_tr_b16 a[126:127], v29 offset:55456
    s_waitcnt lgkmcnt(0)
    s_barrier
    s_waitcnt vmcnt(0)
    s_mov_b32 s68, 0x40000000
    v_mov_b32 v25, v12
L_P_q:
    s_waitcnt vmcnt(3)
    s_barrier
    s_add_u32 s70, s62, s64
    s_min_u32 s70, s70, 63
    s_xor_b32 s67, s67, 32768
    s_lshl_b32 s21, s70, 15
    s_lshl_b32 s22, s18, 8
    s_add_u32 s21, s21, s22
    s_lshl_b32 s22, s18, 13
    s_add_u32 m0, s22, s67
    ds_read_b128 v[48:51], v25 offset:0
    ds_read_b128 v[52:55], v25 offset:1024
    ds_read_b128 v[56:59], v25 offset:2048
    ds_read_b128 v[60:63], v25 offset:3072
    s_waitcnt lgkmcnt(3)
    v_mfma_f32_16x16x32_bf16 v[64:67], a[0:3], v[48:51], 0
    buffer_load_dwordx4 v3, s[24:27], s21 offen lds
    s_add_u32 m0, m0, 1024
    s_add_u32 s21, s21, 16384
    s_waitcnt lgkmcnt(2)
    v_mfma_f32_16x16x32_bf16 v[68:71], a[0:3], v[52:55], 0
    v_mfma_f32_16x16x32_bf16 v[72:75], a[8:11], v[48:51], 0
    v_mfma_f32_16x16x32_bf16 v[76:79], a[8:11], v[52:55], 0
    ds_read_b128 v[48:51], v25 offset:4096
    ds_read_b128 v[52:55], v25 offset:5120
    s_waitcnt lgkmcnt(3)
    v_mfma_f32_16x16x32_bf16 v[64:67], a[4:7], v[56:59], v[64:67]
    buffer_load_dwordx4 v3, s[24:27], s21 offen lds
    s_add_u32 m0, m0, 1024
    s_add_u32 s21, s21, 0xffffc040
    s_waitcnt lgkmcnt(2)
    v_mfma_f32_16x16x32_bf16 v[68:71], a[4:7], v[60:63], v[68:71]
    v_mfma_f32_16x16x32_bf16 v[72:75], a[12:15], v[56:59], v[72:75]
    v_mfma_f32_16x16x32_bf16 v[76:79], a[12:15], v[60:63], v[76:79]
    ds_read_b128 v[56:59], v25 offset:6144
    ds_read_b128 v[60:63], v25 offset:7168
    s_waitcnt lgkmcnt(3)
    v_mfma_f32_16x16x32_bf16 v[64:67], a[16:19], v[48:51], v[64:67]
    buffer_load_dwordx4 v3, s[24:27], s21 offen lds
    s_add_u32 m0, m0, 1024
    s_add_u32 s21, s21, 16384
    s_waitcnt lgkmcnt(2)
    v_mfma_f32_16x16x32_bf16 v[68:71], a[16:19], v[52:55], v[68:71]
    v_mfma_f32_16x16x32_bf16 v[72:75], a[24:27], v[48:51], v[72:75]
    v_mfma_f32_16x16x32_bf16 v[76:79], a[24:27], v[52:55], v[76:79]
    ds_read_b128 v[48:51], v25 offset:8192
    ds_read_b128 v[52:55], v25 offset:9216
    s_waitcnt lgkmcnt(3)
    v_mfma_f32_16x16x32_bf16 v[64:67], a[20:23], v[56:59], v[64:67]
    buffer_load_dwordx4 v3, s[24:27], s21 offen lds
    s_add_u32 m0, m0, 1024
    s_add_u32 s21, s21, 0xffffc040
    s_waitcnt lgkmcnt(2)
    v_mfma_f32_16x16x32_bf16 v[68:71], a[20:23], v[60:63], v[68:71]
    v_mfma_f32_16x16x32_bf16 v[72:75], a[28:31], v[56:59], v[72:75]
    v_mfma_f32_16x16x32_bf16 v[76:79], a[28:31], v[60:63], v[76:79]
    ds_read_b128 v[56:59], v25 offset:10240
    ds_read_b128 v[60:63], v25 offset:11264
    s_waitcnt lgkmcnt(3)
    v_mfma_f32_16x16x32_bf16 v[64:67], a[32:35], v[48:51], v[64:67]
    buffer_load_dwordx4 v3, s[24:27], s21 offen lds
    s_add_u32 m0, m0, 1024
    s_add_u32 s21, s21, 16384
    s_waitcnt lgkmcnt(2)
    v_mfma_f32_16x16x32_bf16 v[68:71], a[32:35], v[52:55], v[68:71]
    v_mfma_f32_16x16x32_bf16 v[72:75], a[40:43], v[48:51], v[72:75]
    v_mfma_f32_16x16x32_bf16 v[76:79], a[40:43], v[52:55], v[76:79]
    ds_read_b128 v[48:51], v25 offset:12288
    ds_read_b128 v[52:55], v25 offset:13312
    s_waitcnt lgkmcnt(3)
    v_mfma_f32_16x16x32_bf16 v[64:67], a[36:39], v[56:59], v[64:67]
    buffer_load_dwordx4 v3, s[24:27], s21 offen lds
    s_add_u32 m0, m0, 1024
    s_add_u32 s21, s21, 0xffffc040
    s_waitcnt lgkmcnt(2)
    v_mfma_f32_16x16x32_bf16 v[68:71], a[36:39], v[60:63], v[68:71]
    v_mfma_f32_16x16x32_bf16 v[72:75], a[44:47], v[56:59], v[72:75]
    v_mfma_f32_16x16x32_bf16 v[76:79], a[44:47], v[60:63], v[76:79]
    ds_read_b128 v[56:59], v25 offset:14336
    ds_read_b128 v[60:63], v25 offset:15360
    s_waitcnt lgkmcnt(3)
    v_mfma_f32_16x16x32_bf16 v[64:67], a[48:51], v[48:51], v[64:67]
    buffer_load_dwordx4 v3, s[24:27], s21 offen lds
    s_add_u32 m0, m0, 1024
    s_add_u32 s21, s21, 16384
    s_waitcnt lgkmcnt(2)
    v_mfma_f32_16x16x32_bf16 v[68:71], a[48:51], v[52:55], v[68:71]
    v_mfma_f32_16x16x32_bf16 v[72:75], a[56:59], v[48:51], v[72:75]
    v_mfma_f32_16x16x32_bf16 v[76:79], a[56:59], v[52:55], v[76:79]
    ds_read_b128 v[48:51], v25 offset:16384
    ds_read_b128 v[52:55], v25 offset:17408
    s_waitcnt lgkmcnt(3)
    v_mfma_f32_16x16x32_bf16 v[64:67], a[52:55], v[56:59], v[64:67]
    buffer_load_dwordx4 v3, s[24:27], s21 offen lds
    s_add_u32 m0, m0, 1024
    s_add_u32 s21, s21, 0xffffc040
    s_waitcnt lgkmcnt(2)
    v_mfma_f32_16x16x32_bf16 v[68:71], a[52:55], v[60:63], v[68:71]
    v_mfma_f32_16x16x32_bf16 v[72:75], a[60:63], v[56:59], v[72:75]
    v_mfma_f32_16x16x32_bf16 v[76:79], a[60:63], v[60:63], v[76:79]
    ds_read_b128 v[56:59], v25 offset:18432
    ds_read_b128 v[60:63], v25 offset:19456
    s_waitcnt lgkmcnt(3)
    v_mfma_f32_16x16x32_bf16 v[64:67], a[64:67], v[48:51], v[64:67]
    s_waitcnt lgkmcnt(2)
    v_mfma_f32_16x16x32_bf16 v[68:71], a[64:67], v[52:55], v[68:71]
    v_mfma_f32_16x16x32_bf16 v[72:75], a[72:75], v[48:51], v[72:75]
    v_mfma_f32_16x16x32_bf16 v[76:79], a[72:75], v[52:55], v[76:79]
    ds_read_b128 v[48:51], v25 offset:20480
    ds_read_b128 v[52:55], v25 offset:21504
    s_waitcnt vmcnt(8)
    buffer_store_dword v21, v1, s[4:7], s68 offen sc1
    s_waitcnt lgkmcnt(3)
    v_mfma_f32_16x16x32_bf16 v[64:67], a[68:71], v[56:59], v[64:67]
    s_waitcnt lgkmcnt(2)
    v_mfma_f32_16x16x32_bf16 v[68:71], a[68:71], v[60:63], v[68:71]
    v_mfma_f32_16x16x32_bf16 v[72:75], a[76:79], v[56:59], v[72:75]
    v_mfma_f32_16x16x32_bf16 v[76:79], a[76:79], v[60:63], v[76:79]
    ds_read_b128 v[56:59], v25 offset:22528
    ds_read_b128 v[60:63], v25 offset:23552
    s_waitcnt lgkmcnt(3)
    v_mfma_f32_16x16x32_bf16 v[64:67], a[80:83], v[48:51], v[64:67]
    s_waitcnt lgkmcnt(2)
    v_mfma_f32_16x16x32_bf16 v[68:71], a[80:83], v[52:55], v[68:71]
    v_mfma_f32_16x16x32_bf16 v[72:75], a[88:91], v[48:51], v[72:75]
    v_mfma_f32_16x16x32_bf16 v[76:79], a[88:91], v[52:55], v[76:79]
    ds_read_b128 v[48:51], v25 offset:24576
    ds_read_b128 v[52:55], v25 offset:25600
    s_waitcnt lgkmcnt(3)
    v_mfma_f32_16x16x32_bf16 v[64:67], a[84:87], v[56:59], v[64:67]
    s_waitcnt lgkmcnt(2)
    v_mfma_f32_16x16x32_bf16 v[68:71], a[84:87], v[60:63], v[68:71]
    v_mfma_f32_16x16x32_bf16 v[72:75], a[92:95], v[56:59], v[72:75]
    v_mfma_f32_16x16x32_bf16 v[76:79], a[92:95], v[60:63], v[76:79]
    ds_read_b128 v[56:59], v25 offset:26624
    ds_read_b128 v[60:63], v25 offset:27648
    s_waitcnt lgkmcnt(3)
    v_mfma_f32_16x16x32_bf16 v[64:67], a[96:99], v[48:51], v[64:67]
    s_waitcnt lgkmcnt(2)
    v_mfma_f32_16x16x32_bf16 v[68:71], a[96:99], v[52:55], v[68:71]
    v_mfma_f32_16x16x32_bf16 v[72:75], a[104:107], v[48:51], v[72:75]
    v_mfma_f32_16x16x32_bf16 v[76:79], a[104:107], v[52:55], v[76:79]
    ds_read_b128 v[48:51], v25 offset:28672
    ds_read_b128 v[52:55], v25 offset:29696
    s_waitcnt lgkmcnt(3)
    v_mfma_f32_16x16x32_bf16 v[64:67], a[100:103], v[56:59], v[64:67]
    s_waitcnt lgkmcnt(2)
    v_mfma_f32_16x16x32_bf16 v[68:71], a[100:103], v[60:63], v[68:71]
    v_mfma_f32_16x16x32_bf16 v[72:75], a[108:111], v[56:59], v[72:75]
    v_mfma_f32_16x16x32_bf16 v[76:79], a[108:111], v[60:63], v[76:79]
    ds_read_b128 v[56:59], v25 offset:30720
    ds_read_b128 v[60:63], v25 offset:31744
    s_waitcnt lgkmcnt(3)
    v_mfma_f32_16x16x32_bf16 v[64:67], a[112:115], v[48:51], v[64:67]
    s_waitcnt lgkmcnt(2)
    v_mfma_f32_16x16x32_bf16 v[68:71], a[112:115], v[52:55], v[68:71]
    v_mfma_f32_16x16x32_bf16 v[72:75], a[120:123], v[48:51], v[72:75]
    v_mfma_f32_16x16x32_bf16 v[76:79], a[120:123], v[52:55], v[76:79]
    s_waitcnt lgkmcnt(1)
    v_mfma_f32_16x16x32_bf16 v[64:67], a[116:119], v[56:59], v[64:67]
    s_waitcnt lgkmcnt(0)
    v_mfma_f32_16x16x32_bf16 v[68:71], a[116:119], v[60:63], v[68:71]
    v_mfma_f32_16x16x32_bf16 v[72:75], a[124:127], v[56:59], v[72:75]
    v_mfma_f32_16x16x32_bf16 v[76:79], a[124:127], v[60:63], v[76:79]
    v_xor_b32 v25, 32768, v25
    s_lshl_b32 s21, s62, 5
    s_add_u32 s21, s21, s72
    s_lshl_b32 s68, s21, 6
    s_mul_i32 s21, s21, 24576
    s_mul_i32 s22, s18, 6144
    s_add_u32 s21, s21, s22
    s_add_u32 s21, s21, 4096
    s_lshl_b32 s23, s18, 2
    s_add_u32 s68, s68, s23
    s_add_u32 s68, s68, 0x4300010
    v_cvt_pk_bf16_f32 v32, v64, v65
    v_cvt_pk_bf16_f32 v33, v66, v67
    v_cvt_pk_bf16_f32 v34, v72, v73
    v_cvt_pk_bf16_f32 v35, v74, v75
    buffer_store_dwordx4 v[32:35], v0, s[4:7], s21 offen offset:0 sc1
    v_cvt_pk_bf16_f32 v36, v68, v69
    v_cvt_pk_bf16_f32 v37, v70, v71
    v_cvt_pk_bf16_f32 v38, v76, v77
    v_cvt_pk_bf16_f32 v39, v78, v79
    buffer_store_dwordx4 v[36:39], v0, s[4:7], s21 offen offset:1024 sc1
    s_add_u32 s62, s62, s64
    s_cmp_lt_u32 s62, s63
    s_cbranch_scc1 L_P_q
    s_waitcnt vmcnt(0)
    buffer_store_dword v21, v1, s[4:7], s68 offen sc1
    s_barrier
    s_branch L_P_done
L_w_Bload:
    s_cmp_eq_u32 s61, 1
    s_cselect_b32 s8, s48, s36
    s_cselect_b32 s9, s49, s37
    s_mov_b32 s10, s75
    s_mov_b32 s11, 0x20000
    s_cselect_b32 s76, 0, 0
    s_add_u32 s76, s76, s77
    s_add_u32 m0, s78, 0
    s_add_u32 s21, s18, 0
    s_mul_i32 s21, s21, s79
    s_add_u32 s21, s21, s76
    buffer_load_dwordx4 v28, s[8:11], s21 offen lds
    s_add_u32 m0, m0, 1056
    s_add_u32 s21, s21, s66
    buffer_load_dwordx4 v28, s[8:11], s21 offen lds
    s_add_u32 m0, m0, 1056
    s_add_u32 s21, s21, s66
    buffer_load_dwordx4 v28, s[8:11], s21 offen lds
    s_add_u32 m0, m0, 1056
    s_add_u32 s21, s21, s66
    buffer_load_dwordx4 v28, s[8:11], s21 offen lds
    s_add_u32 m0, m0, 1056
    s_add_u32 s21, s21, s66
    buffer_load_dwordx4 v28, s[8:11], s21 offen lds
    s_add_u32 m0, m0, 1056
    s_add_u32 s21, s21, s66
    buffer_load_dwordx4 v28, s[8:11], s21 offen lds
    s_add_u32 m0, m0, 1056
    s_add_u32 s21, s21, s66
    buffer_load_dwordx4 v28, s[8:11], s21 offen lds
    s_add_u32 m0, m0, 1056
    s_add_u32 s21, s21, s66
    buffer_load_dwordx4 v28, s[8:11], s21 offen lds
    s_add_u32 m0, m0, 1056
    s_add_u32 s21, s21, s66
    buffer_load_dwordx4 v28, s[8:11], s21 offen lds
    s_add_u32 m0, m0, 1056
    s_add_u32 s21, s21, s66
    buffer_load_dwordx4 v28, s[8:11], s21 offen lds
    s_add_u32 m0, m0, 1056
    s_add_u32 s21, s21, s66
    buffer_load_dwordx4 v28, s[8:11], s21 offen lds
    s_add_u32 m0, m0, 1056
    s_add_u32 s21, s21, s66
    buffer_load_dwordx4 v28, s[8:11], s21 offen lds
    s_add_u32 m0, m0, 1056
    s_add_u32 s21, s21, s66
    buffer_load_dwordx4 v28, s[8:11], s21 offen lds
    s_add_u32 m0, m0, 1056
    s_add_u32 s21, s21, s66
    buffer_load_dwordx4 v28, s[8:11], s21 offen lds
    s_add_u32 m0, m0, 1056
    s_add_u32 s21, s21, s66
    buffer_load_dwordx4 v28, s[8:11], s21 offen lds
    s_add_u32 m0, m0, 1056
    s_add_u32 s21, s21, s66
    buffer_load_dwordx4 v28, s[8:11], s21 offen lds
    s_waitcnt vmcnt(16)
    s_barrier
    ds_read_b64_tr_b16 v[192:193], v29 offset:0
    ds_read_b64_tr_b16 v[194:195], v29 offset:4224
    ds_read_b64_tr_b16 v[196:197], v29 offset:512
    ds_read_b64_tr_b16 v[198:199], v29 offset:4736
    ds_read_b64_tr_b16 v[200:201], v29 offset:32
    ds_read_b64_tr_b16 v[202:203], v29 offset:4256
    ds_read_b64_tr_b16 v[204:205], v29 offset:544
    ds_read_b64_tr_b16 v[206:207], v29 offset:4768
    ds_read_b64_tr_b16 v[208:209], v29 offset:16896
    ds_read_b64_tr_b16 v[210:211], v29 offset:21120
    ds_read_b64_tr_b16 v[212:213], v29 offset:17408
    ds_read_b64_tr_b16 v[214:215], v29 offset:21632
    ds_read_b64_tr_b16 v[216:217], v29 offset:16928
    ds_read_b64_tr_b16 v[218:219], v29 offset:21152
    ds_read_b64_tr_b16 v[220:221], v29 offset:17440
    ds_read_b64_tr_b16 v[222:223], v29 offset:21664
    ds_read_b64_tr_b16 v[224:225], v29 offset:33792
    ds_read_b64_tr_b16 v[226:227], v29 offset:38016
    ds_read_b64_tr_b16 v[228:229], v29 offset:34304
    ds_read_b64_tr_b16 v[230:231], v29 offset:38528
    ds_read_b64_tr_b16 v[232:233], v29 offset:33824
    ds_read_b64_tr_b16 v[234:235], v29 offset:38048
    ds_read_b64_tr_b16 v[236:237], v29 offset:34336
    ds_read_b64_tr_b16 v[238:239], v29 offset:38560
    ds_read_b64_tr_b16 v[240:241], v29 offset:50688
    ds_read_b64_tr_b16 v[242:243], v29 offset:54912
    ds_read_b64_tr_b16 v[244:245], v29 offset:51200
    ds_read_b64_tr_b16 v[246:247], v29 offset:55424
    ds_read_b64_tr_b16 v[248:249], v29 offset:50720
    ds_read_b64_tr_b16 v[250:251], v29 offset:54944
    ds_read_b64_tr_b16 v[252:253], v29 offset:51232
    ds_read_b64_tr_b16 v[254:255], v29 offset:55456
    s_waitcnt lgkmcnt(0)
    s_barrier
    s_add_u32 m0, s78, 67584
    s_add_u32 s21, s18, 4
    s_mul_i32 s21, s21, s79
    s_add_u32 s21, s21, s76
    buffer_load_dwordx4 v28, s[8:11], s21 offen lds
    s_add_u32 m0, m0, 1056
    s_add_u32 s21, s21, s66
    buffer_load_dwordx4 v28, s[8:11], s21 offen lds
    s_add_u32 m0, m0, 1056
    s_add_u32 s21, s21, s66
    buffer_load_dwordx4 v28, s[8:11], s21 offen lds
    s_add_u32 m0, m0, 1056
    s_add_u32 s21, s21, s66
    buffer_load_dwordx4 v28, s[8:11], s21 offen lds
    s_add_u32 m0, m0, 1056
    s_add_u32 s21, s21, s66
    buffer_load_dwordx4 v28, s[8:11], s21 offen lds
    s_add_u32 m0, m0, 1056
    s_add_u32 s21, s21, s66
    buffer_load_dwordx4 v28, s[8:11], s21 offen lds
    s_add_u32 m0, m0, 1056
    s_add_u32 s21, s21, s66
    buffer_load_dwordx4 v28, s[8:11], s21 offen lds
    s_add_u32 m0, m0, 1056
    s_add_u32 s21, s21, s66
    buffer_load_dwordx4 v28, s[8:11], s21 offen lds
    s_add_u32 m0, m0, 1056
    s_add_u32 s21, s21, s66
    buffer_load_dwordx4 v28, s[8:11], s21 offen lds
    s_add_u32 m0, m0, 1056
    s_add_u32 s21, s21, s66
    buffer_load_dwordx4 v28, s[8:11], s21 offen lds
    s_add_u32 m0, m0, 1056
    s_add_u32 s21, s21, s66
    buffer_load_dwordx4 v28, s[8:11], s21 offen lds
    s_add_u32 m0, m0, 1056
    s_add_u32 s21, s21, s66
    buffer_load_dwordx4 v28, s[8:11], s21 offen lds
    s_add_u32 m0, m0, 1056
    s_add_u32 s21, s21, s66
    buffer_load_dwordx4 v28, s[8:11], s21 offen lds
    s_add_u32 m0, m0, 1056
    s_add_u32 s21, s21, s66
    buffer_load_dwordx4 v28, s[8:11], s21 offen lds
    s_add_u32 m0, m0, 1056
    s_add_u32 s21, s21, s66
    buffer_load_dwordx4 v28, s[8:11], s21 offen lds
    s_add_u32 m0, m0, 1056
    s_add_u32 s21, s21, s66
    buffer_load_dwordx4 v28, s[8:11], s21 offen lds
    s_waitcnt vmcnt(16)
    s_barrier
    ds_read_b64_tr_b16 a[0:1], v2 offset:0
    ds_read_b64_tr_b16 a[2:3], v2 offset:4224
    ds_read_b64_tr_b16 a[4:5], v2 offset:512
    ds_read_b64_tr_b16 a[6:7], v2 offset:4736
    ds_read_b64_tr_b16 a[8:9], v2 offset:32
    ds_read_b64_tr_b16 a[10:11], v2 offset:4256
    ds_read_b64_tr_b16 a[12:13], v2 offset:544
    ds_read_b64_tr_b16 a[14:15], v2 offset:4768
    ds_read_b64_tr_b16 a[16:17], v2 offset:16896
    ds_read_b64_tr_b16 a[18:19], v2 offset:21120
    ds_read_b64_tr_b16 a[20:21], v2 offset:17408
    ds_read_b64_tr_b16 a[22:23], v2 offset:21632
    ds_read_b64_tr_b16 a[24:25], v2 offset:16928
    ds_read_b64_tr_b16 a[26:27], v2 offset:21152
    ds_read_b64_tr_b16 a[28:29], v2 offset:17440
    ds_read_b64_tr_b16 a[30:31], v2 offset:21664
    ds_read_b64_tr_b16 a[32:33], v2 offset:33792
    ds_read_b64_tr_b16 a[34:35], v2 offset:38016
    ds_read_b64_tr_b16 a[36:37], v2 offset:34304
    ds_read_b64_tr_b16 a[38:39], v2 offset:38528
    ds_read_b64_tr_b16 a[40:41], v2 offset:33824
    ds_read_b64_tr_b16 a[42:43], v2 offset:38048
    ds_read_b64_tr_b16 a[44:45], v2 offset:34336
    ds_read_b64_tr_b16 a[46:47], v2 offset:38560
    ds_read_b64_tr_b16 a[48:49], v2 offset:50688
    ds_read_b64_tr_b16 a[50:51], v2 offset:54912
    ds_read_b64_tr_b16 a[52:53], v2 offset:51200
    ds_read_b64_tr_b16 a[54:55], v2 offset:55424
    ds_read_b64_tr_b16 a[56:57], v2 offset:50720
    ds_read_b64_tr_b16 a[58:59], v2 offset:54944
    ds_read_b64_tr_b16 a[60:61], v2 offset:51232
    ds_read_b64_tr_b16 a[62:63], v2 offset:55456
    s_waitcnt lgkmcnt(0)
    s_barrier
    s_lshl_b32 s21, s70, 15
    s_lshl_b32 s22, s18, 8
    s_add_u32 s21, s21, s22
    s_lshl_b32 s22, s18, 13
    s_add_u32 m0, s22, s67
    s_nop 0
    buffer_load_dwordx4 v3, s[24:27], s21 offen lds
    s_add_u32 m0, m0, 1024
    s_add_u32 s21, s21, 16384
    buffer_load_dwordx4 v3, s[24:27], s21 offen lds
    s_add_u32 m0, m0, 1024
    s_add_u32 s21, s21, 0xffffc040
    buffer_load_dwordx4 v3, s[24:27], s21 offen lds
    s_add_u32 m0, m0, 1024
    s_add_u32 s21, s21, 16384
    buffer_load_dwordx4 v3, s[24:27], s21 offen lds
    s_add_u32 m0, m0, 1024
    s_add_u32 s21, s21, 0xffffc040
    buffer_load_dwordx4 v3, s[24:27], s21 offen lds
    s_add_u32 m0, m0, 1024
    s_add_u32 s21, s21, 16384
    buffer_load_dwordx4 v3, s[24:27], s21 offen lds
    s_add_u32 m0, m0, 1024
    s_add_u32 s21, s21, 0xffffc040
    buffer_load_dwordx4 v3, s[24:27], s21 offen lds
    s_add_u32 m0, m0, 1024
    s_add_u32 s21, s21, 16384
    buffer_load_dwordx4 v3, s[24:27], s21 offen lds
    s_add_u32 m0, m0, 1024
    s_add_u32 s21, s21, 0xffffc040
    s_waitcnt vmcnt(8)
    s_barrier
    ds_read_b64_tr_b16 a[64:65], v29 offset:0
    ds_read_b64_tr_b16 a[66:67], v29 offset:4224
    ds_read_b64_tr_b16 a[68:69], v29 offset:512
    ds_read_b64_tr_b16 a[70:71], v29 offset:4736
    ds_read_b64_tr_b16 a[72:73], v29 offset:32
    ds_read_b64_tr_b16 a[74:75], v29 offset:4256
    ds_read_b64_tr_b16 a[76:77], v29 offset:544
    ds_read_b64_tr_b16 a[78:79], v29 offset:4768
    ds_read_b64_tr_b16 a[80:81], v29 offset:16896
    ds_read_b64_tr_b16 a[82:83], v29 offset:21120
    ds_read_b64_tr_b16 a[84:85], v29 offset:17408
    ds_read_b64_tr_b16 a[86:87], v29 offset:21632
    ds_read_b64_tr_b16 a[88:89], v29 offset:16928
    ds_read_b64_tr_b16 a[90:91], v29 offset:21152
    ds_read_b64_tr_b16 a[92:93], v29 offset:17440
    ds_read_b64_tr_b16 a[94:95], v29 offset:21664
    ds_read_b64_tr_b16 a[96:97], v29 offset:33792
    ds_read_b64_tr_b16 a[98:99], v29 offset:38016
    ds_read_b64_tr_b16 a[100:101], v29 offset:34304
    ds_read_b64_tr_b16 a[102:103], v29 offset:38528
    ds_read_b64_tr_b16 a[104:105], v29 offset:33824
    ds_read_b64_tr_b16 a[106:107], v29 offset:38048
    ds_read_b64_tr_b16 a[108:109], v29 offset:34336
    ds_read_b64_tr_b16 a[110:111], v29 offset:38560
    ds_read_b64_tr_b16 a[112:113], v29 offset:50688
    ds_read_b64_tr_b16 a[114:115], v29 offset:54912
    ds_read_b64_tr_b16 a[116:117], v29 offset:51200
    ds_read_b64_tr_b16 a[118:119], v29 offset:55424
    ds_read_b64_tr_b16 a[120:121], v29 offset:50720
    ds_read_b64_tr_b16 a[122:123], v29 offset:54944
    ds_read_b64_tr_b16 a[124:125], v29 offset:51232
    ds_read_b64_tr_b16 a[126:127], v29 offset:55456
    s_waitcnt lgkmcnt(0)
    s_barrier
    v_mov_b32 v44, 163824
    s_cmp_lg_u32 s18, 0
    s_cbranch_scc1 L_wz_30
    s_mov_b32 s12, s56
    s_mov_b32 s13, s57
    s_mov_b32 s14, 0x100
    s_mov_b32 s15, 0x20000
    v_and_b32 v40, 3, v24
    v_lshlrev_b32 v40, 6, v40
    v_add_u32 v40, 60, v40
    s_mul_i32 s21, s16, 24
    s_add_u32 s21, s21, 40
    s_cmp_eq_u32 s16, 0
    s_cselect_b32 s21, 0, s21
    v_and_b32 v42, 1, v24
    v_lshl_add_u32 v42, v42, 3, s21
    s_mov_b32 s23, s60
L_wi_31:
    buffer_load_dword v41, v40, s[12:15], 0 offen sc1
    buffer_load_dword v43, v42, s[12:15], 0 offen sc1
    s_waitcnt vmcnt(0)
    v_readlane_b32 s22, v43, 1
    v_readlane_b32 s84, v41, 0
    v_readlane_b32 s85, v41, 1
    v_readlane_b32 s86, v41, 2
    v_readlane_b32 s87, v41, 3
    v_readlane_b32 s21, v43, 0
    s_nop 1
    s_bcnt1_i32_b32 s21, s21
    s_add_u32 s21, s21, s22
    s_add_u32 s84, s84, s85
    s_add_u32 s86, s86, s87
    s_add_u32 s84, s84, s86
    s_cmp_ge_u32 s84, 256
    s_cbranch_scc1 L_wiok_32
    s_sleep 16
    s_sub_u32 s23, s23, 1
    s_cbranch_scc0 L_wi_31
L_wiok_32:
    v_mov_b32 v45, s21
    ds_write_b32 v44, v45
    s_waitcnt lgkmcnt(0)
L_wz_30:
    s_waitcnt vmcnt(0)
    s_barrier
    ds_read_b32 v45, v44
    s_waitcnt lgkmcnt(0)
    v_readfirstlane_b32 s21, v45
    s_nop 0
    s_cmp_ge_u32 s21, 32
    s_cselect_b32 s89, 1, 0
    v_mov_b64 v[112:113], 0
    v_mov_b64 v[114:115], 0
    v_mov_b64 v[116:117], 0
    v_mov_b64 v[118:119], 0
    s_mov_b32 s68, 0x40000000
    v_mov_b32 v25, v12
L_P_B:
    s_waitcnt vmcnt(5)
    s_barrier
    s_add_u32 s70, s62, s64
    s_min_u32 s70, s70, 63
    s_xor_b32 s67, s67, 32768
    s_lshl_b32 s21, s70, 15
    s_lshl_b32 s22, s18, 8
    s_add_u32 s21, s21, s22
    s_lshl_b32 s22, s18, 13
    s_add_u32 m0, s22, s67
    ds_read_b128 v[48:51], v25 offset:0
    ds_read_b128 v[52:55], v25 offset:1024
    ds_read_b128 v[56:59], v25 offset:2048
    ds_read_b128 v[60:63], v25 offset:3072
    s_waitcnt lgkmcnt(3)
    v_mfma_f32_16x16x32_bf16 v[64:67], a[0:3], v[48:51], 0
    buffer_load_dwordx4 v3, s[24:27], s21 offen lds
    s_add_u32 m0, m0, 1024
    s_add_u32 s21, s21, 16384
    s_waitcnt lgkmcnt(2)
    v_mfma_f32_16x16x32_bf16 v[68:71], a[0:3], v[52:55], 0
    v_mfma_f32_16x16x32_bf16 v[72:75], a[8:11], v[48:51], 0
    v_mfma_f32_16x16x32_bf16 v[76:79], a[8:11], v[52:55], 0
    v_mfma_f32_16x16x32_bf16 v[80:83], a[128:131], v[48:51], 0
    v_mfma_f32_16x16x32_bf16 v[84:87], a[128:131], v[52:55], 0
    v_mfma_f32_16x16x32_bf16 v[88:91], a[136:139], v[48:51], 0
    v_mfma_f32_16x16x32_bf16 v[92:95], a[136:139], v[52:55], 0
    v_mfma_f32_16x16x32_bf16 v[96:99], v[48:51], v[128:131], 0
    v_mfma_f32_16x16x32_bf16 v[100:103], v[52:55], v[128:131], 0
    v_mfma_f32_16x16x32_bf16 v[104:107], v[48:51], v[136:139], 0
    v_mfma_f32_16x16x32_bf16 v[108:111], v[52:55], v[136:139], 0
    ds_read_b128 v[48:51], v25 offset:4096
    ds_read_b128 v[52:55], v25 offset:5120
    s_waitcnt lgkmcnt(3)
    v_mfma_f32_16x16x32_bf16 v[64:67], a[4:7], v[56:59], v[64:67]
    buffer_load_dwordx4 v3, s[24:27], s21 offen lds
    s_add_u32 m0, m0, 1024
    s_add_u32 s21, s21, 0xffffc040
    s_waitcnt lgkmcnt(2)
    v_mfma_f32_16x16x32_bf16 v[68:71], a[4:7], v[60:63], v[68:71]
    v_mfma_f32_16x16x32_bf16 v[72:75], a[12:15], v[56:59], v[72:75]
    v_mfma_f32_16x16x32_bf16 v[76:79], a[12:15], v[60:63], v[76:79]
    v_mfma_f32_16x16x32_bf16 v[80:83], a[132:135], v[56:59], v[80:83]
    v_mfma_f32_16x16x32_bf16 v[84:87], a[132:135], v[60:63], v[84:87]
    v_mfma_f32_16x16x32_bf16 v[88:91], a[140:143], v[56:59], v[88:91]
    v_mfma_f32_16x16x32_bf16 v[92:95], a[140:143], v[60:63], v[92:95]
    v_mfma_f32_16x16x32_bf16 v[96:99], v[56:59], v[132:135], v[96:99]
    v_mfma_f32_16x16x32_bf16 v[100:103], v[60:63], v[132:135], v[100:103]
    v_mfma_f32_16x16x32_bf16 v[104:107], v[56:59], v[140:143], v[104:107]
    v_mfma_f32_16x16x32_bf16 v[108:111], v[60:63], v[140:143], v[108:111]
    ds_read_b128 v[56:59], v25 offset:6144
    ds_read_b128 v[60:63], v25 offset:7168
    s_waitcnt lgkmcnt(3)
    v_mfma_f32_16x16x32_bf16 v[64:67], a[16:19], v[48:51], v[64:67]
    buffer_load_dwordx4 v3, s[24:27], s21 offen lds
    s_add_u32 m0, m0, 1024
    s_add_u32 s21, s21, 16384
    s_waitcnt lgkmcnt(2)
    v_mfma_f32_16x16x32_bf16 v[68:71], a[16:19], v[52:55], v[68:71]
    v_mfma_f32_16x16x32_bf16 v[72:75], a[24:27], v[48:51], v[72:75]
    v_mfma_f32_16x16x32_bf16 v[76:79], a[24:27], v[52:55], v[76:79]
    v_mfma_f32_16x16x32_bf16 v[80:83], a[144:147], v[48:51], v[80:83]
    v_mfma_f32_16x16x32_bf16 v[84:87], a[144:147], v[52:55], v[84:87]
    v_mfma_f32_16x16x32_bf16 v[88:91], a[152:155], v[48:51], v[88:91]
    v_mfma_f32_16x16x32_bf16 v[92:95], a[152:155], v[52:55], v[92:95]
    v_mfma_f32_16x16x32_bf16 v[96:99], v[48:51], v[144:147], v[96:99]
    v_mfma_f32_16x16x32_bf16 v[100:103], v[52:55], v[144:147], v[100:103]
    v_mfma_f32_16x16x32_bf16 v[104:107], v[48:51], v[152:155], v[104:107]
    v_mfma_f32_16x16x32_bf16 v[108:111], v[52:55], v[152:155], v[108:111]
    ds_read_b128 v[48:51], v25 offset:8192
    ds_read_b128 v[52:55], v25 offset:9216
    s_waitcnt lgkmcnt(3)
    v_mfma_f32_16x16x32_bf16 v[64:67], a[20:23], v[56:59], v[64:67]
    buffer_load_dwordx4 v3, s[24:27], s21 offen lds
    s_add_u32 m0, m0, 1024
    s_add_u32 s21, s21, 0xffffc040
    s_waitcnt lgkmcnt(2)
    v_mfma_f32_16x16x32_bf16 v[68:71], a[20:23], v[60:63], v[68:71]
    v_mfma_f32_16x16x32_bf16 v[72:75], a[28:31], v[56:59], v[72:75]
    v_mfma_f32_16x16x32_bf16 v[76:79], a[28:31], v[60:63], v[76:79]
    v_mfma_f32_16x16x32_bf16 v[80:83], a[148:151], v[56:59], v[80:83]
    v_mfma_f32_16x16x32_bf16 v[84:87], a[148:151], v[60:63], v[84:87]
    v_mfma_f32_16x16x32_bf16 v[88:91], a[156:159], v[56:59], v[88:91]
    v_mfma_f32_16x16x32_bf16 v[92:95], a[156:159], v[60:63], v[92:95]
    v_mfma_f32_16x16x32_bf16 v[96:99], v[56:59], v[148:151], v[96:99]
    v_mfma_f32_16x16x32_bf16 v[100:103], v[60:63], v[148:151], v[100:103]
    v_mfma_f32_16x16x32_bf16 v[104:107], v[56:59], v[156:159], v[104:107]
    v_mfma_f32_16x16x32_bf16 v[108:111], v[60:63], v[156:159], v[108:111]
    ds_read_b128 v[56:59], v25 offset:10240
    ds_read_b128 v[60:63], v25 offset:11264
    s_waitcnt lgkmcnt(3)
    v_mfma_f32_16x16x32_bf16 v[64:67], a[32:35], v[48:51], v[64:67]
    buffer_load_dwordx4 v3, s[24:27], s21 offen lds
    s_add_u32 m0, m0, 1024
    s_add_u32 s21, s21, 16384
    s_waitcnt lgkmcnt(2)
    v_mfma_f32_16x16x32_bf16 v[68:71], a[32:35], v[52:55], v[68:71]
    v_mfma_f32_16x16x32_bf16 v[72:75], a[40:43], v[48:51], v[72:75]
    v_mfma_f32_16x16x32_bf16 v[76:79], a[40:43], v[52:55], v[76:79]
    v_mfma_f32_16x16x32_bf16 v[80:83], a[160:163], v[48:51], v[80:83]
    v_mfma_f32_16x16x32_bf16 v[84:87], a[160:163], v[52:55], v[84:87]
    v_mfma_f32_16x16x32_bf16 v[88:91], a[168:171], v[48:51], v[88:91]
    v_mfma_f32_16x16x32_bf16 v[92:95], a[168:171], v[52:55], v[92:95]
    v_mfma_f32_16x16x32_bf16 v[96:99], v[48:51], v[160:163], v[96:99]
    v_mfma_f32_16x16x32_bf16 v[100:103], v[52:55], v[160:163], v[100:103]
    v_mfma_f32_16x16x32_bf16 v[104:107], v[48:51], v[168:171], v[104:107]
    v_mfma_f32_16x16x32_bf16 v[108:111], v[52:55], v[168:171], v[108:111]
    ds_read_b128 v[48:51], v25 offset:12288
    ds_read_b128 v[52:55], v25 offset:13312
    s_waitcnt lgkmcnt(3)
    v_mfma_f32_16x16x32_bf16 v[64:67], a[36:39], v[56:59], v[64:67]
    buffer_load_dwordx4 v3, s[24:27], s21 offen lds
    s_add_u32 m0, m0, 1024
    s_add_u32 s21, s21, 0xffffc040
    s_waitcnt lgkmcnt(2)
    v_mfma_f32_16x16x32_bf16 v[68:71], a[36:39], v[60:63], v[68:71]
    v_mfma_f32_16x16x32_bf16 v[72:75], a[44:47], v[56:59], v[72:75]
    v_mfma_f32_16x16x32_bf16 v[76:79], a[44:47], v[60:63], v[76:79]
    v_mfma_f32_16x16x32_bf16 v[80:83], a[164:167], v[56:59], v[80:83]
    v_mfma_f32_16x16x32_bf16 v[84:87], a[164:167], v[60:63], v[84:87]
    v_mfma_f32_16x16x32_bf16 v[88:91], a[172:175], v[56:59], v[88:91]
    v_mfma_f32_16x16x32_bf16 v[92:95], a[172:175], v[60:63], v[92:95]
    v_mfma_f32_16x16x32_bf16 v[96:99], v[56:59], v[164:167], v[96:99]
    v_mfma_f32_16x16x32_bf16 v[100:103], v[60:63], v[164:167], v[100:103]
    v_mfma_f32_16x16x32_bf16 v[104:107], v[56:59], v[172:175], v[104:107]
    v_mfma_f32_16x16x32_bf16 v[108:111], v[60:63], v[172:175], v[108:111]
    ds_read_b128 v[56:59], v25 offset:14336
    ds_read_b128 v[60:63], v25 offset:15360
    s_waitcnt lgkmcnt(3)
    v_mfma_f32_16x16x32_bf16 v[64:67], a[48:51], v[48:51], v[64:67]
    buffer_load_dwordx4 v3, s[24:27], s21 offen lds
    s_add_u32 m0, m0, 1024
    s_add_u32 s21, s21, 16384
    s_waitcnt lgkmcnt(2)
    v_mfma_f32_16x16x32_bf16 v[68:71], a[48:51], v[52:55], v[68:71]
    v_mfma_f32_16x16x32_bf16 v[72:75], a[56:59], v[48:51], v[72:75]
    v_mfma_f32_16x16x32_bf16 v[76:79], a[56:59], v[52:55], v[76:79]
    v_mfma_f32_16x16x32_bf16 v[80:83], a[176:179], v[48:51], v[80:83]
    v_mfma_f32_16x16x32_bf16 v[84:87], a[176:179], v[52:55], v[84:87]
    v_mfma_f32_16x16x32_bf16 v[88:91], a[184:187], v[48:51], v[88:91]
    v_mfma_f32_16x16x32_bf16 v[92:95], a[184:187], v[52:55], v[92:95]
    v_mfma_f32_16x16x32_bf16 v[96:99], v[48:51], v[176:179], v[96:99]
    v_mfma_f32_16x16x32_bf16 v[100:103], v[52:55], v[176:179], v[100:103]
    v_mfma_f32_16x16x32_bf16 v[104:107], v[48:51], v[184:187], v[104:107]
    v_mfma_f32_16x16x32_bf16 v[108:111], v[52:55], v[184:187], v[108:111]
    ds_read_b128 v[48:51], v25 offset:16384
    ds_read_b128 v[52:55], v25 offset:17408
    s_waitcnt lgkmcnt(3)
    v_mfma_f32_16x16x32_bf16 v[64:67], a[52:55], v[56:59], v[64:67]
    buffer_load_dwordx4 v3, s[24:27], s21 offen lds
    s_add_u32 m0, m0, 1024
    s_add_u32 s21, s21, 0xffffc040
    s_waitcnt lgkmcnt(2)
    v_mfma_f32_16x16x32_bf16 v[68:71], a[52:55], v[60:63], v[68:71]
    v_mfma_f32_16x16x32_bf16 v[72:75], a[60:63], v[56:59], v[72:75]
    v_mfma_f32_16x16x32_bf16 v[76:79], a[60:63], v[60:63], v[76:79]
    v_mfma_f32_16x16x32_bf16 v[80:83], a[180:183], v[56:59], v[80:83]
    v_mfma_f32_16x16x32_bf16 v[84:87], a[180:183], v[60:63], v[84:87]
    v_mfma_f32_16x16x32_bf16 v[88:91], a[188:191], v[56:59], v[88:91]
    v_mfma_f32_16x16x32_bf16 v[92:95], a[188:191], v[60:63], v[92:95]
    v_mfma_f32_16x16x32_bf16 v[96:99], v[56:59], v[180:183], v[96:99]
    v_mfma_f32_16x16x32_bf16 v[100:103], v[60:63], v[180:183], v[100:103]
    v_mfma_f32_16x16x32_bf16 v[104:107], v[56:59], v[188:191], v[104:107]
    v_mfma_f32_16x16x32_bf16 v[108:111], v[60:63], v[188:191], v[108:111]
    ds_read_b128 v[56:59], v25 offset:18432
    ds_read_b128 v[60:63], v25 offset:19456
    s_waitcnt lgkmcnt(3)
    v_mfma_f32_16x16x32_bf16 v[64:67], a[64:67], v[48:51], v[64:67]
    s_waitcnt lgkmcnt(2)
    v_mfma_f32_16x16x32_bf16 v[68:71], a[64:67], v[52:55], v[68:71]
    v_mfma_f32_16x16x32_bf16 v[72:75], a[72:75], v[48:51], v[72:75]
    v_mfma_f32_16x16x32_bf16 v[76:79], a[72:75], v[52:55], v[76:79]
    v_mfma_f32_16x16x32_bf16 v[80:83], a[192:195], v[48:51], v[80:83]
    v_mfma_f32_16x16x32_bf16 v[84:87], a[192:195], v[52:55], v[84:87]
    v_mfma_f32_16x16x32_bf16 v[88:91], a[200:203], v[48:51], v[88:91]
    v_mfma_f32_16x16x32_bf16 v[92:95], a[200:203], v[52:55], v[92:95]
    v_mfma_f32_16x16x32_bf16 v[96:99], v[48:51], v[192:195], v[96:99]
    v_mfma_f32_16x16x32_bf16 v[100:103], v[52:55], v[192:195], v[100:103]
    v_mfma_f32_16x16x32_bf16 v[104:107], v[48:51], v[200:203], v[104:107]
    v_mfma_f32_16x16x32_bf16 v[108:111], v[52:55], v[200:203], v[108:111]
    ds_read_b128 v[48:51], v25 offset:20480
    ds_read_b128 v[52:55], v25 offset:21504
    s_waitcnt vmcnt(8)
    buffer_store_dword v21, v1, s[4:7], s68 offen sc1
    s_waitcnt lgkmcnt(3)
    v_mfma_f32_16x16x32_bf16 v[64:67], a[68:71], v[56:59], v[64:67]
    s_waitcnt lgkmcnt(2)
    v_mfma_f32_16x16x32_bf16 v[68:71], a[68:71], v[60:63], v[68:71]
    v_mfma_f32_16x16x32_bf16 v[72:75], a[76:79], v[56:59], v[72:75]
    v_mfma_f32_16x16x32_bf16 v[76:79], a[76:79], v[60:63], v[76:79]
    v_mfma_f32_16x16x32_bf16 v[80:83], a[196:199], v[56:59], v[80:83]
    v_mfma_f32_16x16x32_bf16 v[84:87], a[196:199], v[60:63], v[84:87]
    v_mfma_f32_16x16x32_bf16 v[88:91], a[204:207], v[56:59], v[88:91]
    v_mfma_f32_16x16x32_bf16 v[92:95], a[204:207], v[60:63], v[92:95]
    v_mfma_f32_16x16x32_bf16 v[96:99], v[56:59], v[196:199], v[96:99]
    v_mfma_f32_16x16x32_bf16 v[100:103], v[60:63], v[196:199], v[100:103]
    v_mfma_f32_16x16x32_bf16 v[104:107], v[56:59], v[204:207], v[104:107]
    v_mfma_f32_16x16x32_bf16 v[108:111], v[60:63], v[204:207], v[108:111]
    ds_read_b128 v[56:59], v25 offset:22528
    ds_read_b128 v[60:63], v25 offset:23552
    s_waitcnt lgkmcnt(3)
    v_mfma_f32_16x16x32_bf16 v[64:67], a[80:83], v[48:51], v[64:67]
    s_waitcnt lgkmcnt(2)
    v_mfma_f32_16x16x32_bf16 v[68:71], a[80:83], v[52:55], v[68:71]
    v_mfma_f32_16x16x32_bf16 v[72:75], a[88:91], v[48:51], v[72:75]
    v_mfma_f32_16x16x32_bf16 v[76:79], a[88:91], v[52:55], v[76:79]
    v_mfma_f32_16x16x32_bf16 v[80:83], a[208:211], v[48:51], v[80:83]
    v_mfma_f32_16x16x32_bf16 v[84:87], a[208:211], v[52:55], v[84:87]
    v_mfma_f32_16x16x32_bf16 v[88:91], a[216:219], v[48:51], v[88:91]
    v_mfma_f32_16x16x32_bf16 v[92:95], a[216:219], v[52:55], v[92:95]
    v_mfma_f32_16x16x32_bf16 v[96:99], v[48:51], v[208:211], v[96:99]
    v_mfma_f32_16x16x32_bf16 v[100:103], v[52:55], v[208:211], v[100:103]
    v_mfma_f32_16x16x32_bf16 v[104:107], v[48:51], v[216:219], v[104:107]
    v_mfma_f32_16x16x32_bf16 v[108:111], v[52:55], v[216:219], v[108:111]
    ds_read_b128 v[48:51], v25 offset:24576
    ds_read_b128 v[52:55], v25 offset:25600
    s_waitcnt lgkmcnt(3)
    v_mfma_f32_16x16x32_bf16 v[64:67], a[84:87], v[56:59], v[64:67]
    s_waitcnt lgkmcnt(2)
    v_mfma_f32_16x16x32_bf16 v[68:71], a[84:87], v[60:63], v[68:71]
    v_mfma_f32_16x16x32_bf16 v[72:75], a[92:95], v[56:59], v[72:75]
    v_mfma_f32_16x16x32_bf16 v[76:79], a[92:95], v[60:63], v[76:79]
    v_mfma_f32_16x16x32_bf16 v[80:83], a[212:215], v[56:59], v[80:83]
    v_mfma_f32_16x16x32_bf16 v[84:87], a[212:215], v[60:63], v[84:87]
    v_mfma_f32_16x16x32_bf16 v[88:91], a[220:223], v[56:59], v[88:91]
    v_mfma_f32_16x16x32_bf16 v[92:95], a[220:223], v[60:63], v[92:95]
    v_mfma_f32_16x16x32_bf16 v[96:99], v[56:59], v[212:215], v[96:99]
    v_mfma_f32_16x16x32_bf16 v[100:103], v[60:63], v[212:215], v[100:103]
    v_mfma_f32_16x16x32_bf16 v[104:107], v[56:59], v[220:223], v[104:107]
    v_mfma_f32_16x16x32_bf16 v[108:111], v[60:63], v[220:223], v[108:111]
    ds_read_b128 v[56:59], v25 offset:26624
    ds_read_b128 v[60:63], v25 offset:27648
    s_waitcnt lgkmcnt(3)
    v_mfma_f32_16x16x32_bf16 v[64:67], a[96:99], v[48:51], v[64:67]
    s_waitcnt lgkmcnt(2)
    v_mfma_f32_16x16x32_bf16 v[68:71], a[96:99], v[52:55], v[68:71]
    v_mfma_f32_16x16x32_bf16 v[72:75], a[104:107], v[48:51], v[72:75]
    v_mfma_f32_16x16x32_bf16 v[76:79], a[104:107], v[52:55], v[76:79]
    v_mfma_f32_16x16x32_bf16 v[80:83], a[224:227], v[48:51], v[80:83]
    v_mfma_f32_16x16x32_bf16 v[84:87], a[224:227], v[52:55], v[84:87]
    v_mfma_f32_16x16x32_bf16 v[88:91], a[232:235], v[48:51], v[88:91]
    v_mfma_f32_16x16x32_bf16 v[92:95], a[232:235], v[52:55], v[92:95]
    v_mfma_f32_16x16x32_bf16 v[96:99], v[48:51], v[224:227], v[96:99]
    v_mfma_f32_16x16x32_bf16 v[100:103], v[52:55], v[224:227], v[100:103]
    v_mfma_f32_16x16x32_bf16 v[104:107], v[48:51], v[232:235], v[104:107]
    v_mfma_f32_16x16x32_bf16 v[108:111], v[52:55], v[232:235], v[108:111]
    ds_read_b128 v[48:51], v25 offset:28672
    ds_read_b128 v[52:55], v25 offset:29696
    s_waitcnt lgkmcnt(3)
    v_mfma_f32_16x16x32_bf16 v[64:67], a[100:103], v[56:59], v[64:67]
    s_waitcnt lgkmcnt(2)
    v_mfma_f32_16x16x32_bf16 v[68:71], a[100:103], v[60:63], v[68:71]
    v_mfma_f32_16x16x32_bf16 v[72:75], a[108:111], v[56:59], v[72:75]
    v_mfma_f32_16x16x32_bf16 v[76:79], a[108:111], v[60:63], v[76:79]
    v_mfma_f32_16x16x32_bf16 v[80:83], a[228:231], v[56:59], v[80:83]
    v_mfma_f32_16x16x32_bf16 v[84:87], a[228:231], v[60:63], v[84:87]
    v_mfma_f32_16x16x32_bf16 v[88:91], a[236:239], v[56:59], v[88:91]
    v_mfma_f32_16x16x32_bf16 v[92:95], a[236:239], v[60:63], v[92:95]
    v_mfma_f32_16x16x32_bf16 v[96:99], v[56:59], v[228:231], v[96:99]
    v_mfma_f32_16x16x32_bf16 v[100:103], v[60:63], v[228:231], v[100:103]
    v_mfma_f32_16x16x32_bf16 v[104:107], v[56:59], v[236:239], v[104:107]
    v_mfma_f32_16x16x32_bf16 v[108:111], v[60:63], v[236:239], v[108:111]
    ds_read_b128 v[56:59], v25 offset:30720
    ds_read_b128 v[60:63], v25 offset:31744
    s_waitcnt lgkmcnt(3)
    v_mfma_f32_16x16x32_bf16 v[64:67], a[112:115], v[48:51], v[64:67]
    s_waitcnt lgkmcnt(2)
    v_mfma_f32_16x16x32_bf16 v[68:71], a[112:115], v[52:55], v[68:71]
    v_mfma_f32_16x16x32_bf16 v[72:75], a[120:123], v[48:51], v[72:75]
    v_mfma_f32_16x16x32_bf16 v[76:79], a[120:123], v[52:55], v[76:79]
    v_mfma_f32_16x16x32_bf16 v[80:83], a[240:243], v[48:51], v[80:83]
    v_mfma_f32_16x16x32_bf16 v[84:87], a[240:243], v[52:55], v[84:87]
    v_mfma_f32_16x16x32_bf16 v[88:91], a[248:251], v[48:51], v[88:91]
    v_mfma_f32_16x16x32_bf16 v[92:95], a[248:251], v[52:55], v[92:95]
    v_mfma_f32_16x16x32_bf16 v[96:99], v[48:51], v[240:243], v[96:99]
    v_mfma_f32_16x16x32_bf16 v[100:103], v[52:55], v[240:243], v[100:103]
    v_mfma_f32_16x16x32_bf16 v[104:107], v[48:51], v[248:251], v[104:107]
    v_mfma_f32_16x16x32_bf16 v[108:111], v[52:55], v[248:251], v[108:111]
    s_waitcnt lgkmcnt(1)
    v_mfma_f32_16x16x32_bf16 v[64:67], a[116:119], v[56:59], v[64:67]
    s_waitcnt lgkmcnt(0)
    v_mfma_f32_16x16x32_bf16 v[68:71], a[116:119], v[60:63], v[68:71]
    v_mfma_f32_16x16x32_bf16 v[72:75], a[124:127], v[56:59], v[72:75]
    v_mfma_f32_16x16x32_bf16 v[76:79], a[124:127], v[60:63], v[76:79]
    v_mfma_f32_16x16x32_bf16 v[80:83], a[244:247], v[56:59], v[80:83]
    v_mfma_f32_16x16x32_bf16 v[84:87], a[244:247], v[60:63], v[84:87]
    v_mfma_f32_16x16x32_bf16 v[88:91], a[252:255], v[56:59], v[88:91]
    v_mfma_f32_16x16x32_bf16 v[92:95], a[252:255], v[60:63], v[92:95]
    v_mfma_f32_16x16x32_bf16 v[96:99], v[56:59], v[244:247], v[96:99]
    v_mfma_f32_16x16x32_bf16 v[100:103], v[60:63], v[244:247], v[100:103]
    v_mfma_f32_16x16x32_bf16 v[104:107], v[56:59], v[252:255], v[104:107]
    v_mfma_f32_16x16x32_bf16 v[108:111], v[60:63], v[252:255], v[108:111]
    v_xor_b32 v25, 32768, v25
    s_lshl_b32 s21, s62, 7
    s_add_u32 s21, s21, 0x4200000
    buffer_load_dword v26, v8, s[4:7], s21 offen sc1
    buffer_load_dword v27, v8, s[4:7], s21 offen offset:64 sc1
    v_cvt_pk_bf16_f32 v64, v64, v65
    v_cvt_pk_bf16_f32 v65, v66, v67
    v_cvt_pk_bf16_f32 v68, v68, v69
    v_cvt_pk_bf16_f32 v69, v70, v71
    v_cvt_pk_bf16_f32 v72, v72, v73
    v_cvt_pk_bf16_f32 v73, v74, v75
    v_cvt_pk_bf16_f32 v76, v76, v77
    v_cvt_pk_bf16_f32 v77, v78, v79
    v_cvt_pk_bf16_f32 v80, v80, v81
    v_cvt_pk_bf16_f32 v81, v82, v83
    v_cvt_pk_bf16_f32 v84, v84, v85
    v_cvt_pk_bf16_f32 v85, v86, v87
    v_cvt_pk_bf16_f32 v88, v88, v89
    v_cvt_pk_bf16_f32 v89, v90, v91
    v_cvt_pk_bf16_f32 v92, v92, v93
    v_cvt_pk_bf16_f32 v93, v94, v95
    v_cvt_pk_bf16_f32 v96, v96, v97
    v_cvt_pk_bf16_f32 v97, v98, v99
    v_cvt_pk_bf16_f32 v100, v100, v101
    v_cvt_pk_bf16_f32 v101, v102, v103
    v_cvt_pk_bf16_f32 v104, v104, v105
    v_cvt_pk_bf16_f32 v105, v106, v107
    v_cvt_pk_bf16_f32 v108, v108, v109
    v_cvt_pk_bf16_f32 v109, v110, v111
    s_mov_b32 s80, 0xaaaaaaaa
    s_mov_b32 s81, 0xaaaaaaaa
    v_cmp_ne_u32 s[82:83], 0, v4
    v_cmp_ne_u32 s[84:85], 0, v5
    s_mov_b32 s86, 0x3eb8aa3b
    s_cmp_eq_u32 s62, 0
    s_cselect_b32 s87, 0xf149f2ca, 0
    s_lshl_b32 s21, s62, 5
    s_lshl_b32 s22, s72, 3
    s_add_u32 s21, s21, s22
    s_lshl_b32 s22, s18, 1
    s_add_u32 s21, s21, s22
    s_lshl_b32 s21, s21, 10
    s_add_u32 s21, s21, 0x4000000
    s_cmp_lt_u32 s62, s73
    s_cselect_b32 s21, 0x40000000, s21
    s_lshl_b32 s68, s62, 2
    s_add_u32 s68, s68, s72
    s_lshl_b32 s68, s68, 6
    s_lshl_b32 s22, s18, 2
    s_add_u32 s68, s68, s22
    s_add_u32 s68, s68, 0x4360000
    s_cmp_lt_u32 s62, s73
    s_cselect_b32 s68, 0x40000000, s68
    s_waitcnt vmcnt(0)
    v_sub_f32 v26, 1.0, v26
    v_sub_f32 v27, 1.0, v27
    v_mfma_f32_16x16x16_bf16 v[28:31], v[80:81], v[64:65], 0
    v_mfma_f32_16x16x16_bf16 v[32:35], v[112:113], v[64:65], 0
    s_nop 6
    v_cndmask_b32 v28, v28, v29, s[80:81]
    v_cndmask_b32 v32, v32, v33, s[80:81]
    v_add_f32 v32, s87, v32
    v_cndmask_b32 v40, v32, v28, s[82:83]
    v_cndmask_b32 v30, v30, v31, s[80:81]
    v_cndmask_b32 v34, v34, v35, s[80:81]
    v_add_f32 v34, s87, v34
    v_cndmask_b32 v41, v34, v30, s[84:85]
    v_cvt_pk_bf16_f32 v41, v40, v41
    v_lshlrev_b32 v40, 16, v41
    v_and_b32 v41, 0xffff0000, v41
    v_max_f32 v42, v40, v41
    v_mov_b32 v43, v42
    s_nop 1
    v_permlane16_swap_b32 v42, v43
    v_max_f32 v42, v42, v43
    v_mov_b32 v43, v42
    s_nop 1
    v_permlane32_swap_b32 v42, v43
    v_max_f32 v42, v42, v43
    v_mul_f32 v42, s86, v42
    v_fma_f32 v40, v40, s86, -v42
    v_exp_f32 v40, v40
    v_fma_f32 v41, v41, s86, -v42
    v_exp_f32 v41, v41
    s_nop 0
    v_add_f32 v42, v40, v41
    v_mov_b32 v43, v42
    s_nop 1
    v_permlane16_swap_b32 v42, v43
    v_add_f32 v42, v42, v43
    v_mov_b32 v43, v42
    s_nop 1
    v_permlane32_swap_b32 v42, v43
    v_add_f32 v42, v42, v43
    v_rcp_f32 v42, v42
    v_cvt_pk_bf16_f32 v40, v40, v40
    v_and_b32 v44, v40, v4
    v_and_b32 v46, v40, v6
    v_cvt_pk_bf16_f32 v41, v41, v41
    v_and_b32 v45, v41, v5
    v_and_b32 v47, v41, v7
    v_mul_f32 v42, v42, v26
    v_mfma_f32_16x16x16_bf16 v[36:39], v[96:97], v[44:45], 0
    v_mfma_f32_16x16x16_bf16 v[36:39], v[116:117], v[46:47], v[36:39]
    s_nop 7
    v_mul_f32 v36, v36, v42
    v_mul_f32 v37, v37, v42
    v_mul_f32 v38, v38, v42
    v_mul_f32 v39, v39, v42
    v_cvt_pk_bf16_f32 v48, v36, v37
    v_cvt_pk_bf16_f32 v49, v38, v39
    buffer_store_dwordx2 v[48:49], v9, s[4:7], s21 offen offset:0 sc1
    v_mfma_f32_16x16x16_bf16 v[28:31], v[84:85], v[68:69], 0
    v_mfma_f32_16x16x16_bf16 v[32:35], v[80:81], v[68:69], 0
    s_nop 6
    v_cndmask_b32 v28, v28, v29, s[80:81]
    v_cndmask_b32 v32, v32, v33, s[80:81]
    v_cndmask_b32 v40, v32, v28, s[82:83]
    v_cndmask_b32 v30, v30, v31, s[80:81]
    v_cndmask_b32 v34, v34, v35, s[80:81]
    v_cndmask_b32 v41, v34, v30, s[84:85]
    v_cvt_pk_bf16_f32 v41, v40, v41
    v_lshlrev_b32 v40, 16, v41
    v_and_b32 v41, 0xffff0000, v41
    v_max_f32 v42, v40, v41
    v_mov_b32 v43, v42
    s_nop 1
    v_permlane16_swap_b32 v42, v43
    v_max_f32 v42, v42, v43
    v_mov_b32 v43, v42
    s_nop 1
    v_permlane32_swap_b32 v42, v43
    v_max_f32 v42, v42, v43
    v_mul_f32 v42, s86, v42
    v_fma_f32 v40, v40, s86, -v42
    v_exp_f32 v40, v40
    v_fma_f32 v41, v41, s86, -v42
    v_exp_f32 v41, v41
    s_nop 0
    v_add_f32 v42, v40, v41
    v_mov_b32 v43, v42
    s_nop 1
    v_permlane16_swap_b32 v42, v43
    v_add_f32 v42, v42, v43
    v_mov_b32 v43, v42
    s_nop 1
    v_permlane32_swap_b32 v42, v43
    v_add_f32 v42, v42, v43
    v_rcp_f32 v42, v42
    v_cvt_pk_bf16_f32 v40, v40, v40
    v_and_b32 v44, v40, v4
    v_and_b32 v46, v40, v6
    v_cvt_pk_bf16_f32 v41, v41, v41
    v_and_b32 v45, v41, v5
    v_and_b32 v47, v41, v7
    v_mul_f32 v42, v42, v27
    v_mfma_f32_16x16x16_bf16 v[36:39], v[100:101], v[44:45], 0
    v_mfma_f32_16x16x16_bf16 v[36:39], v[96:97], v[46:47], v[36:39]
    s_nop 7
    v_mul_f32 v36, v36, v42
    v_mul_f32 v37, v37, v42
    v_mul_f32 v38, v38, v42
    v_mul_f32 v39, v39, v42
    v_cvt_pk_bf16_f32 v50, v36, v37
    v_cvt_pk_bf16_f32 v51, v38, v39
    buffer_store_dwordx2 v[50:51], v9, s[4:7], s21 offen offset:512 sc1
    v_mfma_f32_16x16x16_bf16 v[28:31], v[88:89], v[72:73], 0
    v_mfma_f32_16x16x16_bf16 v[32:35], v[114:115], v[72:73], 0
    s_nop 6
    v_cndmask_b32 v28, v28, v29, s[80:81]
    v_cndmask_b32 v32, v32, v33, s[80:81]
    v_add_f32 v32, s87, v32
    v_cndmask_b32 v40, v32, v28, s[82:83]
    v_cndmask_b32 v30, v30, v31, s[80:81]
    v_cndmask_b32 v34, v34, v35, s[80:81]
    v_add_f32 v34, s87, v34
    v_cndmask_b32 v41, v34, v30, s[84:85]
    v_cvt_pk_bf16_f32 v41, v40, v41
    v_lshlrev_b32 v40, 16, v41
    v_and_b32 v41, 0xffff0000, v41
    v_max_f32 v42, v40, v41
    v_mov_b32 v43, v42
    s_nop 1
    v_permlane16_swap_b32 v42, v43
    v_max_f32 v42, v42, v43
    v_mov_b32 v43, v42
    s_nop 1
    v_permlane32_swap_b32 v42, v43
    v_max_f32 v42, v42, v43
    v_mul_f32 v42, s86, v42
    v_fma_f32 v40, v40, s86, -v42
    v_exp_f32 v40, v40
    v_fma_f32 v41, v41, s86, -v42
    v_exp_f32 v41, v41
    s_nop 0
    v_add_f32 v42, v40, v41
    v_mov_b32 v43, v42
    s_nop 1
    v_permlane16_swap_b32 v42, v43
    v_add_f32 v42, v42, v43
    v_mov_b32 v43, v42
    s_nop 1
    v_permlane32_swap_b32 v42, v43
    v_add_f32 v42, v42, v43
    v_rcp_f32 v42, v42
    v_cvt_pk_bf16_f32 v40, v40, v40
    v_and_b32 v44, v40, v4
    v_and_b32 v46, v40, v6
    v_cvt_pk_bf16_f32 v41, v41, v41
    v_and_b32 v45, v41, v5
    v_and_b32 v47, v41, v7
    v_mul_f32 v42, v42, v26
    v_mfma_f32_16x16x16_bf16 v[36:39], v[104:105], v[44:45], 0
    v_mfma_f32_16x16x16_bf16 v[36:39], v[118:119], v[46:47], v[36:39]
    s_nop 7
    v_mul_f32 v36, v36, v42
    v_mul_f32 v37, v37, v42
    v_mul_f32 v38, v38, v42
    v_mul_f32 v39, v39, v42
    v_cvt_pk_bf16_f32 v52, v36, v37
    v_cvt_pk_bf16_f32 v53, v38, v39
    buffer_store_dwordx2 v[52:53], v9, s[4:7], s21 offen offset:1024 sc1
    v_mfma_f32_16x16x16_bf16 v[28:31], v[92:93], v[76:77], 0
    v_mfma_f32_16x16x16_bf16 v[32:35], v[88:89], v[76:77], 0
    s_nop 6
    v_cndmask_b32 v28, v28, v29, s[80:81]
    v_cndmask_b32 v32, v32, v33, s[80:81]
    v_cndmask_b32 v40, v32, v28, s[82:83]
    v_cndmask_b32 v30, v30, v31, s[80:81]
    v_cndmask_b32 v34, v34, v35, s[80:81]
    v_cndmask_b32 v41, v34, v30, s[84:85]
    v_cvt_pk_bf16_f32 v41, v40, v41
    v_lshlrev_b32 v40, 16, v41
    v_and_b32 v41, 0xffff0000, v41
    v_max_f32 v42, v40, v41
    v_mov_b32 v43, v42
    s_nop 1
    v_permlane16_swap_b32 v42, v43
    v_max_f32 v42, v42, v43
    v_mov_b32 v43, v42
    s_nop 1
    v_permlane32_swap_b32 v42, v43
    v_max_f32 v42, v42, v43
    v_mul_f32 v42, s86, v42
    v_fma_f32 v40, v40, s86, -v42
    v_exp_f32 v40, v40
    v_fma_f32 v41, v41, s86, -v42
    v_exp_f32 v41, v41
    s_nop 0
    v_add_f32 v42, v40, v41
    v_mov_b32 v43, v42
    s_nop 1
    v_permlane16_swap_b32 v42, v43
    v_add_f32 v42, v42, v43
    v_mov_b32 v43, v42
    s_nop 1
    v_permlane32_swap_b32 v42, v43
    v_add_f32 v42, v42, v43
    v_rcp_f32 v42, v42
    v_cvt_pk_bf16_f32 v40, v40, v40
    v_and_b32 v44, v40, v4
    v_and_b32 v46, v40, v6
    v_cvt_pk_bf16_f32 v41, v41, v41
    v_and_b32 v45, v41, v5
    v_and_b32 v47, v41, v7
    v_mul_f32 v42, v42, v27
    v_mfma_f32_16x16x16_bf16 v[36:39], v[108:109], v[44:45], 0
    v_mfma_f32_16x16x16_bf16 v[36:39], v[104:105], v[46:47], v[36:39]
    s_nop 7
    v_mul_f32 v36, v36, v42
    v_mul_f32 v37, v37, v42
    v_mul_f32 v38, v38, v42
    v_mul_f32 v39, v39, v42
    v_cvt_pk_bf16_f32 v54, v36, v37
    v_cvt_pk_bf16_f32 v55, v38, v39
    buffer_store_dwordx2 v[54:55], v9, s[4:7], s21 offen offset:1536 sc1
    v_mov_b64 v[112:113], v[84:85]
    v_mov_b64 v[116:117], v[100:101]
    v_mov_b64 v[114:115], v[92:93]
    v_mov_b64 v[118:119], v[108:109]
    s_add_u32 s62, s62, s64
    s_cmp_lt_u32 s62, s63
    s_cbranch_scc1 L_P_B
    s_waitcnt vmcnt(0)
    buffer_store_dword v21, v1, s[4:7], s68 offen sc1
    s_barrier
L_P_done:
    s_mov_b32 s8, s42
    s_mov_b32 s9, s43
    s_mov_b32 s10, 0x400000
    s_mov_b32 s11, 0x20000
    s_mul_i32 s78, s18, 36864
    s_mov_b32 m0, s78
    s_lshl_b32 s21, s17, 17
    s_add_u32 s21, s21, 0
    buffer_load_dwordx4 v11, s[8:11], s21 offen lds
    s_add_u32 m0, m0, 1024
    s_add_u32 s21, s21, 16384
    buffer_load_dwordx4 v11, s[8:11], s21 offen lds
    s_add_u32 m0, m0, 1024
    s_add_u32 s21, s21, 16384
    buffer_load_dwordx4 v11, s[8:11], s21 offen lds
    s_add_u32 m0, m0, 1024
    s_add_u32 s21, s21, 16384
    buffer_load_dwordx4 v11, s[8:11], s21 offen lds
    s_add_u32 m0, m0, 1024
    s_lshl_b32 s21, s17, 17
    s_add_u32 s21, s21, 64
    buffer_load_dwordx4 v11, s[8:11], s21 offen lds
    s_add_u32 m0, m0, 1024
    s_add_u32 s21, s21, 16384
    buffer_load_dwordx4 v11, s[8:11], s21 offen lds
    s_add_u32 m0, m0, 1024
    s_add_u32 s21, s21, 16384
    buffer_load_dwordx4 v11, s[8:11], s21 offen lds
    s_add_u32 m0, m0, 1024
    s_add_u32 s21, s21, 16384
    buffer_load_dwordx4 v11, s[8:11], s21 offen lds
    s_add_u32 m0, m0, 1024
    s_lshl_b32 s21, s17, 17
    s_add_u32 s21, s21, 128
    buffer_load_dwordx4 v11, s[8:11], s21 offen lds
    s_add_u32 m0, m0, 1024
    s_add_u32 s21, s21, 16384
    buffer_load_dwordx4 v11, s[8:11], s21 offen lds
    s_add_u32 m0, m0, 1024
    s_add_u32 s21, s21, 16384
    buffer_load_dwordx4 v11, s[8:11], s21 offen lds
    s_add_u32 m0, m0, 1024
    s_add_u32 s21, s21, 16384
    buffer_load_dwordx4 v11, s[8:11], s21 offen lds
    s_add_u32 m0, m0, 1024
    s_lshl_b32 s21, s17, 17
    s_add_u32 s21, s21, 192
    buffer_load_dwordx4 v11, s[8:11], s21 offen lds
    s_add_u32 m0, m0, 1024
    s_add_u32 s21, s21, 16384
    buffer_load_dwordx4 v11, s[8:11], s21 offen lds
    s_add_u32 m0, m0, 1024
    s_add_u32 s21, s21, 16384
    buffer_load_dwordx4 v11, s[8:11], s21 offen lds
    s_add_u32 m0, m0, 1024
    s_add_u32 s21, s21, 16384
    buffer_load_dwordx4 v11, s[8:11], s21 offen lds
    s_add_u32 m0, m0, 1024
    s_lshl_b32 s21, s17, 17
    s_add_u32 s21, s21, 65536
    buffer_load_dwordx4 v11, s[8:11], s21 offen lds
    s_add_u32 m0, m0, 1024
    s_add_u32 s21, s21, 16384
    buffer_load_dwordx4 v11, s[8:11], s21 offen lds
    s_add_u32 m0, m0, 1024
    s_add_u32 s21, s21, 16384
    buffer_load_dwordx4 v11, s[8:11], s21 offen lds
    s_add_u32 m0, m0, 1024
    s_add_u32 s21, s21, 16384
    buffer_load_dwordx4 v11, s[8:11], s21 offen lds
    s_add_u32 m0, m0, 1024
    s_lshl_b32 s21, s17, 17
    s_add_u32 s21, s21, 65600
    buffer_load_dwordx4 v11, s[8:11], s21 offen lds
    s_add_u32 m0, m0, 1024
    s_add_u32 s21, s21, 16384
    buffer_load_dwordx4 v11, s[8:11], s21 offen lds
    s_add_u32 m0, m0, 1024
    s_add_u32 s21, s21, 16384
    buffer_load_dwordx4 v11, s[8:11], s21 offen lds
    s_add_u32 m0, m0, 1024
    s_add_u32 s21, s21, 16384
    buffer_load_dwordx4 v11, s[8:11], s21 offen lds
    s_add_u32 m0, m0, 1024
    s_lshl_b32 s21, s17, 17
    s_add_u32 s21, s21, 65664
    buffer_load_dwordx4 v11, s[8:11], s21 offen lds
    s_add_u32 m0, m0, 1024
    s_add_u32 s21, s21, 16384
    buffer_load_dwordx4 v11, s[8:11], s21 offen lds
    s_add_u32 m0, m0, 1024
    s_add_u32 s21, s21, 16384
    buffer_load_dwordx4 v11, s[8:11], s21 offen lds
    s_add_u32 m0, m0, 1024
    s_add_u32 s21, s21, 16384
    buffer_load_dwordx4 v11, s[8:11], s21 offen lds
    s_add_u32 m0, m0, 1024
    s_lshl_b32 s21, s17, 17
    s_add_u32 s21, s21, 65728
    buffer_load_dwordx4 v11, s[8:11], s21 offen lds
    s_add_u32 m0, m0, 1024
    s_add_u32 s21, s21, 16384
    buffer_load_dwordx4 v11, s[8:11], s21 offen lds
    s_add_u32 m0, m0, 1024
    s_add_u32 s21, s21, 16384
    buffer_load_dwordx4 v11, s[8:11], s21 offen lds
    s_add_u32 m0, m0, 1024
    s_add_u32 s21, s21, 16384
    buffer_load_dwordx4 v11, s[8:11], s21 offen lds
    s_add_u32 m0, m0, 1024
    s_mov_b32 s8, s50
    s_mov_b32 s9, s51
    s_mov_b32 s10, 0x80000
    s_mov_b32 s11, 0x20000
    s_lshl_b32 s21, s17, 14
    s_add_u32 s21, s21, 0
    buffer_load_dwordx4 v11, s[8:11], s21 offen lds
    s_add_u32 m0, m0, 1024
    s_lshl_b32 s21, s17, 14
    s_add_u32 s21, s21, 64
    buffer_load_dwordx4 v11, s[8:11], s21 offen lds
    s_add_u32 m0, m0, 1024
    s_lshl_b32 s21, s17, 14
    s_add_u32 s21, s21, 128
    buffer_load_dwordx4 v11, s[8:11], s21 offen lds
    s_add_u32 m0, m0, 1024
    s_lshl_b32 s21, s17, 14
    s_add_u32 s21, s21, 192
    buffer_load_dwordx4 v11, s[8:11], s21 offen lds
    s_add_u32 m0, m0, 1024
    s_mov_b32 s12, s54
    s_mov_b32 s13, s55
    s_mov_b32 s14, 0x200000
    s_mov_b32 s15, 0x20000
    v_mov_b32 v26, 0
    v_cmp_le_i32 s[64:65], 0, v22
    v_cmp_le_i32 s[66:67], 1, v22
    v_cmp_le_i32 s[68:69], 2, v22
    v_cmp_le_i32 s[70:71], 3, v22
    v_cmp_le_i32 s[72:73], 16, v22
    v_cmp_le_i32 s[74:75], 17, v22
    v_cmp_le_i32 s[76:77], 18, v22
    v_cmp_le_i32 s[78:79], 19, v22
    s_waitcnt vmcnt(0)
    ds_read_b64_tr_b16 a[0:1], v10 offset:0
    ds_read_b64_tr_b16 a[2:3], v10 offset:1024
    ds_read_b64_tr_b16 a[4:5], v10 offset:2048
    ds_read_b64_tr_b16 a[6:7], v10 offset:3072
    ds_read_b64_tr_b16 a[16:17], v10 offset:8
    ds_read_b64_tr_b16 a[18:19], v10 offset:1032
    ds_read_b64_tr_b16 a[20:21], v10 offset:2056
    ds_read_b64_tr_b16 a[22:23], v10 offset:3080
    ds_read_b64_tr_b16 a[32:33], v10 offset:4096
    ds_read_b64_tr_b16 a[34:35], v10 offset:5120
    ds_read_b64_tr_b16 a[36:37], v10 offset:6144
    ds_read_b64_tr_b16 a[38:39], v10 offset:7168
    ds_read_b64_tr_b16 a[48:49], v10 offset:4104
    ds_read_b64_tr_b16 a[50:51], v10 offset:5128
    ds_read_b64_tr_b16 a[52:53], v10 offset:6152
    ds_read_b64_tr_b16 a[54:55], v10 offset:7176
    ds_read_b64_tr_b16 a[64:65], v10 offset:8192
    ds_read_b64_tr_b16 a[66:67], v10 offset:9216
    ds_read_b64_tr_b16 a[68:69], v10 offset:10240
    ds_read_b64_tr_b16 a[70:71], v10 offset:11264
    ds_read_b64_tr_b16 a[80:81], v10 offset:8200
    ds_read_b64_tr_b16 a[82:83], v10 offset:9224
    ds_read_b64_tr_b16 a[84:85], v10 offset:10248
    ds_read_b64_tr_b16 a[86:87], v10 offset:11272
    ds_read_b64_tr_b16 a[96:97], v10 offset:12288
    ds_read_b64_tr_b16 a[98:99], v10 offset:13312
    ds_read_b64_tr_b16 a[100:101], v10 offset:14336
    ds_read_b64_tr_b16 a[102:103], v10 offset:15360
    ds_read_b64_tr_b16 a[112:113], v10 offset:12296
    ds_read_b64_tr_b16 a[114:115], v10 offset:13320
    ds_read_b64_tr_b16 a[116:117], v10 offset:14344
    ds_read_b64_tr_b16 a[118:119], v10 offset:15368
    ds_read_b64_tr_b16 a[8:9], v10 offset:16384
    ds_read_b64_tr_b16 a[10:11], v10 offset:17408
    ds_read_b64_tr_b16 a[12:13], v10 offset:18432
    ds_read_b64_tr_b16 a[14:15], v10 offset:19456
    ds_read_b64_tr_b16 a[24:25], v10 offset:16392
    ds_read_b64_tr_b16 a[26:27], v10 offset:17416
    ds_read_b64_tr_b16 a[28:29], v10 offset:18440
    ds_read_b64_tr_b16 a[30:31], v10 offset:19464
    ds_read_b64_tr_b16 a[40:41], v10 offset:20480
    ds_read_b64_tr_b16 a[42:43], v10 offset:21504
    ds_read_b64_tr_b16 a[44:45], v10 offset:22528
    ds_read_b64_tr_b16 a[46:47], v10 offset:23552
    ds_read_b64_tr_b16 a[56:57], v10 offset:20488
    ds_read_b64_tr_b16 a[58:59], v10 offset:21512
    ds_read_b64_tr_b16 a[60:61], v10 offset:22536
    ds_read_b64_tr_b16 a[62:63], v10 offset:23560
    ds_read_b64_tr_b16 a[72:73], v10 offset:24576
    ds_read_b64_tr_b16 a[74:75], v10 offset:25600
    ds_read_b64_tr_b16 a[76:77], v10 offset:26624
    ds_read_b64_tr_b16 a[78:79], v10 offset:27648
    ds_read_b64_tr_b16 a[88:89], v10 offset:24584
    ds_read_b64_tr_b16 a[90:91], v10 offset:25608
    ds_read_b64_tr_b16 a[92:93], v10 offset:26632
    ds_read_b64_tr_b16 a[94:95], v10 offset:27656
    ds_read_b64_tr_b16 a[104:105], v10 offset:28672
    ds_read_b64_tr_b16 a[106:107], v10 offset:29696
    ds_read_b64_tr_b16 a[108:109], v10 offset:30720
    ds_read_b64_tr_b16 a[110:111], v10 offset:31744
    ds_read_b64_tr_b16 a[120:121], v10 offset:28680
    ds_read_b64_tr_b16 a[122:123], v10 offset:29704
    ds_read_b64_tr_b16 a[124:125], v10 offset:30728
    ds_read_b64_tr_b16 a[126:127], v10 offset:31752
    ds_read_b64_tr_b16 a[128:129], v10 offset:32768
    ds_read_b64_tr_b16 a[130:131], v10 offset:32776
    ds_read_b64_tr_b16 a[132:133], v10 offset:33792
    ds_read_b64_tr_b16 a[134:135], v10 offset:33800
    ds_read_b64_tr_b16 a[136:137], v10 offset:34816
    ds_read_b64_tr_b16 a[138:139], v10 offset:34824
    ds_read_b64_tr_b16 a[140:141], v10 offset:35840
    ds_read_b64_tr_b16 a[142:143], v10 offset:35848
    s_waitcnt lgkmcnt(0)
    s_sub_u32 s61, s16, 2
    s_mov_b32 s80, 0x3e0293ee
    s_mov_b32 s81, 0xf149f2ca
    s_lshr_b32 s82, s18, 1
    s_and_b32 s83, s18, 1
    s_lshl_b32 s86, s16, 21
    s_add_u32 s86, s86, 0x4800000
L_F_loop:
    s_lshl_b32 s21, s61, 5
    s_add_u32 s21, s21, s17
    s_lshl_b32 s63, s21, 6
    s_mul_i32 s62, s21, 24576
    s_lshl_b32 s84, s21, 12
    s_add_u32 s84, s84, 0x3000000
    s_lshl_b32 s85, s21, 10
    s_add_u32 s85, s85, 0x4000000
    s_add_u32 s88, s63, 0x4300010
    s_lshl_b32 s21, s61, 2
    s_lshr_b32 s22, s17, 3
    s_add_u32 s21, s21, s22
    s_lshl_b32 s21, s21, 6
    s_and_b32 s22, s17, 6
    s_lshl_b32 s22, s22, 1
    s_add_u32 s21, s21, s22
    s_add_u32 s47, s21, 0x4360000
    s_add_u32 s21, s63, 0x4320000
    s_barrier
    buffer_load_dwordx4 v[28:31], v26, s[4:7], s88 offen sc1
    buffer_load_dword v32, v26, s[4:7], s47 offen sc1
    buffer_load_dwordx4 v[36:39], v26, s[4:7], s21 offen sc1
    s_waitcnt vmcnt(2)
    v_min3_u32 v28, v28, v29, v30
    s_waitcnt vmcnt(1)
    v_min3_u32 v28, v28, v31, v32
    s_waitcnt vmcnt(0)
    v_min_u32 v36, v36, v37
    v_min3_u32 v36, v36, v38, v39
    s_nop 0
    v_readfirstlane_b32 s46, v36
    v_cmp_eq_u32 vcc, 0, v28
    s_cmp_ge_u32 s61, 61
    s_cselect_b32 s46, 0, s46
    s_cbranch_vccz L_F_have
    s_mov_b32 s23, s60
L_s4_33:
    buffer_load_dwordx4 v[28:31], v26, s[4:7], s88 offen sc1
    s_waitcnt vmcnt(0)
    s_waitcnt vmcnt(0)
    v_min_u32 v28, v28, v29
    v_min3_u32 v28, v28, v30, v31
    v_cmp_eq_u32 vcc, 0, v28
    s_cbranch_vccz L_s4ok_34
    s_sleep 2
    s_sub_u32 s23, s23, 1
    s_cbranch_scc0 L_s4_33
    s_mov_b32 s60, 0x400
L_s4ok_34:
    s_mov_b32 s23, s60
L_s4_35:
    buffer_load_dword v28, v26, s[4:7], s47 offen sc1
    s_waitcnt vmcnt(0)
    s_waitcnt vmcnt(0)
    v_cmp_eq_u32 vcc, 0, v28
    s_cbranch_vccz L_s4ok_36
    s_sleep 2
    s_sub_u32 s23, s23, 1
    s_cbranch_scc0 L_s4_35
    s_mov_b32 s60, 0x400
L_s4ok_36:
L_F_have:
    s_lshl_b32 s87, s61, 2
    s_add_u32 s87, s87, s18
    s_lshl_b32 s87, s87, 5
    s_add_u32 s87, s87, s17
    s_lshl_b32 s87, s87, 2
    s_add_u32 s87, s87, 0x4340000
    s_cmp_eq_u32 s89, 0
    s_cselect_b32 s21, 0x40000000, s87
    buffer_load_dword v252, v1, s[4:7], s21 offen
    buffer_load_dwordx2 v[112:113], v9, s[4:7], s85 offen offset:0 sc1
    buffer_load_dwordx2 v[114:115], v9, s[4:7], s85 offen offset:512 sc1
    s_lshl_b32 s22, s82, 10
    s_add_u32 s22, s22, 4096
    s_add_u32 s22, s22, s62
    s_mov_b32 s21, s62
    buffer_load_dwordx4 v[28:31], v0, s[4:7], s22 offen sc1
    buffer_load_dwordx4 v[44:47], v0, s[4:7], s21 offen sc1
    buffer_load_dwordx4 v[60:63], v0, s[4:7], s21 offen offset:1024 sc1
    s_add_u32 s21, s21, 6144
    s_add_u32 s22, s22, 6144
    buffer_load_dwordx4 v[32:35], v0, s[4:7], s22 offen sc1
    buffer_load_dwordx4 v[48:51], v0, s[4:7], s21 offen sc1
    buffer_load_dwordx4 v[64:67], v0, s[4:7], s21 offen offset:1024 sc1
    s_add_u32 s21, s21, 6144
    s_add_u32 s22, s22, 6144
    buffer_load_dwordx4 v[36:39], v0, s[4:7], s22 offen sc1
    buffer_load_dwordx4 v[52:55], v0, s[4:7], s21 offen sc1
    buffer_load_dwordx4 v[68:71], v0, s[4:7], s21 offen offset:1024 sc1
    s_add_u32 s21, s21, 6144
    s_add_u32 s22, s22, 6144
    buffer_load_dwordx4 v[40:43], v0, s[4:7], s22 offen sc1
    buffer_load_dwordx4 v[56:59], v0, s[4:7], s21 offen sc1
    buffer_load_dwordx4 v[72:75], v0, s[4:7], s21 offen offset:1024 sc1
    s_mul_i32 s21, s83, 12288
    s_add_u32 s21, s21, s62
    s_add_u32 s22, s21, 6144
    buffer_load_dwordx4 v[76:79], v0, s[4:7], s21 offen offset:2048 sc1
    buffer_load_dwordx4 v[80:83], v0, s[4:7], s21 offen offset:3072 sc1
    buffer_load_dwordx4 v[84:87], v0, s[4:7], s22 offen offset:2048 sc1
    buffer_load_dwordx4 v[88:91], v0, s[4:7], s22 offen offset:3072 sc1
    s_lshl_b32 s21, s61, 7
    s_lshl_b32 s22, s82, 6
    s_add_u32 s21, s21, s22
    s_add_u32 s21, s21, 0x4200000
    buffer_load_dword v116, v8, s[4:7], s21 offen sc1
    s_cmp_ge_u32 s61, 61
    s_cselect_b32 s22, 0xd00000, 0
    s_add_u32 s84, s84, s22
    s_lshl_b32 s85, s83, 11
    s_add_u32 s85, s85, s84
    s_cmp_eq_u32 s46, 0
    s_cbranch_scc1 L_F_nokm
    buffer_load_dwordx4 v[92:95], v0, s[4:7], s84 offen offset:0 sc1
    buffer_load_dwordx4 v[96:99], v0, s[4:7], s84 offen offset:1024 sc1
    buffer_load_dwordx4 v[100:103], v0, s[4:7], s84 offen offset:2048 sc1
    buffer_load_dwordx4 v[104:107], v0, s[4:7], s84 offen offset:3072 sc1
    buffer_load_dwordx2 v[108:109], v23, s[4:7], s85 offen offset:0 sc1
    buffer_load_dwordx2 v[110:111], v23, s[4:7], s85 offen offset:1024 sc1
L_F_nokm:
    s_waitcnt vmcnt(18)
    v_mfma_f32_16x16x16_bf16 v[188:191], a[128:129], v[112:113], 0
    v_mfma_f32_16x16x16_bf16 v[192:195], a[130:131], v[112:113], 0
    v_mfma_f32_16x16x16_bf16 v[196:199], a[132:133], v[112:113], 0
    v_mfma_f32_16x16x16_bf16 v[200:203], a[134:135], v[112:113], 0
    v_mfma_f32_16x16x16_bf16 v[204:207], a[136:137], v[112:113], 0
    v_mfma_f32_16x16x16_bf16 v[208:211], a[138:139], v[112:113], 0
    v_mfma_f32_16x16x16_bf16 v[212:215], a[140:141], v[112:113], 0
    v_mfma_f32_16x16x16_bf16 v[216:219], a[142:143], v[112:113], 0
    s_waitcnt vmcnt(17)
    v_mfma_f32_16x16x16_bf16 v[220:223], a[128:129], v[114:115], 0
    v_mfma_f32_16x16x16_bf16 v[224:227], a[130:131], v[114:115], 0
    v_mfma_f32_16x16x16_bf16 v[228:231], a[132:133], v[114:115], 0
    v_mfma_f32_16x16x16_bf16 v[232:235], a[134:135], v[114:115], 0
    v_mfma_f32_16x16x16_bf16 v[236:239], a[136:137], v[114:115], 0
    v_mfma_f32_16x16x16_bf16 v[240:243], a[138:139], v[114:115], 0
    v_mfma_f32_16x16x16_bf16 v[244:247], a[140:141], v[114:115], 0
    v_mfma_f32_16x16x16_bf16 v[248:251], a[142:143], v[114:115], 0
    s_waitcnt vmcnt(15)
    v_mfma_f32_16x16x32_bf16 v[120:123], v[44:47], v[28:31], 0
    s_waitcnt vmcnt(14)
    v_mfma_f32_16x16x32_bf16 v[124:127], v[60:63], v[28:31], 0
    s_waitcnt vmcnt(12)
    v_mfma_f32_16x16x32_bf16 v[120:123], v[48:51], v[32:35], v[120:123]
    s_waitcnt vmcnt(11)
    v_mfma_f32_16x16x32_bf16 v[124:127], v[64:67], v[32:35], v[124:127]
    s_waitcnt vmcnt(9)
    v_mfma_f32_16x16x32_bf16 v[120:123], v[52:55], v[36:39], v[120:123]
    s_waitcnt vmcnt(8)
    v_mfma_f32_16x16x32_bf16 v[124:127], v[68:71], v[36:39], v[124:127]
    s_waitcnt vmcnt(6)
    v_mfma_f32_16x16x32_bf16 v[120:123], v[56:59], v[40:43], v[120:123]
    s_waitcnt vmcnt(5)
    v_mfma_f32_16x16x32_bf16 v[124:127], v[72:75], v[40:43], v[124:127]
    v_mov_b32 v27, s81
    s_nop 4
    v_cndmask_b32 v120, v27, v120, s[64:65]
    v_cndmask_b32 v121, v27, v121, s[66:67]
    v_cndmask_b32 v122, v27, v122, s[68:69]
    v_cndmask_b32 v123, v27, v123, s[70:71]
    v_cndmask_b32 v124, v27, v124, s[72:73]
    v_cndmask_b32 v125, v27, v125, s[74:75]
    v_cndmask_b32 v126, v27, v126, s[76:77]
    v_cndmask_b32 v127, v27, v127, s[78:79]
    v_max3_f32 v117, v120, v121, v122
    v_max3_f32 v117, v117, v123, v124
    v_max3_f32 v117, v117, v125, v126
    v_max_f32 v117, v117, v127
    s_cmp_lg_u32 s46, 0
    s_cbranch_scc1 L_F_kmw
    s_xor_b32 s22, s86, 1048576
    s_lshl_b32 s21, s17, 10
    s_add_u32 s21, s21, s22
    s_lshl_b32 s22, s18, 17
    s_add_u32 s21, s21, s22
    s_cmp_eq_u32 s89, 0
    s_cselect_b32 s21, 0x40000000, s21
    buffer_load_dwordx4 v[156:159], v0, s[4:7], s21 offen
    s_add_u32 s21, s21, 32768
    buffer_load_dwordx4 v[156:159], v0, s[4:7], s21 offen
    s_add_u32 s21, s21, 32768
    buffer_load_dwordx4 v[156:159], v0, s[4:7], s21 offen
    s_add_u32 s21, s21, 32768
    buffer_load_dwordx4 v[156:159], v0, s[4:7], s21 offen
    s_add_u32 s21, s21, 425984
    buffer_load_dwordx4 v[156:159], v0, s[4:7], s21 offen
    s_add_u32 s21, s21, 32768
    buffer_load_dwordx4 v[156:159], v0, s[4:7], s21 offen
    s_add_u32 s21, s21, 32768
    buffer_load_dwordx4 v[156:159], v0, s[4:7], s21 offen
    s_add_u32 s21, s21, 32768
    buffer_load_dwordx4 v[156:159], v0, s[4:7], s21 offen
    s_add_u32 s21, s21, 425984
    s_max_u32 s22, s61, 60
    s_sub_u32 s22, s22, 60
    s_lshr_b32 s21, s22, 1
    s_sub_u32 s22, s22, s21
    s_lshl_b32 s22, s22, 11
    s_add_u32 s21, s63, 0x4320000
    s_sub_u32 s21, s21, s22
    s_mov_b32 s23, s60
L_s4_37:
    buffer_load_dwordx4 v[92:95], v26, s[4:7], s21 offen sc1
    s_waitcnt vmcnt(0)
    v_min_u32 v92, v92, v93
    v_min3_u32 v92, v92, v94, v95
    v_cmp_eq_u32 vcc, 0, v92
    s_cbranch_vccz L_s4ok_38
    s_sleep 4
    s_sub_u32 s23, s23, 1
    s_cbranch_scc0 L_s4_37
    s_mov_b32 s60, 0x400
L_s4ok_38:
    s_mov_b32 s23, 0x8000
L_F_km:
    buffer_load_dwordx4 v[92:95], v0, s[4:7], s84 offen offset:0 sc1
    buffer_load_dwordx4 v[96:99], v0, s[4:7], s84 offen offset:1024 sc1
    buffer_load_dwordx4 v[100:103], v0, s[4:7], s84 offen offset:2048 sc1
    buffer_load_dwordx4 v[104:107], v0, s[4:7], s84 offen offset:3072 sc1
    buffer_load_dwordx2 v[108:109], v23, s[4:7], s85 offen offset:0 sc1
    buffer_load_dwordx2 v[110:111], v23, s[4:7], s85 offen offset:1024 sc1
    s_cmp_lt_u32 s61, 61
    s_cbranch_scc1 L_F_kmw
    s_waitcnt vmcnt(0)
    v_max3_u32 v118, v92, v93, v94
    v_max3_u32 v118, v118, v95, v96
    v_max3_u32 v118, v118, v97, v98
    v_max3_u32 v118, v118, v99, v100
    v_max3_u32 v118, v118, v101, v102
    v_max3_u32 v118, v118, v103, v104
    v_max3_u32 v118, v118, v105, v106
    v_max3_u32 v118, v118, v107, v108
    v_max3_u32 v118, v118, v109, v110
    v_max_u32 v118, v118, v111
    v_cmp_eq_u32 vcc, -1, v118
    s_cbranch_vccz L_F_kmw
    s_sub_u32 s23, s23, 1
    s_cbranch_scc0 L_F_km
L_F_kmw:
    s_waitcnt vmcnt(0)
    v_mfma_f32_16x16x32_bf16 v[128:131], v[92:95], v[28:31], 0
    v_mfma_f32_16x16x32_bf16 v[128:131], v[96:99], v[32:35], v[128:131]
    v_mfma_f32_16x16x32_bf16 v[128:131], v[100:103], v[36:39], v[128:131]
    v_mfma_f32_16x16x32_bf16 v[128:131], v[104:107], v[40:43], v[128:131]
    s_nop 7
    v_max3_f32 v117, v117, v128, v129
    v_mov_b32 v118, v117
    s_nop 1
    v_permlane16_swap_b32 v117, v118
    v_max_f32 v117, v117, v118
    v_mov_b32 v118, v117
    s_nop 1
    v_permlane32_swap_b32 v117, v118
    v_max_f32 v117, v117, v118
    v_mul_f32 v117, s80, v117
    v_fma_f32 v120, v120, s80, -v117
    v_fma_f32 v121, v121, s80, -v117
    v_fma_f32 v122, v122, s80, -v117
    v_fma_f32 v123, v123, s80, -v117
    v_fma_f32 v124, v124, s80, -v117
    v_fma_f32 v125, v125, s80, -v117
    v_fma_f32 v126, v126, s80, -v117
    v_fma_f32 v127, v127, s80, -v117
    v_fma_f32 v128, v128, s80, -v117
    v_fma_f32 v129, v129, s80, -v117
    v_exp_f32 v120, v120
    v_exp_f32 v121, v121
    v_exp_f32 v122, v122
    v_exp_f32 v123, v123
    v_exp_f32 v124, v124
    v_exp_f32 v125, v125
    v_exp_f32 v126, v126
    v_exp_f32 v127, v127
    v_exp_f32 v128, v128
    v_exp_f32 v129, v129
    v_cvt_pk_bf16_f32 v132, v120, v121
    v_cvt_pk_bf16_f32 v133, v122, v123
    v_cvt_pk_bf16_f32 v134, v124, v125
    v_cvt_pk_bf16_f32 v135, v126, v127
    v_cvt_pk_bf16_f32 v136, v128, v129
    v_mov_b32 v137, 0
    v_mov_b32 v138, 0
    v_cvt_pk_bf16_f32 v139, v128, v129
    v_mfma_f32_16x16x16_bf16 v[140:143], v[76:77], v[132:133], 0
    v_mfma_f32_16x16x16_bf16 v[140:143], v[82:83], v[134:135], v[140:143]
    v_mfma_f32_16x16x16_bf16 v[140:143], v[108:109], v[136:137], v[140:143]
    v_mfma_f32_16x16x16_bf16 v[144:147], v[80:81], v[132:133], 0
    v_mfma_f32_16x16x16_bf16 v[144:147], v[78:79], v[134:135], v[144:147]
    v_mfma_f32_16x16x16_bf16 v[144:147], v[108:109], v[138:139], v[144:147]
    v_mfma_f32_16x16x16_bf16 v[148:151], v[84:85], v[132:133], 0
    v_mfma_f32_16x16x16_bf16 v[148:151], v[90:91], v[134:135], v[148:151]
    v_mfma_f32_16x16x16_bf16 v[148:151], v[110:111], v[136:137], v[148:151]
    v_mfma_f32_16x16x16_bf16 v[152:155], v[88:89], v[132:133], 0
    v_mfma_f32_16x16x16_bf16 v[152:155], v[86:87], v[134:135], v[152:155]
    v_mfma_f32_16x16x16_bf16 v[152:155], v[110:111], v[138:139], v[152:155]
    v_add_f32 v119, v120, v121
    v_add_f32 v119, v119, v122
    v_add_f32 v119, v119, v123
    v_add_f32 v119, v119, v124
    v_add_f32 v119, v119, v125
    v_add_f32 v119, v119, v126
    v_add_f32 v119, v119, v127
    v_add_f32 v119, v119, v128
    v_add_f32 v119, v119, v129
    v_mov_b32 v118, v119
    s_nop 1
    v_permlane16_swap_b32 v119, v118
    v_add_f32 v119, v119, v118
    v_mov_b32 v118, v119
    s_nop 1
    v_permlane32_swap_b32 v119, v118
    v_add_f32 v119, v119, v118
    v_rcp_f32 v119, v119
    s_nop 0
    v_mul_f32 v119, v119, v116
    v_mul_f32 v140, v140, v119
    v_mul_f32 v141, v141, v119
    v_mul_f32 v142, v142, v119
    v_mul_f32 v143, v143, v119
    v_mul_f32 v144, v144, v119
    v_mul_f32 v145, v145, v119
    v_mul_f32 v146, v146, v119
    v_mul_f32 v147, v147, v119
    v_mul_f32 v148, v148, v119
    v_mul_f32 v149, v149, v119
    v_mul_f32 v150, v150, v119
    v_mul_f32 v151, v151, v119
    v_mul_f32 v152, v152, v119
    v_mul_f32 v153, v153, v119
    v_mul_f32 v154, v154, v119
    v_mul_f32 v155, v155, v119
    v_cvt_pk_bf16_f32 v140, v140, v141
    v_cvt_pk_bf16_f32 v141, v142, v143
    v_cvt_pk_bf16_f32 v142, v144, v145
    v_cvt_pk_bf16_f32 v143, v146, v147
    v_cvt_pk_bf16_f32 v144, v148, v149
    v_cvt_pk_bf16_f32 v145, v150, v151
    v_cvt_pk_bf16_f32 v146, v152, v153
    v_cvt_pk_bf16_f32 v147, v154, v155
    ds_write_b128 v20, v[140:143] offset:0
    ds_write_b128 v20, v[144:147] offset:1024
    s_waitcnt lgkmcnt(0)
    s_barrier
    ds_read_b128 v[156:159], v21 offset:0
    ds_read_b128 v[160:163], v21 offset:1024
    ds_read_b128 v[164:167], v21 offset:2048
    ds_read_b128 v[168:171], v21 offset:3072
    ds_read_b128 v[172:175], v21 offset:4096
    ds_read_b128 v[176:179], v21 offset:5120
    ds_read_b128 v[180:183], v21 offset:6144
    ds_read_b128 v[184:187], v21 offset:7168
    s_xor_b32 s86, s86, 1048576
    s_lshl_b32 s21, s17, 10
    s_add_u32 s21, s21, s86
    s_lshl_b32 s22, s18, 17
    s_add_u32 s21, s21, s22
    s_cmp_eq_u32 s89, 0
    s_cbranch_scc1 L_F_slowst
    s_waitcnt lgkmcnt(7)
    v_mfma_f32_16x16x32_bf16 v[188:191], a[0:3], v[156:159], v[188:191]
    v_mfma_f32_16x16x32_bf16 v[192:195], a[16:19], v[156:159], v[192:195]
    s_waitcnt lgkmcnt(6)
    v_mfma_f32_16x16x32_bf16 v[188:191], a[4:7], v[160:163], v[188:191]
    v_mfma_f32_16x16x32_bf16 v[192:195], a[20:23], v[160:163], v[192:195]
    s_waitcnt lgkmcnt(5)
    v_mfma_f32_16x16x32_bf16 v[188:191], a[8:11], v[164:167], v[188:191]
    v_mfma_f32_16x16x32_bf16 v[192:195], a[24:27], v[164:167], v[192:195]
    s_waitcnt lgkmcnt(4)
    v_mfma_f32_16x16x32_bf16 v[188:191], a[12:15], v[168:171], v[188:191]
    v_mfma_f32_16x16x32_bf16 v[192:195], a[28:31], v[168:171], v[192:195]
    v_mfma_f32_16x16x32_bf16 v[196:199], a[32:35], v[156:159], v[196:199]
    v_mfma_f32_16x16x32_bf16 v[200:203], a[48:51], v[156:159], v[200:203]
    v_mfma_f32_16x16x32_bf16 v[196:199], a[36:39], v[160:163], v[196:199]
    v_mfma_f32_16x16x32_bf16 v[200:203], a[52:55], v[160:163], v[200:203]
    v_mfma_f32_16x16x32_bf16 v[196:199], a[40:43], v[164:167], v[196:199]
    v_mfma_f32_16x16x32_bf16 v[200:203], a[56:59], v[164:167], v[200:203]
    v_mfma_f32_16x16x32_bf16 v[196:199], a[44:47], v[168:171], v[196:199]
    v_mfma_f32_16x16x32_bf16 v[200:203], a[60:63], v[168:171], v[200:203]
    v_cvt_pk_bf16_f32 v188, v188, v189
    v_cvt_pk_bf16_f32 v189, v190, v191
    v_cvt_pk_bf16_f32 v190, v192, v193
    v_cvt_pk_bf16_f32 v191, v194, v195
    buffer_store_dwordx4 v[188:191], v0, s[4:7], s21 offen
    s_add_u32 s21, s21, 32768
    v_mfma_f32_16x16x32_bf16 v[204:207], a[64:67], v[156:159], v[204:207]
    v_mfma_f32_16x16x32_bf16 v[208:211], a[80:83], v[156:159], v[208:211]
    v_mfma_f32_16x16x32_bf16 v[204:207], a[68:71], v[160:163], v[204:207]
    v_mfma_f32_16x16x32_bf16 v[208:211], a[84:87], v[160:163], v[208:211]
    v_mfma_f32_16x16x32_bf16 v[204:207], a[72:75], v[164:167], v[204:207]
    v_mfma_f32_16x16x32_bf16 v[208:211], a[88:91], v[164:167], v[208:211]
    v_mfma_f32_16x16x32_bf16 v[204:207], a[76:79], v[168:171], v[204:207]
    v_mfma_f32_16x16x32_bf16 v[208:211], a[92:95], v[168:171], v[208:211]
    v_cvt_pk_bf16_f32 v196, v196, v197
    v_cvt_pk_bf16_f32 v197, v198, v199
    v_cvt_pk_bf16_f32 v198, v200, v201
    v_cvt_pk_bf16_f32 v199, v202, v203
    buffer_store_dwordx4 v[196:199], v0, s[4:7], s21 offen
    s_add_u32 s21, s21, 32768
    v_mfma_f32_16x16x32_bf16 v[212:215], a[96:99], v[156:159], v[212:215]
    v_mfma_f32_16x16x32_bf16 v[216:219], a[112:115], v[156:159], v[216:219]
    v_mfma_f32_16x16x32_bf16 v[212:215], a[100:103], v[160:163], v[212:215]
    v_mfma_f32_16x16x32_bf16 v[216:219], a[116:119], v[160:163], v[216:219]
    v_mfma_f32_16x16x32_bf16 v[212:215], a[104:107], v[164:167], v[212:215]
    v_mfma_f32_16x16x32_bf16 v[216:219], a[120:123], v[164:167], v[216:219]
    v_mfma_f32_16x16x32_bf16 v[212:215], a[108:111], v[168:171], v[212:215]
    v_mfma_f32_16x16x32_bf16 v[216:219], a[124:127], v[168:171], v[216:219]
    v_cvt_pk_bf16_f32 v204, v204, v205
    v_cvt_pk_bf16_f32 v205, v206, v207
    v_cvt_pk_bf16_f32 v206, v208, v209
    v_cvt_pk_bf16_f32 v207, v210, v211
    buffer_store_dwordx4 v[204:207], v0, s[4:7], s21 offen
    s_add_u32 s21, s21, 32768
    s_waitcnt lgkmcnt(3)
    v_mfma_f32_16x16x32_bf16 v[220:223], a[0:3], v[172:175], v[220:223]
    v_mfma_f32_16x16x32_bf16 v[224:227], a[16:19], v[172:175], v[224:227]
    s_waitcnt lgkmcnt(2)
    v_mfma_f32_16x16x32_bf16 v[220:223], a[4:7], v[176:179], v[220:223]
    v_mfma_f32_16x16x32_bf16 v[224:227], a[20:23], v[176:179], v[224:227]
    s_waitcnt lgkmcnt(1)
    v_mfma_f32_16x16x32_bf16 v[220:223], a[8:11], v[180:183], v[220:223]
    v_mfma_f32_16x16x32_bf16 v[224:227], a[24:27], v[180:183], v[224:227]
    s_waitcnt lgkmcnt(0)
    v_mfma_f32_16x16x32_bf16 v[220:223], a[12:15], v[184:187], v[220:223]
    v_mfma_f32_16x16x32_bf16 v[224:227], a[28:31], v[184:187], v[224:227]
    v_cvt_pk_bf16_f32 v212, v212, v213
    v_cvt_pk_bf16_f32 v213, v214, v215
    v_cvt_pk_bf16_f32 v214, v216, v217
    v_cvt_pk_bf16_f32 v215, v218, v219
    buffer_store_dwordx4 v[212:215], v0, s[4:7], s21 offen
    s_add_u32 s21, s21, 425984
    v_mfma_f32_16x16x32_bf16 v[228:231], a[32:35], v[172:175], v[228:231]
    v_mfma_f32_16x16x32_bf16 v[232:235], a[48:51], v[172:175], v[232:235]
    v_mfma_f32_16x16x32_bf16 v[228:231], a[36:39], v[176:179], v[228:231]
    v_mfma_f32_16x16x32_bf16 v[232:235], a[52:55], v[176:179], v[232:235]
    v_mfma_f32_16x16x32_bf16 v[228:231], a[40:43], v[180:183], v[228:231]
    v_mfma_f32_16x16x32_bf16 v[232:235], a[56:59], v[180:183], v[232:235]
    v_mfma_f32_16x16x32_bf16 v[228:231], a[44:47], v[184:187], v[228:231]
    v_mfma_f32_16x16x32_bf16 v[232:235], a[60:63], v[184:187], v[232:235]
    v_cvt_pk_bf16_f32 v220, v220, v221
    v_cvt_pk_bf16_f32 v221, v222, v223
    v_cvt_pk_bf16_f32 v222, v224, v225
    v_cvt_pk_bf16_f32 v223, v226, v227
    buffer_store_dwordx4 v[220:223], v0, s[4:7], s21 offen
    s_add_u32 s21, s21, 32768
    v_mfma_f32_16x16x32_bf16 v[236:239], a[64:67], v[172:175], v[236:239]
    v_mfma_f32_16x16x32_bf16 v[240:243], a[80:83], v[172:175], v[240:243]
    v_mfma_f32_16x16x32_bf16 v[236:239], a[68:71], v[176:179], v[236:239]
    v_mfma_f32_16x16x32_bf16 v[240:243], a[84:87], v[176:179], v[240:243]
    v_mfma_f32_16x16x32_bf16 v[236:239], a[72:75], v[180:183], v[236:239]
    v_mfma_f32_16x16x32_bf16 v[240:243], a[88:91], v[180:183], v[240:243]
    v_mfma_f32_16x16x32_bf16 v[236:239], a[76:79], v[184:187], v[236:239]
    v_mfma_f32_16x16x32_bf16 v[240:243], a[92:95], v[184:187], v[240:243]
    v_cvt_pk_bf16_f32 v228, v228, v229
    v_cvt_pk_bf16_f32 v229, v230, v231
    v_cvt_pk_bf16_f32 v230, v232, v233
    v_cvt_pk_bf16_f32 v231, v234, v235
    buffer_store_dwordx4 v[228:231], v0, s[4:7], s21 offen
    s_add_u32 s21, s21, 32768
    v_mfma_f32_16x16x32_bf16 v[244:247], a[96:99], v[172:175], v[244:247]
    v_mfma_f32_16x16x32_bf16 v[248:251], a[112:115], v[172:175], v[248:251]
    v_mfma_f32_16x16x32_bf16 v[244:247], a[100:103], v[176:179], v[244:247]
    v_mfma_f32_16x16x32_bf16 v[248:251], a[116:119], v[176:179], v[248:251]
    v_mfma_f32_16x16x32_bf16 v[244:247], a[104:107], v[180:183], v[244:247]
    v_mfma_f32_16x16x32_bf16 v[248:251], a[120:123], v[180:183], v[248:251]
    v_mfma_f32_16x16x32_bf16 v[244:247], a[108:111], v[184:187], v[244:247]
    v_mfma_f32_16x16x32_bf16 v[248:251], a[124:127], v[184:187], v[248:251]
    v_cvt_pk_bf16_f32 v236, v236, v237
    v_cvt_pk_bf16_f32 v237, v238, v239
    v_cvt_pk_bf16_f32 v238, v240, v241
    v_cvt_pk_bf16_f32 v239, v242, v243
    buffer_store_dwordx4 v[236:239], v0, s[4:7], s21 offen
    s_add_u32 s21, s21, 32768
    s_nop 0
    v_cvt_pk_bf16_f32 v244, v244, v245
    v_cvt_pk_bf16_f32 v245, v246, v247
    v_cvt_pk_bf16_f32 v246, v248, v249
    v_cvt_pk_bf16_f32 v247, v250, v251
    buffer_store_dwordx4 v[244:247], v0, s[4:7], s21 offen
    s_add_u32 s21, s21, 425984
    s_waitcnt vmcnt(0)
    buffer_store_dword v21, v1, s[4:7], s87 offen
    s_branch L_F_stdone
L_F_slowst:
    s_waitcnt lgkmcnt(7)
    v_mfma_f32_16x16x32_bf16 v[188:191], a[0:3], v[156:159], v[188:191]
    v_mfma_f32_16x16x32_bf16 v[192:195], a[16:19], v[156:159], v[192:195]
    s_waitcnt lgkmcnt(6)
    v_mfma_f32_16x16x32_bf16 v[188:191], a[4:7], v[160:163], v[188:191]
    v_mfma_f32_16x16x32_bf16 v[192:195], a[20:23], v[160:163], v[192:195]
    s_waitcnt lgkmcnt(5)
    v_mfma_f32_16x16x32_bf16 v[188:191], a[8:11], v[164:167], v[188:191]
    v_mfma_f32_16x16x32_bf16 v[192:195], a[24:27], v[164:167], v[192:195]
    s_waitcnt lgkmcnt(4)
    v_mfma_f32_16x16x32_bf16 v[188:191], a[12:15], v[168:171], v[188:191]
    v_mfma_f32_16x16x32_bf16 v[192:195], a[28:31], v[168:171], v[192:195]
    v_mfma_f32_16x16x32_bf16 v[196:199], a[32:35], v[156:159], v[196:199]
    v_mfma_f32_16x16x32_bf16 v[200:203], a[48:51], v[156:159], v[200:203]
    v_mfma_f32_16x16x32_bf16 v[196:199], a[36:39], v[160:163], v[196:199]
    v_mfma_f32_16x16x32_bf16 v[200:203], a[52:55], v[160:163], v[200:203]
    v_mfma_f32_16x16x32_bf16 v[196:199], a[40:43], v[164:167], v[196:199]
    v_mfma_f32_16x16x32_bf16 v[200:203], a[56:59], v[164:167], v[200:203]
    v_mfma_f32_16x16x32_bf16 v[196:199], a[44:47], v[168:171], v[196:199]
    v_mfma_f32_16x16x32_bf16 v[200:203], a[60:63], v[168:171], v[200:203]
    v_cvt_pk_bf16_f32 v188, v188, v189
    v_cvt_pk_bf16_f32 v189, v190, v191
    v_cvt_pk_bf16_f32 v190, v192, v193
    v_cvt_pk_bf16_f32 v191, v194, v195
    buffer_store_dwordx4 v[188:191], v0, s[4:7], s21 offen sc1
    s_add_u32 s21, s21, 32768
    v_mfma_f32_16x16x32_bf16 v[204:207], a[64:67], v[156:159], v[204:207]
    v_mfma_f32_16x16x32_bf16 v[208:211], a[80:83], v[156:159], v[208:211]
    v_mfma_f32_16x16x32_bf16 v[204:207], a[68:71], v[160:163], v[204:207]
    v_mfma_f32_16x16x32_bf16 v[208:211], a[84:87], v[160:163], v[208:211]
    v_mfma_f32_16x16x32_bf16 v[204:207], a[72:75], v[164:167], v[204:207]
    v_mfma_f32_16x16x32_bf16 v[208:211], a[88:91], v[164:167], v[208:211]
    v_mfma_f32_16x16x32_bf16 v[204:207], a[76:79], v[168:171], v[204:207]
    v_mfma_f32_16x16x32_bf16 v[208:211], a[92:95], v[168:171], v[208:211]
    v_cvt_pk_bf16_f32 v196, v196, v197
    v_cvt_pk_bf16_f32 v197, v198, v199
    v_cvt_pk_bf16_f32 v198, v200, v201
    v_cvt_pk_bf16_f32 v199, v202, v203
    buffer_store_dwordx4 v[196:199], v0, s[4:7], s21 offen sc1
    s_add_u32 s21, s21, 32768
    v_mfma_f32_16x16x32_bf16 v[212:215], a[96:99], v[156:159], v[212:215]
    v_mfma_f32_16x16x32_bf16 v[216:219], a[112:115], v[156:159], v[216:219]
    v_mfma_f32_16x16x32_bf16 v[212:215], a[100:103], v[160:163], v[212:215]
    v_mfma_f32_16x16x32_bf16 v[216:219], a[116:119], v[160:163], v[216:219]
    v_mfma_f32_16x16x32_bf16 v[212:215], a[104:107], v[164:167], v[212:215]
    v_mfma_f32_16x16x32_bf16 v[216:219], a[120:123], v[164:167], v[216:219]
    v_mfma_f32_16x16x32_bf16 v[212:215], a[108:111], v[168:171], v[212:215]
    v_mfma_f32_16x16x32_bf16 v[216:219], a[124:127], v[168:171], v[216:219]
    v_cvt_pk_bf16_f32 v204, v204, v205
    v_cvt_pk_bf16_f32 v205, v206, v207
    v_cvt_pk_bf16_f32 v206, v208, v209
    v_cvt_pk_bf16_f32 v207, v210, v211
    buffer_store_dwordx4 v[204:207], v0, s[4:7], s21 offen sc1
    s_add_u32 s21, s21, 32768
    s_waitcnt lgkmcnt(3)
    v_mfma_f32_16x16x32_bf16 v[220:223], a[0:3], v[172:175], v[220:223]
    v_mfma_f32_16x16x32_bf16 v[224:227], a[16:19], v[172:175], v[224:227]
    s_waitcnt lgkmcnt(2)
    v_mfma_f32_16x16x32_bf16 v[220:223], a[4:7], v[176:179], v[220:223]
    v_mfma_f32_16x16x32_bf16 v[224:227], a[20:23], v[176:179], v[224:227]
    s_waitcnt lgkmcnt(1)
    v_mfma_f32_16x16x32_bf16 v[220:223], a[8:11], v[180:183], v[220:223]
    v_mfma_f32_16x16x32_bf16 v[224:227], a[24:27], v[180:183], v[224:227]
    s_waitcnt lgkmcnt(0)
    v_mfma_f32_16x16x32_bf16 v[220:223], a[12:15], v[184:187], v[220:223]
    v_mfma_f32_16x16x32_bf16 v[224:227], a[28:31], v[184:187], v[224:227]
    v_cvt_pk_bf16_f32 v212, v212, v213
    v_cvt_pk_bf16_f32 v213, v214, v215
    v_cvt_pk_bf16_f32 v214, v216, v217
    v_cvt_pk_bf16_f32 v215, v218, v219
    buffer_store_dwordx4 v[212:215], v0, s[4:7], s21 offen sc1
    s_add_u32 s21, s21, 425984
    v_mfma_f32_16x16x32_bf16 v[228:231], a[32:35], v[172:175], v[228:231]
    v_mfma_f32_16x16x32_bf16 v[232:235], a[48:51], v[172:175], v[232:235]
    v_mfma_f32_16x16x32_bf16 v[228:231], a[36:39], v[176:179], v[228:231]
    v_mfma_f32_16x16x32_bf16 v[232:235], a[52:55], v[176:179], v[232:235]
    v_mfma_f32_16x16x32_bf16 v[228:231], a[40:43], v[180:183], v[228:231]
    v_mfma_f32_16x16x32_bf16 v[232:235], a[56:59], v[180:183], v[232:235]
    v_mfma_f32_16x16x32_bf16 v[228:231], a[44:47], v[184:187], v[228:231]
    v_mfma_f32_16x16x32_bf16 v[232:235], a[60:63], v[184:187], v[232:235]
    v_cvt_pk_bf16_f32 v220, v220, v221
    v_cvt_pk_bf16_f32 v221, v222, v223
    v_cvt_pk_bf16_f32 v222, v224, v225
    v_cvt_pk_bf16_f32 v223, v226, v227
    buffer_store_dwordx4 v[220:223], v0, s[4:7], s21 offen sc1
    s_add_u32 s21, s21, 32768
    v_mfma_f32_16x16x32_bf16 v[236:239], a[64:67], v[172:175], v[236:239]
    v_mfma_f32_16x16x32_bf16 v[240:243], a[80:83], v[172:175], v[240:243]
    v_mfma_f32_16x16x32_bf16 v[236:239], a[68:71], v[176:179], v[236:239]
    v_mfma_f32_16x16x32_bf16 v[240:243], a[84:87], v[176:179], v[240:243]
    v_mfma_f32_16x16x32_bf16 v[236:239], a[72:75], v[180:183], v[236:239]
    v_mfma_f32_16x16x32_bf16 v[240:243], a[88:91], v[180:183], v[240:243]
    v_mfma_f32_16x16x32_bf16 v[236:239], a[76:79], v[184:187], v[236:239]
    v_mfma_f32_16x16x32_bf16 v[240:243], a[92:95], v[184:187], v[240:243]
    v_cvt_pk_bf16_f32 v228, v228, v229
    v_cvt_pk_bf16_f32 v229, v230, v231
    v_cvt_pk_bf16_f32 v230, v232, v233
    v_cvt_pk_bf16_f32 v231, v234, v235
    buffer_store_dwordx4 v[228:231], v0, s[4:7], s21 offen sc1
    s_add_u32 s21, s21, 32768
    v_mfma_f32_16x16x32_bf16 v[244:247], a[96:99], v[172:175], v[244:247]
    v_mfma_f32_16x16x32_bf16 v[248:251], a[112:115], v[172:175], v[248:251]
    v_mfma_f32_16x16x32_bf16 v[244:247], a[100:103], v[176:179], v[244:247]
    v_mfma_f32_16x16x32_bf16 v[248:251], a[116:119], v[176:179], v[248:251]
    v_mfma_f32_16x16x32_bf16 v[244:247], a[104:107], v[180:183], v[244:247]
    v_mfma_f32_16x16x32_bf16 v[248:251], a[120:123], v[180:183], v[248:251]
    v_mfma_f32_16x16x32_bf16 v[244:247], a[108:111], v[184:187], v[244:247]
    v_mfma_f32_16x16x32_bf16 v[248:251], a[124:127], v[184:187], v[248:251]
    v_cvt_pk_bf16_f32 v236, v236, v237
    v_cvt_pk_bf16_f32 v237, v238, v239
    v_cvt_pk_bf16_f32 v238, v240, v241
    v_cvt_pk_bf16_f32 v239, v242, v243
    buffer_store_dwordx4 v[236:239], v0, s[4:7], s21 offen sc1
    s_add_u32 s21, s21, 32768
    s_nop 0
    v_cvt_pk_bf16_f32 v244, v244, v245
    v_cvt_pk_bf16_f32 v245, v246, v247
    v_cvt_pk_bf16_f32 v246, v248, v249
    v_cvt_pk_bf16_f32 v247, v250, v251
    buffer_store_dwordx4 v[244:247], v0, s[4:7], s21 offen sc1
    s_add_u32 s21, s21, 425984
    s_waitcnt vmcnt(0)
    buffer_store_dword v21, v1, s[4:7], s87 offen sc1
L_F_stdone:
    s_lshl_b32 s21, s61, 9
    s_and_b32 s22, s17, 12
    s_lshl_b32 s22, s22, 5
    s_add_u32 s21, s21, s22
    s_add_u32 s21, s21, 0x4340000
    s_mov_b32 s23, s60
L_s4_39:
    buffer_load_dword v28, v15, s[4:7], s21 offen sc1
    s_waitcnt vmcnt(0)
    s_waitcnt vmcnt(0)
    v_cmp_eq_u32 vcc, 0, v28
    s_cbranch_vccz L_s4ok_40
    s_sub_u32 s23, s23, 1
    s_cbranch_scc0 L_s4_39
    s_mov_b32 s60, 0x400
L_s4ok_40:
    s_lshl_b32 s21, s17, 15
    s_add_u32 s21, s21, s86
    buffer_load_dwordx4 v[28:31], v13, s[4:7], s21 offen sc1
    s_add_u32 s21, s21, 4096
    buffer_load_dwordx4 v[32:35], v13, s[4:7], s21 offen sc1
    s_add_u32 s21, s21, 4096
    buffer_load_dwordx4 v[36:39], v13, s[4:7], s21 offen sc1
    s_add_u32 s21, s21, 4096
    buffer_load_dwordx4 v[40:43], v13, s[4:7], s21 offen sc1
    s_add_u32 s21, s21, 4096
    buffer_load_dwordx4 v[44:47], v13, s[4:7], s21 offen sc1
    s_add_u32 s21, s21, 4096
    buffer_load_dwordx4 v[48:51], v13, s[4:7], s21 offen sc1
    s_add_u32 s21, s21, 4096
    buffer_load_dwordx4 v[52:55], v13, s[4:7], s21 offen sc1
    s_add_u32 s21, s21, 4096
    buffer_load_dwordx4 v[56:59], v13, s[4:7], s21 offen sc1
    s_waitcnt vmcnt(7)
    v_mfma_f32_16x16x32_bf16 v[120:123], v[16:19], v[28:31], 0
    s_waitcnt vmcnt(6)
    v_mfma_f32_16x16x32_bf16 v[120:123], v[16:19], v[32:35], v[120:123]
    s_waitcnt vmcnt(5)
    v_mfma_f32_16x16x32_bf16 v[120:123], v[16:19], v[36:39], v[120:123]
    s_waitcnt vmcnt(4)
    v_mfma_f32_16x16x32_bf16 v[120:123], v[16:19], v[40:43], v[120:123]
    s_waitcnt vmcnt(3)
    v_mfma_f32_16x16x32_bf16 v[120:123], v[16:19], v[44:47], v[120:123]
    s_waitcnt vmcnt(2)
    v_mfma_f32_16x16x32_bf16 v[120:123], v[16:19], v[48:51], v[120:123]
    s_waitcnt vmcnt(1)
    v_mfma_f32_16x16x32_bf16 v[120:123], v[16:19], v[52:55], v[120:123]
    s_waitcnt vmcnt(0)
    v_mfma_f32_16x16x32_bf16 v[120:123], v[16:19], v[56:59], v[120:123]
    s_lshl_b32 s21, s61, 5
    s_and_b32 s22, s17, 16
    s_add_u32 s21, s21, s22
    s_lshl_b32 s21, s21, 10
    s_and_b32 s22, s17, 15
    s_lshl_b32 s22, s22, 6
    s_add_u32 s21, s21, s22
    s_nop 0
    v_cvt_pk_bf16_f32 v120, v120, v121
    v_cvt_pk_bf16_f32 v121, v122, v123
    buffer_store_dwordx2 v[120:121], v14, s[12:15], s21 offen
    s_add_u32 s61, s61, 6
    s_cmp_lt_u32 s61, 64
    s_cbranch_scc1 L_F_loop
    s_waitcnt vmcnt(0)
    s_endpgm
    s_mov_b32 s12, s56
    s_mov_b32 s13, s57
    s_mov_b32 s14, 0x100
    s_mov_b32 s15, 0x20000
L_reclaim:
    s_waitcnt vmcnt(0)
    s_barrier
    s_mov_b32 s12, s56
    s_mov_b32 s13, s57
    s_mov_b32 s14, 256
    s_mov_b32 s15, 0x20000
    v_mov_b32 v4, 0x40000000
    v_cmp_ne_u32 vcc, 0, v0
    s_cmp_lg_u32 s18, 0
    s_cbranch_scc1 L_rc_done
    v_mov_b32 v2, s29
    v_cndmask_b32 v2, v2, v4, vcc
    v_mov_b32 v63, 1
    buffer_atomic_add v63, v2, s[12:15], 0 offen offset:8 sc0
    v_and_b32 v2, 7, v0
    v_mul_u32_u24 v61, 24, v2
    v_add_u32 v61, 40, v61
    v_cmp_eq_u32 vcc, 0, v2
    s_nop 1
    v_cndmask_b32 v61, v61, v2, vcc
    s_waitcnt vmcnt(0)
    v_readfirstlane_b32 s28, v63
    s_mov_b32 s21, s60
L_ov_poll:
    buffer_load_dword v60, v61, s[12:15], 0 offen sc1
    buffer_load_dword v63, v61, s[12:15], 0 offen offset:8 sc1
    s_waitcnt vmcnt(0)
    s_mov_b32 s22, 0
    v_readlane_b32 s64, v60, 0
    v_readlane_b32 s72, v63, 0
    v_readlane_b32 s65, v60, 1
    v_readlane_b32 s73, v63, 1
    v_readlane_b32 s66, v60, 2
    v_readlane_b32 s74, v63, 2
    v_readlane_b32 s67, v60, 3
    v_readlane_b32 s75, v63, 3
    v_readlane_b32 s68, v60, 4
    v_readlane_b32 s76, v63, 4
    v_readlane_b32 s69, v60, 5
    v_readlane_b32 s77, v63, 5
    v_readlane_b32 s70, v60, 6
    v_readlane_b32 s78, v63, 6
    v_readlane_b32 s71, v60, 7
    v_readlane_b32 s79, v63, 7
    s_nop 1
    s_bcnt1_i32_b32 s23, s64
    s_add_u32 s22, s22, s23
    s_add_u32 s22, s22, s72
    s_bcnt1_i32_b32 s23, s65
    s_add_u32 s22, s22, s23
    s_add_u32 s22, s22, s73
    s_bcnt1_i32_b32 s23, s66
    s_add_u32 s22, s22, s23
    s_add_u32 s22, s22, s74
    s_bcnt1_i32_b32 s23, s67
    s_add_u32 s22, s22, s23
    s_add_u32 s22, s22, s75
    s_bcnt1_i32_b32 s23, s68
    s_add_u32 s22, s22, s23
    s_add_u32 s22, s22, s76
    s_bcnt1_i32_b32 s23, s69
    s_add_u32 s22, s22, s23
    s_add_u32 s22, s22, s77
    s_bcnt1_i32_b32 s23, s70
    s_add_u32 s22, s22, s23
    s_add_u32 s22, s22, s78
    s_bcnt1_i32_b32 s23, s71
    s_add_u32 s22, s22, s23
    s_add_u32 s22, s22, s79
    s_cmp_ge_u32 s22, 256
    s_cbranch_scc1 L_ov_have
    s_sub_u32 s21, s21, 1
    s_cbranch_scc1 L_ov_none
    s_sleep 4
    s_branch L_ov_poll
L_ov_have:
    s_mov_b32 s22, 0
    s_bcnt0_i32_b32 s80, s64
    s_cmp_eq_u32 s20, 0
    s_cselect_b32 s21, s64, s21
    s_cselect_b32 s29, s80, s29
    s_max_u32 s23, s72, s80
    s_sub_u32 s23, s23, s80
    s_cmp_gt_u32 s20, 0
    s_cselect_b32 s23, s23, 0
    s_add_u32 s22, s22, s23
    s_bcnt0_i32_b32 s81, s65
    s_cmp_eq_u32 s20, 1
    s_cselect_b32 s21, s65, s21
    s_cselect_b32 s29, s81, s29
    s_max_u32 s23, s73, s81
    s_sub_u32 s23, s23, s81
    s_cmp_gt_u32 s20, 1
    s_cselect_b32 s23, s23, 0
    s_add_u32 s22, s22, s23
    s_bcnt0_i32_b32 s82, s66
    s_cmp_eq_u32 s20, 2
    s_cselect_b32 s21, s66, s21
    s_cselect_b32 s29, s82, s29
    s_max_u32 s23, s74, s82
    s_sub_u32 s23, s23, s82
    s_cmp_gt_u32 s20, 2
    s_cselect_b32 s23, s23, 0
    s_add_u32 s22, s22, s23
    s_bcnt0_i32_b32 s83, s67
    s_cmp_eq_u32 s20, 3
    s_cselect_b32 s21, s67, s21
    s_cselect_b32 s29, s83, s29
    s_max_u32 s23, s75, s83
    s_sub_u32 s23, s23, s83
    s_cmp_gt_u32 s20, 3
    s_cselect_b32 s23, s23, 0
    s_add_u32 s22, s22, s23
    s_bcnt0_i32_b32 s84, s68
    s_cmp_eq_u32 s20, 4
    s_cselect_b32 s21, s68, s21
    s_cselect_b32 s29, s84, s29
    s_max_u32 s23, s76, s84
    s_sub_u32 s23, s23, s84
    s_cmp_gt_u32 s20, 4
    s_cselect_b32 s23, s23, 0
    s_add_u32 s22, s22, s23
    s_bcnt0_i32_b32 s85, s69
    s_cmp_eq_u32 s20, 5
    s_cselect_b32 s21, s69, s21
    s_cselect_b32 s29, s85, s29
    s_max_u32 s23, s77, s85
    s_sub_u32 s23, s23, s85
    s_cmp_gt_u32 s20, 5
    s_cselect_b32 s23, s23, 0
    s_add_u32 s22, s22, s23
    s_bcnt0_i32_b32 s86, s70
    s_cmp_eq_u32 s20, 6
    s_cselect_b32 s21, s70, s21
    s_cselect_b32 s29, s86, s29
    s_max_u32 s23, s78, s86
    s_sub_u32 s23, s23, s86
    s_cmp_gt_u32 s20, 6
    s_cselect_b32 s23, s23, 0
    s_add_u32 s22, s22, s23
    s_bcnt0_i32_b32 s87, s71
    s_cmp_eq_u32 s20, 7
    s_cselect_b32 s21, s71, s21
    s_cselect_b32 s29, s87, s29
    s_max_u32 s23, s79, s87
    s_sub_u32 s23, s23, s87
    s_cmp_gt_u32 s20, 7
    s_cselect_b32 s23, s23, 0
    s_add_u32 s22, s22, s23
    s_cmp_lt_u32 s28, s29
    s_cbranch_scc1 L_ov_bit
    s_sub_u32 s28, s28, s29
    s_add_u32 s22, s22, s28
    s_max_u32 s23, s80, s72
    s_sub_u32 s23, s23, s72
    s_mov_b32 s16, 0
    s_mov_b32 s21, s64
    s_add_u32 s28, s72, s22
    s_cmp_lt_u32 s22, s23
    s_cbranch_scc1 L_ov_bit
    s_sub_u32 s22, s22, s23
    s_max_u32 s23, s81, s73
    s_sub_u32 s23, s23, s73
    s_mov_b32 s16, 1
    s_mov_b32 s21, s65
    s_add_u32 s28, s73, s22
    s_cmp_lt_u32 s22, s23
    s_cbranch_scc1 L_ov_bit
    s_sub_u32 s22, s22, s23
    s_max_u32 s23, s82, s74
    s_sub_u32 s23, s23, s74
    s_mov_b32 s16, 2
    s_mov_b32 s21, s66
    s_add_u32 s28, s74, s22
    s_cmp_lt_u32 s22, s23
    s_cbranch_scc1 L_ov_bit
    s_sub_u32 s22, s22, s23
    s_max_u32 s23, s83, s75
    s_sub_u32 s23, s23, s75
    s_mov_b32 s16, 3
    s_mov_b32 s21, s67
    s_add_u32 s28, s75, s22
    s_cmp_lt_u32 s22, s23
    s_cbranch_scc1 L_ov_bit
    s_sub_u32 s22, s22, s23
    s_max_u32 s23, s84, s76
    s_sub_u32 s23, s23, s76
    s_mov_b32 s16, 4
    s_mov_b32 s21, s68
    s_add_u32 s28, s76, s22
    s_cmp_lt_u32 s22, s23
    s_cbranch_scc1 L_ov_bit
    s_sub_u32 s22, s22, s23
    s_max_u32 s23, s85, s77
    s_sub_u32 s23, s23, s77
    s_mov_b32 s16, 5
    s_mov_b32 s21, s69
    s_add_u32 s28, s77, s22
    s_cmp_lt_u32 s22, s23
    s_cbranch_scc1 L_ov_bit
    s_sub_u32 s22, s22, s23
    s_max_u32 s23, s86, s78
    s_sub_u32 s23, s23, s78
    s_mov_b32 s16, 6
    s_mov_b32 s21, s70
    s_add_u32 s28, s78, s22
    s_cmp_lt_u32 s22, s23
    s_cbranch_scc1 L_ov_bit
    s_sub_u32 s22, s22, s23
    s_max_u32 s23, s87, s79
    s_sub_u32 s23, s23, s79
    s_mov_b32 s16, 7
    s_mov_b32 s21, s71
    s_add_u32 s28, s79, s22
    s_cmp_lt_u32 s22, s23
    s_cbranch_scc1 L_ov_bit
    s_sub_u32 s22, s22, s23
L_ov_none:
    s_mov_b32 s16, 8
    s_mov_b32 s17, 0
    s_branch L_rc_have
L_ov_bit:
    s_ff0_i32_b32 s17, s21
    s_and_b32 s17, s17, 31
    s_bitset1_b32 s21, s17
    s_sub_u32 s28, s28, 1
    s_cbranch_scc0 L_ov_bit
L_rc_have:
    s_lshl_b32 s21, s16, 5
    s_add_u32 s21, s21, s17
    v_mov_b32 v63, s21
    ds_write_b32 v62, v63
    s_waitcnt lgkmcnt(0)
L_rc_done:
    s_barrier
    ds_read_b32 v63, v62
    s_waitcnt lgkmcnt(0)
    s_waitcnt lgkmcnt(0)
    v_readfirstlane_b32 s21, v63
    s_nop 0
    s_lshr_b32 s16, s21, 5
    s_and_b32 s17, s21, 31
    s_cmp_lt_u32 s16, 8
    s_cbranch_scc1 L_role_ok
L_exit:
    s_endpgm
.p2align 8
T_R:
.long 0x0,0x0,0x0,0x20000,0x20800,0x21000,0x21800,0x22000,0x22400,0x22c00,0x0,0x0,0x4c4c4444,0x1000,0x0,0x0,0x3f80,0x0,0x3f80,0x0,0x3f80,0x0,0x3f80,0x3f80,0x0,0x22c00,0x0,0x0
.long 0x10,0x10,0x4,0x20010,0x20810,0x21010,0x21810,0x22010,0x22410,0x22c10,0x10,0x40000000,0x4e4e4444,0x200800,0x8,0x8,0x3f80,0x0,0x3f80,0x0,0x0,0x0,0x3f800000,0x0,0x2,0x22c10,0x0,0x0
.long 0x20,0x20,0x8,0x20020,0x20820,0x21020,0x21820,0x22020,0x22420,0x22c08,0x20,0x40000000,0x4d4deeee,0x400000,0x10,0x10,0x3f80,0x0,0x3f80,0x0,0x0,0x3f80,0x3f80,0x0,0x4,0x22c00,0x0,0x0
.long 0x30,0x30,0xc,0x20030,0x20830,0x21030,0x21830,0x22030,0x22430,0x22c18,0x30,0x40000000,0x4e4eeeee,0x601000,0x18,0x18,0x3f800000,0x0,0x3f800000,0x0,0x0,0x0,0x3f800000,0x0,0x6,0x22c10,0x0,0x0
.long 0x40,0x2000,0x40000000,0x20040,0x20840,0x21040,0x21840,0x22040,0x22440,0x22c20,0x40,0x40000000,0xc4c44444,0x800800,0x100,0x420,0x0,0x3f80,0x0,0x3f80,0x3f800000,0x0,0x0,0x3f800000,0x40000000,0x22c20,0x0,0x0
.long 0x50,0x2010,0x40000000,0x20050,0x20850,0x21050,0x21850,0x22050,0x22450,0x22c30,0x50,0x40000000,0xe4e44444,0xa00000,0x108,0x428,0x0,0x3f80,0x0,0x3f80,0x0,0x0,0x0,0x0,0x40000000,0x22c30,0x0,0x0
.long 0x60,0x2020,0x40000000,0x20060,0x20860,0x21060,0x21860,0x22060,0x22460,0x22c28,0x60,0x40000000,0xd4d4eeee,0xc01000,0x110,0x430,0x0,0x3f80,0x0,0x3f80,0x0,0x3f800000,0x0,0x0,0x40000000,0x22c20,0x0,0x0
.long 0x70,0x2030,0x40000000,0x20070,0x20870,0x21070,0x21870,0x22070,0x22470,0x22c38,0x70,0x40000000,0xe4e4eeee,0xe00800,0x118,0x438,0x0,0x3f800000,0x0,0x3f800000,0x0,0x0,0x0,0x0,0x40000000,0x22c30,0x0,0x0
.long 0x80,0x4000,0x10,0x20080,0x20880,0x21080,0x21880,0x22080,0x22480,0x22c40,0x80,0x40000000,0x4c4c4444,0x1000000,0x1080,0x20,0x3f80,0x0,0x3f80,0x0,0x0,0x0,0x0,0x0,0x400,0x22c40,0x0,0x0
.long 0x90,0x4010,0x14,0x20090,0x20890,0x21090,0x21890,0x22090,0x22490,0x22c50,0x90,0x40000000,0x4e4e4444,0x1201000,0x1088,0x28,0x3f80,0x0,0x3f80,0x0,0x0,0x0,0x0,0x0,0x402,0x22c50,0x0,0x0
.long 0xa0,0x4020,0x18,0x200a0,0x208a0,0x210a0,0x218a0,0x220a0,0x224a0,0x22c48,0xa0,0x40000000,0x4d4deeee,0x1400800,0x1090,0x30,0x3f80,0x0,0x3f80,0x0,0x0,0x0,0x0,0x0,0x404,0x22c40,0x0,0x0
.long 0xb0,0x4030,0x1c,0x200b0,0x208b0,0x210b0,0x218b0,0x220b0,0x224b0,0x22c58,0xb0,0x40000000,0x4e4eeeee,0x1600000,0x1098,0x38,0x3f800000,0x0,0x3f800000,0x0,0x0,0x0,0x0,0x0,0x406,0x22c50,0x0,0x0
.long 0xc0,0x6000,0x40000000,0x200c0,0x208c0,0x210c0,0x218c0,0x220c0,0x224c0,0x22c60,0xc0,0x40000000,0xc4c44444,0x1801000,0x1180,0x440,0x0,0x3f80,0x0,0x3f80,0x0,0x0,0x0,0x0,0x40000000,0x22c60,0x0,0x0
.long 0xd0,0x6010,0x40000000,0x200d0,0x208d0,0x210d0,0x218d0,0x220d0,0x224d0,0x22c70,0xd0,0x40000000,0xe4e44444,0x1a00800,0x1188,0x448,0x0,0x3f80,0x0,0x3f80,0x0,0x0,0x0,0x0,0x40000000,0x22c70,0x0,0x0
.long 0xe0,0x6020,0x40000000,0x200e0,0x208e0,0x210e0,0x218e0,0x220e0,0x224e0,0x22c68,0xe0,0x40000000,0xd4d4eeee,0x1c00000,0x1190,0x450,0x0,0x3f80,0x0,0x3f80,0x0,0x0,0x0,0x0,0x40000000,0x22c60,0x0,0x0
.long 0xf0,0x6030,0x40000000,0x200f0,0x208f0,0x210f0,0x218f0,0x220f0,0x224f0,0x22c78,0xf0,0x40000000,0xe4e4eeee,0x1e01000,0x1198,0x458,0x0,0x3f800000,0x0,0x3f800000,0x0,0x0,0x0,0x0,0x40000000,0x22c70,0x0,0x0
.long 0x100,0x800,0x200,0x20100,0x20900,0x21100,0x21900,0x22100,0x22500,0x22c80,0x100,0x40000000,0x4c4c4444,0x2000800,0x840,0x100,0x3f80,0x0,0x3f80,0x0,0x0,0x0,0x0,0x0,0x40,0x22c80,0x0,0x0
.long 0x110,0x810,0x204,0x20110,0x20910,0x21110,0x21910,0x22110,0x22510,0x22c90,0x110,0x40000000,0x4e4e4444,0x2200000,0x848,0x108,0x3f80,0x0,0x3f80,0x0,0x0,0x0,0x0,0x0,0x42,0x22c90,0x0,0x0
.long 0x120,0x820,0x208,0x20120,0x20920,0x21120,0x21920,0x22120,0x22520,0x22c88,0x120,0x40000000,0x4d4deeee,0x2401000,0x850,0x110,0x3f80,0x0,0x3f80,0x0,0x0,0x0,0x0,0x0,0x44,0x22c80,0x0,0x0
.long 0x130,0x830,0x20c,0x20130,0x20930,0x21130,0x21930,0x22130,0x22530,0x22c98,0x130,0x40000000,0x4e4eeeee,0x2600800,0x858,0x118,0x3f800000,0x0,0x3f800000,0x0,0x0,0x0,0x0,0x0,0x46,0x22c90,0x0,0x0
.long 0x140,0x2800,0x40000000,0x20140,0x20940,0x21140,0x21940,0x22140,0x22540,0x22ca0,0x140,0x40000000,0xc4c44444,0x2800000,0x940,0x520,0x0,0x3f80,0x0,0x3f80,0x0,0x0,0x3f80,0x0,0x40000000,0x22ca0,0x0,0x0
.long 0x150,0x2810,0x40000000,0x20150,0x20950,0x21150,0x21950,0x22150,0x22550,0x22cb0,0x150,0x40000000,0xe4e44444,0x2a01000,0x948,0x528,0x0,0x3f80,0x0,0x3f80,0x0,0x0,0x3f800000,0x0,0x40000000,0x22cb0,0x0,0x0
.long 0x160,0x2820,0x40000000,0x20160,0x20960,0x21160,0x21960,0x22160,0x22560,0x22ca8,0x160,0x40000000,0xd4d4eeee,0x2c00800,0x950,0x530,0x0,0x3f80,0x0,0x3f80,0x0,0x0,0x3f80,0x0,0x40000000,0x22ca0,0x0,0x0
.long 0x170,0x2830,0x40000000,0x20170,0x20970,0x21170,0x21970,0x22170,0x22570,0x22cb8,0x170,0x40000000,0xe4e4eeee,0x2e00000,0x958,0x538,0x0,0x3f800000,0x0,0x3f800000,0x0,0x0,0x3f800000,0x0,0x40000000,0x22cb0,0x0,0x0
.long 0x180,0x4800,0x210,0x20180,0x20980,0x21180,0x21980,0x22180,0x22580,0x22cc0,0x180,0x40000000,0x4c4c4444,0x3000000,0x18c0,0x120,0x3f80,0x0,0x3f80,0x0,0x3f80,0x0,0x0,0x3f80,0x440,0x22cc0,0x0,0x0
.long 0x190,0x4810,0x214,0x20190,0x20990,0x21190,0x21990,0x22190,0x22590,0x22cd0,0x190,0x40000000,0x4e4e4444,0x3200000,0x18c8,0x128,0x3f80,0x0,0x3f80,0x0,0x0,0x0,0x0,0x0,0x442,0x22cd0,0x0,0x0
.long 0x1a0,0x4820,0x218,0x201a0,0x209a0,0x211a0,0x219a0,0x221a0,0x225a0,0x22cc8,0x1a0,0x40000000,0x4d4deeee,0x3400000,0x18d0,0x130,0x3f80,0x0,0x3f80,0x0,0x0,0x3f80,0x0,0x0,0x444,0x22cc0,0x0,0x0
.long 0x1b0,0x4830,0x21c,0x201b0,0x209b0,0x211b0,0x219b0,0x221b0,0x225b0,0x22cd8,0x1b0,0x40000000,0x4e4eeeee,0x3600000,0x18d8,0x138,0x3f800000,0x0,0x3f800000,0x0,0x0,0x0,0x0,0x0,0x446,0x22cd0,0x0,0x0
.long 0x1c0,0x6800,0x40000000,0x201c0,0x209c0,0x211c0,0x219c0,0x221c0,0x225c0,0x22ce0,0x1c0,0x40000000,0xc4c44444,0x4378000,0x19c0,0x540,0x0,0x3f80,0x0,0x3f80,0x3f800000,0x0,0x0,0x3f800000,0x40000000,0x22ce0,0x0,0x0
.long 0x1d0,0x6810,0x40000000,0x201d0,0x209d0,0x211d0,0x219d0,0x221d0,0x225d0,0x22cf0,0x1d0,0x40000000,0xe4e44444,0x40000000,0x19c8,0x548,0x0,0x3f80,0x0,0x3f80,0x0,0x0,0x0,0x0,0x40000000,0x22cf0,0x0,0x0
.long 0x1e0,0x6820,0x40000000,0x201e0,0x209e0,0x211e0,0x219e0,0x221e0,0x225e0,0x22ce8,0x1e0,0x40000000,0xd4d4eeee,0x40000000,0x19d0,0x550,0x0,0x3f80,0x0,0x3f80,0x0,0x3f800000,0x0,0x0,0x40000000,0x22ce0,0x0,0x0
.long 0x1f0,0x6830,0x40000000,0x201f0,0x209f0,0x211f0,0x219f0,0x221f0,0x225f0,0x22cf8,0x1f0,0x40000000,0xe4e4eeee,0x40000000,0x19d8,0x558,0x0,0x3f800000,0x0,0x3f800000,0x0,0x0,0x0,0x0,0x40000000,0x22cf0,0x0,0x0
.long 0x200,0x1000,0x40000000,0x20200,0x20a00,0x21200,0x21a00,0x22200,0x22600,0x22d00,0x200,0x40000000,0x4c4c4444,0x40000000,0x2100,0x1080,0x3f80,0x0,0x3f80,0x0,0x0,0x0,0x0,0x0,0x40000000,0x22d00,0x0,0x0
.long 0x210,0x1010,0x40000000,0x20210,0x20a10,0x21210,0x21a10,0x22210,0x22610,0x22d10,0x210,0x40000000,0x4e4e4444,0x40000000,0x2108,0x1088,0x3f80,0x0,0x3f80,0x0,0x3f80,0x0,0x0,0x3f80,0x40000000,0x22d10,0x0,0x0
.long 0x220,0x1020,0x40000000,0x20220,0x20a20,0x21220,0x21a20,0x22220,0x22620,0x22d08,0x220,0x40000000,0x4d4deeee,0x40000000,0x2110,0x1090,0x3f80,0x0,0x3f80,0x0,0x0,0x0,0x0,0x0,0x40000000,0x22d00,0x0,0x0
.long 0x230,0x1030,0x40000000,0x20230,0x20a30,0x21230,0x21a30,0x22230,0x22630,0x22d18,0x230,0x40000000,0x4e4eeeee,0x40000000,0x2118,0x1098,0x3f800000,0x0,0x3f800000,0x0,0x0,0x3f80,0x0,0x0,0x40000000,0x22d10,0x0,0x0
.long 0x240,0x3000,0x40000000,0x20240,0x20a40,0x21240,0x21a40,0x22240,0x22640,0x22d20,0x240,0x40000000,0xc4c44444,0x40000000,0x2200,0x14a0,0x0,0x3f80,0x0,0x3f80,0x0,0x0,0x0,0x0,0x40000000,0x22d20,0x0,0x0
.long 0x250,0x3010,0x40000000,0x20250,0x20a50,0x21250,0x21a50,0x22250,0x22650,0x22d30,0x250,0x40000000,0xe4e44444,0x40000000,0x2208,0x14a8,0x0,0x3f80,0x0,0x3f80,0x3f800000,0x0,0x0,0x3f800000,0x40000000,0x22d30,0x0,0x0
.long 0x260,0x3020,0x40000000,0x20260,0x20a60,0x21260,0x21a60,0x22260,0x22660,0x22d28,0x260,0x40000000,0xd4d4eeee,0x40000000,0x2210,0x14b0,0x0,0x3f80,0x0,0x3f80,0x0,0x0,0x0,0x0,0x40000000,0x22d20,0x0,0x0
.long 0x270,0x3030,0x40000000,0x20270,0x20a70,0x21270,0x21a70,0x22270,0x22670,0x22d38,0x270,0x40000000,0xe4e4eeee,0x40000000,0x2218,0x14b8,0x0,0x3f800000,0x0,0x3f800000,0x0,0x3f800000,0x0,0x0,0x40000000,0x22d30,0x0,0x0
.long 0x280,0x5000,0x40000000,0x20280,0x20a80,0x21280,0x21a80,0x22280,0x22680,0x22d40,0x280,0x40000000,0x4c4c4444,0x40000000,0x3180,0x10a0,0x3f80,0x0,0x3f80,0x0,0x0,0x0,0x3f80,0x0,0x40000000,0x22d40,0x0,0x0
.long 0x290,0x5010,0x40000000,0x20290,0x20a90,0x21290,0x21a90,0x22290,0x22690,0x22d50,0x290,0x40000000,0x4e4e4444,0x40000000,0x3188,0x10a8,0x3f80,0x0,0x3f80,0x0,0x0,0x0,0x3f800000,0x0,0x40000000,0x22d50,0x0,0x0
.long 0x2a0,0x5020,0x40000000,0x202a0,0x20aa0,0x212a0,0x21aa0,0x222a0,0x226a0,0x22d48,0x2a0,0x40000000,0x4d4deeee,0x40000000,0x3190,0x10b0,0x3f80,0x0,0x3f80,0x0,0x0,0x0,0x3f80,0x0,0x40000000,0x22d40,0x0,0x0
.long 0x2b0,0x5030,0x40000000,0x202b0,0x20ab0,0x212b0,0x21ab0,0x222b0,0x226b0,0x22d58,0x2b0,0x40000000,0x4e4eeeee,0x40000000,0x3198,0x10b8,0x3f800000,0x0,0x3f800000,0x0,0x0,0x0,0x3f800000,0x0,0x40000000,0x22d50,0x0,0x0
.long 0x2c0,0x7000,0x40000000,0x202c0,0x20ac0,0x212c0,0x21ac0,0x222c0,0x226c0,0x22d60,0x2c0,0x40000000,0xc4c44444,0x40000000,0x3280,0x14c0,0x0,0x3f80,0x0,0x3f80,0x0,0x0,0x0,0x0,0x40000000,0x22d60,0x0,0x0
.long 0x2d0,0x7010,0x40000000,0x202d0,0x20ad0,0x212d0,0x21ad0,0x222d0,0x226d0,0x22d70,0x2d0,0x40000000,0xe4e44444,0x40000000,0x3288,0x14c8,0x0,0x3f80,0x0,0x3f80,0x0,0x0,0x0,0x0,0x40000000,0x22d70,0x0,0x0
.long 0x2e0,0x7020,0x40000000,0x202e0,0x20ae0,0x212e0,0x21ae0,0x222e0,0x226e0,0x22d68,0x2e0,0x40000000,0xd4d4eeee,0x40000000,0x3290,0x14d0,0x0,0x3f80,0x0,0x3f80,0x0,0x0,0x0,0x0,0x40000000,0x22d60,0x0,0x0
.long 0x2f0,0x7030,0x40000000,0x202f0,0x20af0,0x212f0,0x21af0,0x222f0,0x226f0,0x22d78,0x2f0,0x40000000,0xe4e4eeee,0x40000000,0x3298,0x14d8,0x0,0x3f800000,0x0,0x3f800000,0x0,0x0,0x0,0x0,0x40000000,0x22d70,0x0,0x0
.long 0x300,0x1800,0x40000000,0x20300,0x20b00,0x21300,0x21b00,0x22300,0x22700,0x22d80,0x300,0x40000000,0x4c4c4444,0x40000000,0x2940,0x1180,0x3f80,0x0,0x3f80,0x0,0x0,0x0,0x0,0x0,0x40000000,0x22d80,0x0,0x0
.long 0x310,0x1810,0x40000000,0x20310,0x20b10,0x21310,0x21b10,0x22310,0x22710,0x22d90,0x310,0x40000000,0x4e4e4444,0x40000000,0x2948,0x1188,0x3f80,0x0,0x3f80,0x0,0x0,0x0,0x0,0x0,0x40000000,0x22d90,0x0,0x0
.long 0x320,0x1820,0x40000000,0x20320,0x20b20,0x21320,0x21b20,0x22320,0x22720,0x22d88,0x320,0x40000000,0x4d4deeee,0x40000000,0x2950,0x1190,0x3f80,0x0,0x3f80,0x0,0x0,0x0,0x0,0x0,0x40000000,0x22d80,0x0,0x0
.long 0x330,0x1830,0x40000000,0x20330,0x20b30,0x21330,0x21b30,0x22330,0x22730,0x22d98,0x330,0x40000000,0x4e4eeeee,0x40000000,0x2958,0x1198,0x3f800000,0x0,0x3f800000,0x0,0x0,0x0,0x0,0x0,0x40000000,0x22d90,0x0,0x0
.long 0x340,0x3800,0x40000000,0x20340,0x20b40,0x21340,0x21b40,0x22340,0x22740,0x22da0,0x340,0x40000000,0xc4c44444,0x40000000,0x2a40,0x15a0,0x0,0x3f80,0x0,0x3f80,0x0,0x0,0x0,0x0,0x40000000,0x22da0,0x0,0x0
.long 0x350,0x3810,0x40000000,0x20350,0x20b50,0x21350,0x21b50,0x22350,0x22750,0x22db0,0x350,0x40000000,0xe4e44444,0x40000000,0x2a48,0x15a8,0x0,0x3f80,0x0,0x3f80,0x0,0x0,0x0,0x0,0x40000000,0x22db0,0x0,0x0
.long 0x360,0x3820,0x40000000,0x20360,0x20b60,0x21360,0x21b60,0x22360,0x22760,0x22da8,0x360,0x40000000,0xd4d4eeee,0x40000000,0x2a50,0x15b0,0x0,0x3f80,0x0,0x3f80,0x0,0x0,0x0,0x0,0x40000000,0x22da0,0x0,0x0
.long 0x370,0x3830,0x40000000,0x20370,0x20b70,0x21370,0x21b70,0x22370,0x22770,0x22db8,0x370,0x40000000,0xe4e4eeee,0x40000000,0x2a58,0x15b8,0x0,0x3f800000,0x0,0x3f800000,0x0,0x0,0x0,0x0,0x40000000,0x22db0,0x0,0x0
.long 0x380,0x5800,0x40000000,0x20380,0x20b80,0x21380,0x21b80,0x22380,0x22780,0x22dc0,0x380,0x40000000,0x4c4c4444,0x40000000,0x39c0,0x11a0,0x3f80,0x0,0x3f80,0x0,0x0,0x0,0x0,0x0,0x40000000,0x22dc0,0x0,0x0
.long 0x390,0x5810,0x40000000,0x20390,0x20b90,0x21390,0x21b90,0x22390,0x22790,0x22dd0,0x390,0x40000000,0x4e4e4444,0x40000000,0x39c8,0x11a8,0x3f80,0x0,0x3f80,0x0,0x3f80,0x0,0x0,0x3f80,0x40000000,0x22dd0,0x0,0x0
.long 0x3a0,0x5820,0x40000000,0x203a0,0x20ba0,0x213a0,0x21ba0,0x223a0,0x227a0,0x22dc8,0x3a0,0x40000000,0x4d4deeee,0x40000000,0x39d0,0x11b0,0x3f80,0x0,0x3f80,0x0,0x0,0x0,0x0,0x0,0x40000000,0x22dc0,0x0,0x0
.long 0x3b0,0x5830,0x40000000,0x203b0,0x20bb0,0x213b0,0x21bb0,0x223b0,0x227b0,0x22dd8,0x3b0,0x40000000,0x4e4eeeee,0x40000000,0x39d8,0x11b8,0x3f800000,0x0,0x3f800000,0x0,0x0,0x3f80,0x0,0x0,0x40000000,0x22dd0,0x0,0x0
.long 0x3c0,0x7800,0x40000000,0x203c0,0x20bc0,0x213c0,0x21bc0,0x223c0,0x227c0,0x22de0,0x3c0,0x40000000,0xc4c44444,0x40000000,0x3ac0,0x15c0,0x0,0x3f80,0x0,0x3f80,0x0,0x0,0x3f80,0x0,0x40000000,0x22de0,0x0,0x0
.long 0x3d0,0x7810,0x40000000,0x203d0,0x20bd0,0x213d0,0x21bd0,0x223d0,0x227d0,0x22df0,0x3d0,0x40000000,0xe4e44444,0x40000000,0x3ac8,0x15c8,0x0,0x3f80,0x0,0x3f80,0x3f800000,0x0,0x3f800000,0x3f800000,0x40000000,0x22df0,0x0,0x0
.long 0x3e0,0x7820,0x40000000,0x203e0,0x20be0,0x213e0,0x21be0,0x223e0,0x227e0,0x22de8,0x3e0,0x40000000,0xd4d4eeee,0x40000000,0x3ad0,0x15d0,0x0,0x3f80,0x0,0x3f80,0x0,0x0,0x3f80,0x0,0x40000000,0x22de0,0x0,0x0
.long 0x3f0,0x7830,0x40000000,0x203f0,0x20bf0,0x213f0,0x21bf0,0x223f0,0x227f0,0x22df8,0x3f0,0x40000000,0xe4e4eeee,0x40000000,0x3ad8,0x15d8,0x0,0x3f800000,0x0,0x3f800000,0x0,0x3f800000,0x3f800000,0x0,0x40000000,0x22df0,0x0,0x0
.long 0x0,0x10000,0x0,0x20800,0x20000,0x21800,0x21000,0x22000,0x22404,0x22e00,0x800,0x0,0x4c4c4444,0x1000,0x40,0x4200,0x3f80,0x0,0x3f80,0x0,0x3f80,0x0,0x3f80,0x3f80,0x0,0x22c00,0x0,0x0
.long 0x10,0x10010,0x4,0x20810,0x20010,0x21810,0x21010,0x22010,0x22414,0x22e10,0x810,0x40000000,0x4e4e4444,0x200800,0x48,0x4208,0x3f80,0x0,0x3f80,0x0,0x0,0x0,0x3f800000,0x0,0x2,0x22c10,0x0,0x0
.long 0x20,0x10020,0x8,0x20820,0x20020,0x21820,0x21020,0x22020,0x22424,0x22e08,0x820,0x40000000,0x4d4deeee,0x400000,0x50,0x4210,0x3f80,0x0,0x3f80,0x0,0x0,0x3f80,0x3f80,0x0,0x4,0x22c00,0x0,0x0
.long 0x30,0x10030,0xc,0x20830,0x20030,0x21830,0x21030,0x22030,0x22434,0x22e18,0x830,0x40000000,0x4e4eeeee,0x601000,0x58,0x4218,0x3f800000,0x0,0x3f800000,0x0,0x0,0x0,0x3f800000,0x0,0x6,0x22c10,0x0,0x0
.long 0x40,0x12000,0x40000000,0x20840,0x20040,0x21840,0x21040,0x22040,0x22444,0x22e20,0x840,0x40000000,0xc4c44444,0x800800,0x140,0x4620,0x0,0x3f80,0x0,0x3f80,0x3f800000,0x0,0x0,0x3f800000,0x40000000,0x22c20,0x0,0x0
.long 0x50,0x12010,0x40000000,0x20850,0x20050,0x21850,0x21050,0x22050,0x22454,0x22e30,0x850,0x40000000,0xe4e44444,0xa00000,0x148,0x4628,0x0,0x3f80,0x0,0x3f80,0x0,0x0,0x0,0x0,0x40000000,0x22c30,0x0,0x0
.long 0x60,0x12020,0x40000000,0x20860,0x20060,0x21860,0x21060,0x22060,0x22464,0x22e28,0x860,0x40000000,0xd4d4eeee,0xc01000,0x150,0x4630,0x0,0x3f80,0x0,0x3f80,0x0,0x3f800000,0x0,0x0,0x40000000,0x22c20,0x0,0x0
.long 0x70,0x12030,0x40000000,0x20870,0x20070,0x21870,0x21070,0x22070,0x22474,0x22e38,0x870,0x40000000,0xe4e4eeee,0xe00800,0x158,0x4638,0x0,0x3f800000,0x0,0x3f800000,0x0,0x0,0x0,0x0,0x40000000,0x22c30,0x0,0x0
.long 0x80,0x14000,0x10,0x20880,0x20080,0x21880,0x21080,0x22080,0x22484,0x22e40,0x880,0x40000000,0x4c4c4444,0x1000000,0x10c0,0x4220,0x3f80,0x0,0x3f80,0x0,0x0,0x0,0x0,0x0,0x400,0x22c40,0x0,0x0
.long 0x90,0x14010,0x14,0x20890,0x20090,0x21890,0x21090,0x22090,0x22494,0x22e50,0x890,0x40000000,0x4e4e4444,0x1201000,0x10c8,0x4228,0x3f80,0x0,0x3f80,0x0,0x0,0x0,0x0,0x0,0x402,0x22c50,0x0,0x0
.long 0xa0,0x14020,0x18,0x208a0,0x200a0,0x218a0,0x210a0,0x220a0,0x224a4,0x22e48,0x8a0,0x40000000,0x4d4deeee,0x1400800,0x10d0,0x4230,0x3f80,0x0,0x3f80,0x0,0x0,0x0,0x0,0x0,0x404,0x22c40,0x0,0x0
.long 0xb0,0x14030,0x1c,0x208b0,0x200b0,0x218b0,0x210b0,0x220b0,0x224b4,0x22e58,0x8b0,0x40000000,0x4e4eeeee,0x1600000,0x10d8,0x4238,0x3f800000,0x0,0x3f800000,0x0,0x0,0x0,0x0,0x0,0x406,0x22c50,0x0,0x0
.long 0xc0,0x16000,0x40000000,0x208c0,0x200c0,0x218c0,0x210c0,0x220c0,0x224c4,0x22e60,0x8c0,0x40000000,0xc4c44444,0x1801000,0x11c0,0x4640,0x0,0x3f80,0x0,0x3f80,0x0,0x0,0x0,0x0,0x40000000,0x22c60,0x0,0x0
.long 0xd0,0x16010,0x40000000,0x208d0,0x200d0,0x218d0,0x210d0,0x220d0,0x224d4,0x22e70,0x8d0,0x40000000,0xe4e44444,0x1a00800,0x11c8,0x4648,0x0,0x3f80,0x0,0x3f80,0x0,0x0,0x0,0x0,0x40000000,0x22c70,0x0,0x0
.long 0xe0,0x16020,0x40000000,0x208e0,0x200e0,0x218e0,0x210e0,0x220e0,0x224e4,0x22e68,0x8e0,0x40000000,0xd4d4eeee,0x1c00000,0x11d0,0x4650,0x0,0x3f80,0x0,0x3f80,0x0,0x0,0x0,0x0,0x40000000,0x22c60,0x0,0x0
.long 0xf0,0x16030,0x40000000,0x208f0,0x200f0,0x218f0,0x210f0,0x220f0,0x224f4,0x22e78,0x8f0,0x40000000,0xe4e4eeee,0x1e01000,0x11d8,0x4658,0x0,0x3f800000,0x0,0x3f800000,0x0,0x0,0x0,0x0,0x40000000,0x22c70,0x0,0x0
.long 0x100,0x10800,0x200,0x20900,0x20100,0x21900,0x21100,0x22100,0x22504,0x22e80,0x900,0x40000000,0x4c4c4444,0x2000800,0x880,0x4300,0x3f80,0x0,0x3f80,0x0,0x0,0x0,0x0,0x0,0x40,0x22c80,0x0,0x0
.long 0x110,0x10810,0x204,0x20910,0x20110,0x21910,0x21110,0x22110,0x22514,0x22e90,0x910,0x40000000,0x4e4e4444,0x2200000,0x888,0x4308,0x3f80,0x0,0x3f80,0x0,0x0,0x0,0x0,0x0,0x42,0x22c90,0x0,0x0
.long 0x120,0x10820,0x208,0x20920,0x20120,0x21920,0x21120,0x22120,0x22524,0x22e88,0x920,0x40000000,0x4d4deeee,0x2401000,0x890,0x4310,0x3f80,0x0,0x3f80,0x0,0x0,0x0,0x0,0x0,0x44,0x22c80,0x0,0x0
.long 0x130,0x10830,0x20c,0x20930,0x20130,0x21930,0x21130,0x22130,0x22534,0x22e98,0x930,0x40000000,0x4e4eeeee,0x2600800,0x898,0x4318,0x3f800000,0x0,0x3f800000,0x0,0x0,0x0,0x0,0x0,0x46,0x22c90,0x0,0x0
.long 0x140,0x12800,0x40000000,0x20940,0x20140,0x21940,0x21140,0x22140,0x22544,0x22ea0,0x940,0x40000000,0xc4c44444,0x2800000,0x980,0x4720,0x0,0x3f80,0x0,0x3f80,0x0,0x0,0x3f80,0x0,0x40000000,0x22ca0,0x0,0x0
.long 0x150,0x12810,0x40000000,0x20950,0x20150,0x21950,0x21150,0x22150,0x22554,0x22eb0,0x950,0x40000000,0xe4e44444,0x2a01000,0x988,0x4728,0x0,0x3f80,0x0,0x3f80,0x0,0x0,0x3f800000,0x0,0x40000000,0x22cb0,0x0,0x0
.long 0x160,0x12820,0x40000000,0x20960,0x20160,0x21960,0x21160,0x22160,0x22564,0x22ea8,0x960,0x40000000,0xd4d4eeee,0x2c00800,0x990,0x4730,0x0,0x3f80,0x0,0x3f80,0x0,0x0,0x3f80,0x0,0x40000000,0x22ca0,0x0,0x0
.long 0x170,0x12830,0x40000000,0x20970,0x20170,0x21970,0x21170,0x22170,0x22574,0x22eb8,0x970,0x40000000,0xe4e4eeee,0x2e00000,0x998,0x4738,0x0,0x3f800000,0x0,0x3f800000,0x0,0x0,0x3f800000,0x0,0x40000000,0x22cb0,0x0,0x0
.long 0x180,0x14800,0x210,0x20980,0x20180,0x21980,0x21180,0x22180,0x22584,0x22ec0,0x980,0x40000000,0x4c4c4444,0x3000000,0x1900,0x4320,0x3f80,0x0,0x3f80,0x0,0x3f80,0x0,0x0,0x3f80,0x440,0x22cc0,0x0,0x0
.long 0x190,0x14810,0x214,0x20990,0x20190,0x21990,0x21190,0x22190,0x22594,0x22ed0,0x990,0x40000000,0x4e4e4444,0x3200000,0x1908,0x4328,0x3f80,0x0,0x3f80,0x0,0x0,0x0,0x0,0x0,0x442,0x22cd0,0x0,0x0
.long 0x1a0,0x14820,0x218,0x209a0,0x201a0,0x219a0,0x211a0,0x221a0,0x225a4,0x22ec8,0x9a0,0x40000000,0x4d4deeee,0x3400000,0x1910,0x4330,0x3f80,0x0,0x3f80,0x0,0x0,0x3f80,0x0,0x0,0x444,0x22cc0,0x0,0x0
.long 0x1b0,0x14830,0x21c,0x209b0,0x201b0,0x219b0,0x211b0,0x221b0,0x225b4,0x22ed8,0x9b0,0x40000000,0x4e4eeeee,0x3600000,0x1918,0x4338,0x3f800000,0x0,0x3f800000,0x0,0x0,0x0,0x0,0x0,0x446,0x22cd0,0x0,0x0
.long 0x1c0,0x16800,0x40000000,0x209c0,0x201c0,0x219c0,0x211c0,0x221c0,0x225c4,0x22ee0,0x9c0,0x40000000,0xc4c44444,0x4378000,0x1a00,0x4740,0x0,0x3f80,0x0,0x3f80,0x3f800000,0x0,0x0,0x3f800000,0x40000000,0x22ce0,0x0,0x0
.long 0x1d0,0x16810,0x40000000,0x209d0,0x201d0,0x219d0,0x211d0,0x221d0,0x225d4,0x22ef0,0x9d0,0x40000000,0xe4e44444,0x40000000,0x1a08,0x4748,0x0,0x3f80,0x0,0x3f80,0x0,0x0,0x0,0x0,0x40000000,0x22cf0,0x0,0x0
.long 0x1e0,0x16820,0x40000000,0x209e0,0x201e0,0x219e0,0x211e0,0x221e0,0x225e4,0x22ee8,0x9e0,0x40000000,0xd4d4eeee,0x40000000,0x1a10,0x4750,0x0,0x3f80,0x0,0x3f80,0x0,0x3f800000,0x0,0x0,0x40000000,0x22ce0,0x0,0x0
.long 0x1f0,0x16830,0x40000000,0x209f0,0x201f0,0x219f0,0x211f0,0x221f0,0x225f4,0x22ef8,0x9f0,0x40000000,0xe4e4eeee,0x40000000,0x1a18,0x4758,0x0,0x3f800000,0x0,0x3f800000,0x0,0x0,0x0,0x0,0x40000000,0x22cf0,0x0,0x0
.long 0x200,0x11000,0x40000000,0x20a00,0x20200,0x21a00,0x21200,0x22200,0x22604,0x22f00,0xa00,0x40000000,0x4c4c4444,0x40000000,0x2140,0x5280,0x3f80,0x0,0x3f80,0x0,0x0,0x0,0x0,0x0,0x40000000,0x22d00,0x0,0x0
.long 0x210,0x11010,0x40000000,0x20a10,0x20210,0x21a10,0x21210,0x22210,0x22614,0x22f10,0xa10,0x40000000,0x4e4e4444,0x40000000,0x2148,0x5288,0x3f80,0x0,0x3f80,0x0,0x3f80,0x0,0x0,0x3f80,0x40000000,0x22d10,0x0,0x0
.long 0x220,0x11020,0x40000000,0x20a20,0x20220,0x21a20,0x21220,0x22220,0x22624,0x22f08,0xa20,0x40000000,0x4d4deeee,0x40000000,0x2150,0x5290,0x3f80,0x0,0x3f80,0x0,0x0,0x0,0x0,0x0,0x40000000,0x22d00,0x0,0x0
.long 0x230,0x11030,0x40000000,0x20a30,0x20230,0x21a30,0x21230,0x22230,0x22634,0x22f18,0xa30,0x40000000,0x4e4eeeee,0x40000000,0x2158,0x5298,0x3f800000,0x0,0x3f800000,0x0,0x0,0x3f80,0x0,0x0,0x40000000,0x22d10,0x0,0x0
.long 0x240,0x13000,0x40000000,0x20a40,0x20240,0x21a40,0x21240,0x22240,0x22644,0x22f20,0xa40,0x40000000,0xc4c44444,0x40000000,0x2240,0x56a0,0x0,0x3f80,0x0,0x3f80,0x0,0x0,0x0,0x0,0x40000000,0x22d20,0x0,0x0
.long 0x250,0x13010,0x40000000,0x20a50,0x20250,0x21a50,0x21250,0x22250,0x22654,0x22f30,0xa50,0x40000000,0xe4e44444,0x40000000,0x2248,0x56a8,0x0,0x3f80,0x0,0x3f80,0x3f800000,0x0,0x0,0x3f800000,0x40000000,0x22d30,0x0,0x0
.long 0x260,0x13020,0x40000000,0x20a60,0x20260,0x21a60,0x21260,0x22260,0x22664,0x22f28,0xa60,0x40000000,0xd4d4eeee,0x40000000,0x2250,0x56b0,0x0,0x3f80,0x0,0x3f80,0x0,0x0,0x0,0x0,0x40000000,0x22d20,0x0,0x0
.long 0x270,0x13030,0x40000000,0x20a70,0x20270,0x21a70,0x21270,0x22270,0x22674,0x22f38,0xa70,0x40000000,0xe4e4eeee,0x40000000,0x2258,0x56b8,0x0,0x3f800000,0x0,0x3f800000,0x0,0x3f800000,0x0,0x0,0x40000000,0x22d30,0x0,0x0
.long 0x280,0x15000,0x40000000,0x20a80,0x20280,0x21a80,0x21280,0x22280,0x22684,0x22f40,0xa80,0x40000000,0x4c4c4444,0x40000000,0x31c0,0x52a0,0x3f80,0x0,0x3f80,0x0,0x0,0x0,0x3f80,0x0,0x40000000,0x22d40,0x0,0x0
.long 0x290,0x15010,0x40000000,0x20a90,0x20290,0x21a90,0x21290,0x22290,0x22694,0x22f50,0xa90,0x40000000,0x4e4e4444,0x40000000,0x31c8,0x52a8,0x3f80,0x0,0x3f80,0x0,0x0,0x0,0x3f800000,0x0,0x40000000,0x22d50,0x0,0x0
.long 0x2a0,0x15020,0x40000000,0x20aa0,0x202a0,0x21aa0,0x212a0,0x222a0,0x226a4,0x22f48,0xaa0,0x40000000,0x4d4deeee,0x40000000,0x31d0,0x52b0,0x3f80,0x0,0x3f80,0x0,0x0,0x0,0x3f80,0x0,0x40000000,0x22d40,0x0,0x0
.long 0x2b0,0x15030,0x40000000,0x20ab0,0x202b0,0x21ab0,0x212b0,0x222b0,0x226b4,0x22f58,0xab0,0x40000000,0x4e4eeeee,0x40000000,0x31d8,0x52b8,0x3f800000,0x0,0x3f800000,0x0,0x0,0x0,0x3f800000,0x0,0x40000000,0x22d50,0x0,0x0
.long 0x2c0,0x17000,0x40000000,0x20ac0,0x202c0,0x21ac0,0x212c0,0x222c0,0x226c4,0x22f60,0xac0,0x40000000,0xc4c44444,0x40000000,0x32c0,0x56c0,0x0,0x3f80,0x0,0x3f80,0x0,0x0,0x0,0x0,0x40000000,0x22d60,0x0,0x0
.long 0x2d0,0x17010,0x40000000,0x20ad0,0x202d0,0x21ad0,0x212d0,0x222d0,0x226d4,0x22f70,0xad0,0x40000000,0xe4e44444,0x40000000,0x32c8,0x56c8,0x0,0x3f80,0x0,0x3f80,0x0,0x0,0x0,0x0,0x40000000,0x22d70,0x0,0x0
.long 0x2e0,0x17020,0x40000000,0x20ae0,0x202e0,0x21ae0,0x212e0,0x222e0,0x226e4,0x22f68,0xae0,0x40000000,0xd4d4eeee,0x40000000,0x32d0,0x56d0,0x0,0x3f80,0x0,0x3f80,0x0,0x0,0x0,0x0,0x40000000,0x22d60,0x0,0x0
.long 0x2f0,0x17030,0x40000000,0x20af0,0x202f0,0x21af0,0x212f0,0x222f0,0x226f4,0x22f78,0xaf0,0x40000000,0xe4e4eeee,0x40000000,0x32d8,0x56d8,0x0,0x3f800000,0x0,0x3f800000,0x0,0x0,0x0,0x0,0x40000000,0x22d70,0x0,0x0
.long 0x300,0x11800,0x40000000,0x20b00,0x20300,0x21b00,0x21300,0x22300,0x22704,0x22f80,0xb00,0x40000000,0x4c4c4444,0x40000000,0x2980,0x5380,0x3f80,0x0,0x3f80,0x0,0x0,0x0,0x0,0x0,0x40000000,0x22d80,0x0,0x0
.long 0x310,0x11810,0x40000000,0x20b10,0x20310,0x21b10,0x21310,0x22310,0x22714,0x22f90,0xb10,0x40000000,0x4e4e4444,0x40000000,0x2988,0x5388,0x3f80,0x0,0x3f80,0x0,0x0,0x0,0x0,0x0,0x40000000,0x22d90,0x0,0x0
.long 0x320,0x11820,0x40000000,0x20b20,0x20320,0x21b20,0x21320,0x22320,0x22724,0x22f88,0xb20,0x40000000,0x4d4deeee,0x40000000,0x2990,0x5390,0x3f80,0x0,0x3f80,0x0,0x0,0x0,0x0,0x0,0x40000000,0x22d80,0x0,0x0
.long 0x330,0x11830,0x40000000,0x20b30,0x20330,0x21b30,0x21330,0x22330,0x22734,0x22f98,0xb30,0x40000000,0x4e4eeeee,0x40000000,0x2998,0x5398,0x3f800000,0x0,0x3f800000,0x0,0x0,0x0,0x0,0x0,0x40000000,0x22d90,0x0,0x0
.long 0x340,0x13800,0x40000000,0x20b40,0x20340,0x21b40,0x21340,0x22340,0x22744,0x22fa0,0xb40,0x40000000,0xc4c44444,0x40000000,0x2a80,0x57a0,0x0,0x3f80,0x0,0x3f80,0x0,0x0,0x0,0x0,0x40000000,0x22da0,0x0,0x0
.long 0x350,0x13810,0x40000000,0x20b50,0x20350,0x21b50,0x21350,0x22350,0x22754,0x22fb0,0xb50,0x40000000,0xe4e44444,0x40000000,0x2a88,0x57a8,0x0,0x3f80,0x0,0x3f80,0x0,0x0,0x0,0x0,0x40000000,0x22db0,0x0,0x0
.long 0x360,0x13820,0x40000000,0x20b60,0x20360,0x21b60,0x21360,0x22360,0x22764,0x22fa8,0xb60,0x40000000,0xd4d4eeee,0x40000000,0x2a90,0x57b0,0x0,0x3f80,0x0,0x3f80,0x0,0x0,0x0,0x0,0x40000000,0x22da0,0x0,0x0
.long 0x370,0x13830,0x40000000,0x20b70,0x20370,0x21b70,0x21370,0x22370,0x22774,0x22fb8,0xb70,0x40000000,0xe4e4eeee,0x40000000,0x2a98,0x57b8,0x0,0x3f800000,0x0,0x3f800000,0x0,0x0,0x0,0x0,0x40000000,0x22db0,0x0,0x0
.long 0x380,0x15800,0x40000000,0x20b80,0x20380,0x21b80,0x21380,0x22380,0x22784,0x22fc0,0xb80,0x40000000,0x4c4c4444,0x40000000,0x3a00,0x53a0,0x3f80,0x0,0x3f80,0x0,0x0,0x0,0x0,0x0,0x40000000,0x22dc0,0x0,0x0
.long 0x390,0x15810,0x40000000,0x20b90,0x20390,0x21b90,0x21390,0x22390,0x22794,0x22fd0,0xb90,0x40000000,0x4e4e4444,0x40000000,0x3a08,0x53a8,0x3f80,0x0,0x3f80,0x0,0x3f80,0x0,0x0,0x3f80,0x40000000,0x22dd0,0x0,0x0
.long 0x3a0,0x15820,0x40000000,0x20ba0,0x203a0,0x21ba0,0x213a0,0x223a0,0x227a4,0x22fc8,0xba0,0x40000000,0x4d4deeee,0x40000000,0x3a10,0x53b0,0x3f80,0x0,0x3f80,0x0,0x0,0x0,0x0,0x0,0x40000000,0x22dc0,0x0,0x0
.long 0x3b0,0x15830,0x40000000,0x20bb0,0x203b0,0x21bb0,0x213b0,0x223b0,0x227b4,0x22fd8,0xbb0,0x40000000,0x4e4eeeee,0x40000000,0x3a18,0x53b8,0x3f800000,0x0,0x3f800000,0x0,0x0,0x3f80,0x0,0x0,0x40000000,0x22dd0,0x0,0x0
.long 0x3c0,0x17800,0x40000000,0x20bc0,0x203c0,0x21bc0,0x213c0,0x223c0,0x227c4,0x22fe0,0xbc0,0x40000000,0xc4c44444,0x40000000,0x3b00,0x57c0,0x0,0x3f80,0x0,0x3f80,0x0,0x0,0x3f80,0x0,0x40000000,0x22de0,0x0,0x0
.long 0x3d0,0x17810,0x40000000,0x20bd0,0x203d0,0x21bd0,0x213d0,0x223d0,0x227d4,0x22ff0,0xbd0,0x40000000,0xe4e44444,0x40000000,0x3b08,0x57c8,0x0,0x3f80,0x0,0x3f80,0x3f800000,0x0,0x3f800000,0x3f800000,0x40000000,0x22df0,0x0,0x0
.long 0x3e0,0x17820,0x40000000,0x20be0,0x203e0,0x21be0,0x213e0,0x223e0,0x227e4,0x22fe8,0xbe0,0x40000000,0xd4d4eeee,0x40000000,0x3b10,0x57d0,0x0,0x3f80,0x0,0x3f80,0x0,0x0,0x3f80,0x0,0x40000000,0x22de0,0x0,0x0
.long 0x3f0,0x17830,0x40000000,0x20bf0,0x203f0,0x21bf0,0x213f0,0x223f0,0x227f4,0x22ff8,0xbf0,0x40000000,0xe4e4eeee,0x40000000,0x3b18,0x57d8,0x0,0x3f800000,0x0,0x3f800000,0x0,0x3f800000,0x3f800000,0x0,0x40000000,0x22df0,0x0,0x0
.long 0x0,0x20000,0x0,0x21000,0x21800,0x20000,0x20800,0x22000,0x22408,0x23400,0x1000,0x0,0x4c4c4444,0x1000,0x80,0x8400,0x3f80,0x0,0x3f80,0x0,0x3f80,0x0,0x3f80,0x3f80,0x0,0x22c00,0x0,0x0
.long 0x10,0x20010,0x4,0x21010,0x21810,0x20010,0x20810,0x22010,0x22418,0x23410,0x1010,0x40000000,0x4e4e4444,0x200800,0x88,0x8408,0x3f80,0x0,0x3f80,0x0,0x0,0x0,0x3f800000,0x0,0x2,0x22c10,0x0,0x0
.long 0x20,0x20020,0x8,0x21020,0x21820,0x20020,0x20820,0x22020,0x22428,0x23408,0x1020,0x40000000,0x4d4deeee,0x400000,0x90,0x8410,0x3f80,0x0,0x3f80,0x0,0x0,0x3f80,0x3f80,0x0,0x4,0x22c00,0x0,0x0
.long 0x30,0x20030,0xc,0x21030,0x21830,0x20030,0x20830,0x22030,0x22438,0x23418,0x1030,0x40000000,0x4e4eeeee,0x601000,0x98,0x8418,0x3f800000,0x0,0x3f800000,0x0,0x0,0x0,0x3f800000,0x0,0x6,0x22c10,0x0,0x0
.long 0x40,0x22000,0x40000000,0x21040,0x21840,0x20040,0x20840,0x22040,0x22448,0x23420,0x1040,0x40000000,0xc4c44444,0x800800,0x180,0x8820,0x0,0x3f80,0x0,0x3f80,0x3f800000,0x0,0x0,0x3f800000,0x40000000,0x22c20,0x0,0x0
.long 0x50,0x22010,0x40000000,0x21050,0x21850,0x20050,0x20850,0x22050,0x22458,0x23430,0x1050,0x40000000,0xe4e44444,0xa00000,0x188,0x8828,0x0,0x3f80,0x0,0x3f80,0x0,0x0,0x0,0x0,0x40000000,0x22c30,0x0,0x0
.long 0x60,0x22020,0x40000000,0x21060,0x21860,0x20060,0x20860,0x22060,0x22468,0x23428,0x1060,0x40000000,0xd4d4eeee,0xc01000,0x190,0x8830,0x0,0x3f80,0x0,0x3f80,0x0,0x3f800000,0x0,0x0,0x40000000,0x22c20,0x0,0x0
.long 0x70,0x22030,0x40000000,0x21070,0x21870,0x20070,0x20870,0x22070,0x22478,0x23438,0x1070,0x40000000,0xe4e4eeee,0xe00800,0x198,0x8838,0x0,0x3f800000,0x0,0x3f800000,0x0,0x0,0x0,0x0,0x40000000,0x22c30,0x0,0x0
.long 0x80,0x24000,0x10,0x21080,0x21880,0x20080,0x20880,0x22080,0x22488,0x23440,0x1080,0x40000000,0x4c4c4444,0x1000000,0x1100,0x8420,0x3f80,0x0,0x3f80,0x0,0x0,0x0,0x0,0x0,0x400,0x22c40,0x0,0x0
.long 0x90,0x24010,0x14,0x21090,0x21890,0x20090,0x20890,0x22090,0x22498,0x23450,0x1090,0x40000000,0x4e4e4444,0x1201000,0x1108,0x8428,0x3f80,0x0,0x3f80,0x0,0x0,0x0,0x0,0x0,0x402,0x22c50,0x0,0x0
.long 0xa0,0x24020,0x18,0x210a0,0x218a0,0x200a0,0x208a0,0x220a0,0x224a8,0x23448,0x10a0,0x40000000,0x4d4deeee,0x1400800,0x1110,0x8430,0x3f80,0x0,0x3f80,0x0,0x0,0x0,0x0,0x0,0x404,0x22c40,0x0,0x0
.long 0xb0,0x24030,0x1c,0x210b0,0x218b0,0x200b0,0x208b0,0x220b0,0x224b8,0x23458,0x10b0,0x40000000,0x4e4eeeee,0x1600000,0x1118,0x8438,0x3f800000,0x0,0x3f800000,0x0,0x0,0x0,0x0,0x0,0x406,0x22c50,0x0,0x0
.long 0xc0,0x26000,0x40000000,0x210c0,0x218c0,0x200c0,0x208c0,0x220c0,0x224c8,0x23460,0x10c0,0x40000000,0xc4c44444,0x1801000,0x1200,0x8840,0x0,0x3f80,0x0,0x3f80,0x0,0x0,0x0,0x0,0x40000000,0x22c60,0x0,0x0
.long 0xd0,0x26010,0x40000000,0x210d0,0x218d0,0x200d0,0x208d0,0x220d0,0x224d8,0x23470,0x10d0,0x40000000,0xe4e44444,0x1a00800,0x1208,0x8848,0x0,0x3f80,0x0,0x3f80,0x0,0x0,0x0,0x0,0x40000000,0x22c70,0x0,0x0
.long 0xe0,0x26020,0x40000000,0x210e0,0x218e0,0x200e0,0x208e0,0x220e0,0x224e8,0x23468,0x10e0,0x40000000,0xd4d4eeee,0x1c00000,0x1210,0x8850,0x0,0x3f80,0x0,0x3f80,0x0,0x0,0x0,0x0,0x40000000,0x22c60,0x0,0x0
.long 0xf0,0x26030,0x40000000,0x210f0,0x218f0,0x200f0,0x208f0,0x220f0,0x224f8,0x23478,0x10f0,0x40000000,0xe4e4eeee,0x1e01000,0x1218,0x8858,0x0,0x3f800000,0x0,0x3f800000,0x0,0x0,0x0,0x0,0x40000000,0x22c70,0x0,0x0
.long 0x100,0x20800,0x200,0x21100,0x21900,0x20100,0x20900,0x22100,0x22508,0x23480,0x1100,0x40000000,0x4c4c4444,0x2000800,0x8c0,0x8500,0x3f80,0x0,0x3f80,0x0,0x0,0x0,0x0,0x0,0x40,0x22c80,0x0,0x0
.long 0x110,0x20810,0x204,0x21110,0x21910,0x20110,0x20910,0x22110,0x22518,0x23490,0x1110,0x40000000,0x4e4e4444,0x2200000,0x8c8,0x8508,0x3f80,0x0,0x3f80,0x0,0x0,0x0,0x0,0x0,0x42,0x22c90,0x0,0x0
.long 0x120,0x20820,0x208,0x21120,0x21920,0x20120,0x20920,0x22120,0x22528,0x23488,0x1120,0x40000000,0x4d4deeee,0x2401000,0x8d0,0x8510,0x3f80,0x0,0x3f80,0x0,0x0,0x0,0x0,0x0,0x44,0x22c80,0x0,0x0
.long 0x130,0x20830,0x20c,0x21130,0x21930,0x20130,0x20930,0x22130,0x22538,0x23498,0x1130,0x40000000,0x4e4eeeee,0x2600800,0x8d8,0x8518,0x3f800000,0x0,0x3f800000,0x0,0x0,0x0,0x0,0x0,0x46,0x22c90,0x0,0x0
.long 0x140,0x22800,0x40000000,0x21140,0x21940,0x20140,0x20940,0x22140,0x22548,0x234a0,0x1140,0x40000000,0xc4c44444,0x2800000,0x9c0,0x8920,0x0,0x3f80,0x0,0x3f80,0x0,0x0,0x3f80,0x0,0x40000000,0x22ca0,0x0,0x0
.long 0x150,0x22810,0x40000000,0x21150,0x21950,0x20150,0x20950,0x22150,0x22558,0x234b0,0x1150,0x40000000,0xe4e44444,0x2a01000,0x9c8,0x8928,0x0,0x3f80,0x0,0x3f80,0x0,0x0,0x3f800000,0x0,0x40000000,0x22cb0,0x0,0x0
.long 0x160,0x22820,0x40000000,0x21160,0x21960,0x20160,0x20960,0x22160,0x22568,0x234a8,0x1160,0x40000000,0xd4d4eeee,0x2c00800,0x9d0,0x8930,0x0,0x3f80,0x0,0x3f80,0x0,0x0,0x3f80,0x0,0x40000000,0x22ca0,0x0,0x0
.long 0x170,0x22830,0x40000000,0x21170,0x21970,0x20170,0x20970,0x22170,0x22578,0x234b8,0x1170,0x40000000,0xe4e4eeee,0x2e00000,0x9d8,0x8938,0x0,0x3f800000,0x0,0x3f800000,0x0,0x0,0x3f800000,0x0,0x40000000,0x22cb0,0x0,0x0
.long 0x180,0x24800,0x210,0x21180,0x21980,0x20180,0x20980,0x22180,0x22588,0x234c0,0x1180,0x40000000,0x4c4c4444,0x3000000,0x1940,0x8520,0x3f80,0x0,0x3f80,0x0,0x3f80,0x0,0x0,0x3f80,0x440,0x22cc0,0x0,0x0
.long 0x190,0x24810,0x214,0x21190,0x21990,0x20190,0x20990,0x22190,0x22598,0x234d0,0x1190,0x40000000,0x4e4e4444,0x3200000,0x1948,0x8528,0x3f80,0x0,0x3f80,0x0,0x0,0x0,0x0,0x0,0x442,0x22cd0,0x0,0x0
.long 0x1a0,0x24820,0x218,0x211a0,0x219a0,0x201a0,0x209a0,0x221a0,0x225a8,0x234c8,0x11a0,0x40000000,0x4d4deeee,0x3400000,0x1950,0x8530,0x3f80,0x0,0x3f80,0x0,0x0,0x3f80,0x0,0x0,0x444,0x22cc0,0x0,0x0
.long 0x1b0,0x24830,0x21c,0x211b0,0x219b0,0x201b0,0x209b0,0x221b0,0x225b8,0x234d8,0x11b0,0x40000000,0x4e4eeeee,0x3600000,0x1958,0x8538,0x3f800000,0x0,0x3f800000,0x0,0x0,0x0,0x0,0x0,0x446,0x22cd0,0x0,0x0
.long 0x1c0,0x26800,0x40000000,0x211c0,0x219c0,0x201c0,0x209c0,0x221c0,0x225c8,0x234e0,0x11c0,0x40000000,0xc4c44444,0x4378000,0x1a40,0x8940,0x0,0x3f80,0x0,0x3f80,0x3f800000,0x0,0x0,0x3f800000,0x40000000,0x22ce0,0x0,0x0
.long 0x1d0,0x26810,0x40000000,0x211d0,0x219d0,0x201d0,0x209d0,0x221d0,0x225d8,0x234f0,0x11d0,0x40000000,0xe4e44444,0x40000000,0x1a48,0x8948,0x0,0x3f80,0x0,0x3f80,0x0,0x0,0x0,0x0,0x40000000,0x22cf0,0x0,0x0
.long 0x1e0,0x26820,0x40000000,0x211e0,0x219e0,0x201e0,0x209e0,0x221e0,0x225e8,0x234e8,0x11e0,0x40000000,0xd4d4eeee,0x40000000,0x1a50,0x8950,0x0,0x3f80,0x0,0x3f80,0x0,0x3f800000,0x0,0x0,0x40000000,0x22ce0,0x0,0x0
.long 0x1f0,0x26830,0x40000000,0x211f0,0x219f0,0x201f0,0x209f0,0x221f0,0x225f8,0x234f8,0x11f0,0x40000000,0xe4e4eeee,0x40000000,0x1a58,0x8958,0x0,0x3f800000,0x0,0x3f800000,0x0,0x0,0x0,0x0,0x40000000,0x22cf0,0x0,0x0
.long 0x200,0x21000,0x40000000,0x21200,0x21a00,0x20200,0x20a00,0x22200,0x22608,0x23500,0x1200,0x40000000,0x4c4c4444,0x40000000,0x2180,0x9480,0x3f80,0x0,0x3f80,0x0,0x0,0x0,0x0,0x0,0x40000000,0x22d00,0x0,0x0
.long 0x210,0x21010,0x40000000,0x21210,0x21a10,0x20210,0x20a10,0x22210,0x22618,0x23510,0x1210,0x40000000,0x4e4e4444,0x40000000,0x2188,0x9488,0x3f80,0x0,0x3f80,0x0,0x3f80,0x0,0x0,0x3f80,0x40000000,0x22d10,0x0,0x0
.long 0x220,0x21020,0x40000000,0x21220,0x21a20,0x20220,0x20a20,0x22220,0x22628,0x23508,0x1220,0x40000000,0x4d4deeee,0x40000000,0x2190,0x9490,0x3f80,0x0,0x3f80,0x0,0x0,0x0,0x0,0x0,0x40000000,0x22d00,0x0,0x0
.long 0x230,0x21030,0x40000000,0x21230,0x21a30,0x20230,0x20a30,0x22230,0x22638,0x23518,0x1230,0x40000000,0x4e4eeeee,0x40000000,0x2198,0x9498,0x3f800000,0x0,0x3f800000,0x0,0x0,0x3f80,0x0,0x0,0x40000000,0x22d10,0x0,0x0
.long 0x240,0x23000,0x40000000,0x21240,0x21a40,0x20240,0x20a40,0x22240,0x22648,0x23520,0x1240,0x40000000,0xc4c44444,0x40000000,0x2280,0x98a0,0x0,0x3f80,0x0,0x3f80,0x0,0x0,0x0,0x0,0x40000000,0x22d20,0x0,0x0
.long 0x250,0x23010,0x40000000,0x21250,0x21a50,0x20250,0x20a50,0x22250,0x22658,0x23530,0x1250,0x40000000,0xe4e44444,0x40000000,0x2288,0x98a8,0x0,0x3f80,0x0,0x3f80,0x3f800000,0x0,0x0,0x3f800000,0x40000000,0x22d30,0x0,0x0
.long 0x260,0x23020,0x40000000,0x21260,0x21a60,0x20260,0x20a60,0x22260,0x22668,0x23528,0x1260,0x40000000,0xd4d4eeee,0x40000000,0x2290,0x98b0,0x0,0x3f80,0x0,0x3f80,0x0,0x0,0x0,0x0,0x40000000,0x22d20,0x0,0x0
.long 0x270,0x23030,0x40000000,0x21270,0x21a70,0x20270,0x20a70,0x22270,0x22678,0x23538,0x1270,0x40000000,0xe4e4eeee,0x40000000,0x2298,0x98b8,0x0,0x3f800000,0x0,0x3f800000,0x0,0x3f800000,0x0,0x0,0x40000000,0x22d30,0x0,0x0
.long 0x280,0x25000,0x40000000,0x21280,0x21a80,0x20280,0x20a80,0x22280,0x22688,0x23540,0x1280,0x40000000,0x4c4c4444,0x40000000,0x3200,0x94a0,0x3f80,0x0,0x3f80,0x0,0x0,0x0,0x3f80,0x0,0x40000000,0x22d40,0x0,0x0
.long 0x290,0x25010,0x40000000,0x21290,0x21a90,0x20290,0x20a90,0x22290,0x22698,0x23550,0x1290,0x40000000,0x4e4e4444,0x40000000,0x3208,0x94a8,0x3f80,0x0,0x3f80,0x0,0x0,0x0,0x3f800000,0x0,0x40000000,0x22d50,0x0,0x0
.long 0x2a0,0x25020,0x40000000,0x212a0,0x21aa0,0x202a0,0x20aa0,0x222a0,0x226a8,0x23548,0x12a0,0x40000000,0x4d4deeee,0x40000000,0x3210,0x94b0,0x3f80,0x0,0x3f80,0x0,0x0,0x0,0x3f80,0x0,0x40000000,0x22d40,0x0,0x0
.long 0x2b0,0x25030,0x40000000,0x212b0,0x21ab0,0x202b0,0x20ab0,0x222b0,0x226b8,0x23558,0x12b0,0x40000000,0x4e4eeeee,0x40000000,0x3218,0x94b8,0x3f800000,0x0,0x3f800000,0x0,0x0,0x0,0x3f800000,0x0,0x40000000,0x22d50,0x0,0x0
.long 0x2c0,0x27000,0x40000000,0x212c0,0x21ac0,0x202c0,0x20ac0,0x222c0,0x226c8,0x23560,0x12c0,0x40000000,0xc4c44444,0x40000000,0x3300,0x98c0,0x0,0x3f80,0x0,0x3f80,0x0,0x0,0x0,0x0,0x40000000,0x22d60,0x0,0x0
.long 0x2d0,0x27010,0x40000000,0x212d0,0x21ad0,0x202d0,0x20ad0,0x222d0,0x226d8,0x23570,0x12d0,0x40000000,0xe4e44444,0x40000000,0x3308,0x98c8,0x0,0x3f80,0x0,0x3f80,0x0,0x0,0x0,0x0,0x40000000,0x22d70,0x0,0x0
.long 0x2e0,0x27020,0x40000000,0x212e0,0x21ae0,0x202e0,0x20ae0,0x222e0,0x226e8,0x23568,0x12e0,0x40000000,0xd4d4eeee,0x40000000,0x3310,0x98d0,0x0,0x3f80,0x0,0x3f80,0x0,0x0,0x0,0x0,0x40000000,0x22d60,0x0,0x0
.long 0x2f0,0x27030,0x40000000,0x212f0,0x21af0,0x202f0,0x20af0,0x222f0,0x226f8,0x23578,0x12f0,0x40000000,0xe4e4eeee,0x40000000,0x3318,0x98d8,0x0,0x3f800000,0x0,0x3f800000,0x0,0x0,0x0,0x0,0x40000000,0x22d70,0x0,0x0
.long 0x300,0x21800,0x40000000,0x21300,0x21b00,0x20300,0x20b00,0x22300,0x22708,0x23580,0x1300,0x40000000,0x4c4c4444,0x40000000,0x29c0,0x9580,0x3f80,0x0,0x3f80,0x0,0x0,0x0,0x0,0x0,0x40000000,0x22d80,0x0,0x0
.long 0x310,0x21810,0x40000000,0x21310,0x21b10,0x20310,0x20b10,0x22310,0x22718,0x23590,0x1310,0x40000000,0x4e4e4444,0x40000000,0x29c8,0x9588,0x3f80,0x0,0x3f80,0x0,0x0,0x0,0x0,0x0,0x40000000,0x22d90,0x0,0x0
.long 0x320,0x21820,0x40000000,0x21320,0x21b20,0x20320,0x20b20,0x22320,0x22728,0x23588,0x1320,0x40000000,0x4d4deeee,0x40000000,0x29d0,0x9590,0x3f80,0x0,0x3f80,0x0,0x0,0x0,0x0,0x0,0x40000000,0x22d80,0x0,0x0
.long 0x330,0x21830,0x40000000,0x21330,0x21b30,0x20330,0x20b30,0x22330,0x22738,0x23598,0x1330,0x40000000,0x4e4eeeee,0x40000000,0x29d8,0x9598,0x3f800000,0x0,0x3f800000,0x0,0x0,0x0,0x0,0x0,0x40000000,0x22d90,0x0,0x0
.long 0x340,0x23800,0x40000000,0x21340,0x21b40,0x20340,0x20b40,0x22340,0x22748,0x235a0,0x1340,0x40000000,0xc4c44444,0x40000000,0x2ac0,0x99a0,0x0,0x3f80,0x0,0x3f80,0x0,0x0,0x0,0x0,0x40000000,0x22da0,0x0,0x0
.long 0x350,0x23810,0x40000000,0x21350,0x21b50,0x20350,0x20b50,0x22350,0x22758,0x235b0,0x1350,0x40000000,0xe4e44444,0x40000000,0x2ac8,0x99a8,0x0,0x3f80,0x0,0x3f80,0x0,0x0,0x0,0x0,0x40000000,0x22db0,0x0,0x0
.long 0x360,0x23820,0x40000000,0x21360,0x21b60,0x20360,0x20b60,0x22360,0x22768,0x235a8,0x1360,0x40000000,0xd4d4eeee,0x40000000,0x2ad0,0x99b0,0x0,0x3f80,0x0,0x3f80,0x0,0x0,0x0,0x0,0x40000000,0x22da0,0x0,0x0
.long 0x370,0x23830,0x40000000,0x21370,0x21b70,0x20370,0x20b70,0x22370,0x22778,0x235b8,0x1370,0x40000000,0xe4e4eeee,0x40000000,0x2ad8,0x99b8,0x0,0x3f800000,0x0,0x3f800000,0x0,0x0,0x0,0x0,0x40000000,0x22db0,0x0,0x0
.long 0x380,0x25800,0x40000000,0x21380,0x21b80,0x20380,0x20b80,0x22380,0x22788,0x235c0,0x1380,0x40000000,0x4c4c4444,0x40000000,0x3a40,0x95a0,0x3f80,0x0,0x3f80,0x0,0x0,0x0,0x0,0x0,0x40000000,0x22dc0,0x0,0x0
.long 0x390,0x25810,0x40000000,0x21390,0x21b90,0x20390,0x20b90,0x22390,0x22798,0x235d0,0x1390,0x40000000,0x4e4e4444,0x40000000,0x3a48,0x95a8,0x3f80,0x0,0x3f80,0x0,0x3f80,0x0,0x0,0x3f80,0x40000000,0x22dd0,0x0,0x0
.long 0x3a0,0x25820,0x40000000,0x213a0,0x21ba0,0x203a0,0x20ba0,0x223a0,0x227a8,0x235c8,0x13a0,0x40000000,0x4d4deeee,0x40000000,0x3a50,0x95b0,0x3f80,0x0,0x3f80,0x0,0x0,0x0,0x0,0x0,0x40000000,0x22dc0,0x0,0x0
.long 0x3b0,0x25830,0x40000000,0x213b0,0x21bb0,0x203b0,0x20bb0,0x223b0,0x227b8,0x235d8,0x13b0,0x40000000,0x4e4eeeee,0x40000000,0x3a58,0x95b8,0x3f800000,0x0,0x3f800000,0x0,0x0,0x3f80,0x0,0x0,0x40000000,0x22dd0,0x0,0x0
.long 0x3c0,0x27800,0x40000000,0x213c0,0x21bc0,0x203c0,0x20bc0,0x223c0,0x227c8,0x235e0,0x13c0,0x40000000,0xc4c44444,0x40000000,0x3b40,0x99c0,0x0,0x3f80,0x0,0x3f80,0x0,0x0,0x3f80,0x0,0x40000000,0x22de0,0x0,0x0
.long 0x3d0,0x27810,0x40000000,0x213d0,0x21bd0,0x203d0,0x20bd0,0x223d0,0x227d8,0x235f0,0x13d0,0x40000000,0xe4e44444,0x40000000,0x3b48,0x99c8,0x0,0x3f80,0x0,0x3f80,0x3f800000,0x0,0x3f800000,0x3f800000,0x40000000,0x22df0,0x0,0x0
.long 0x3e0,0x27820,0x40000000,0x213e0,0x21be0,0x203e0,0x20be0,0x223e0,0x227e8,0x235e8,0x13e0,0x40000000,0xd4d4eeee,0x40000000,0x3b50,0x99d0,0x0,0x3f80,0x0,0x3f80,0x0,0x0,0x3f80,0x0,0x40000000,0x22de0,0x0,0x0
.long 0x3f0,0x27830,0x40000000,0x213f0,0x21bf0,0x203f0,0x20bf0,0x223f0,0x227f8,0x235f8,0x13f0,0x40000000,0xe4e4eeee,0x40000000,0x3b58,0x99d8,0x0,0x3f800000,0x0,0x3f800000,0x0,0x3f800000,0x3f800000,0x0,0x40000000,0x22df0,0x0,0x0
.long 0x0,0x30000,0x0,0x21800,0x21000,0x20800,0x20000,0x22000,0x2240c,0x23600,0x1800,0x0,0x4c4c4444,0x1000,0xc0,0xc600,0x3f80,0x0,0x3f80,0x0,0x3f80,0x0,0x3f80,0x3f80,0x0,0x22c00,0x0,0x0
.long 0x10,0x30010,0x4,0x21810,0x21010,0x20810,0x20010,0x22010,0x2241c,0x23610,0x1810,0x40000000,0x4e4e4444,0x200800,0xc8,0xc608,0x3f80,0x0,0x3f80,0x0,0x0,0x0,0x3f800000,0x0,0x2,0x22c10,0x0,0x0
.long 0x20,0x30020,0x8,0x21820,0x21020,0x20820,0x20020,0x22020,0x2242c,0x23608,0x1820,0x40000000,0x4d4deeee,0x400000,0xd0,0xc610,0x3f80,0x0,0x3f80,0x0,0x0,0x3f80,0x3f80,0x0,0x4,0x22c00,0x0,0x0
.long 0x30,0x30030,0xc,0x21830,0x21030,0x20830,0x20030,0x22030,0x2243c,0x23618,0x1830,0x40000000,0x4e4eeeee,0x601000,0xd8,0xc618,0x3f800000,0x0,0x3f800000,0x0,0x0,0x0,0x3f800000,0x0,0x6,0x22c10,0x0,0x0
.long 0x40,0x32000,0x40000000,0x21840,0x21040,0x20840,0x20040,0x22040,0x2244c,0x23620,0x1840,0x40000000,0xc4c44444,0x800800,0x1c0,0xca20,0x0,0x3f80,0x0,0x3f80,0x3f800000,0x0,0x0,0x3f800000,0x40000000,0x22c20,0x0,0x0
.long 0x50,0x32010,0x40000000,0x21850,0x21050,0x20850,0x20050,0x22050,0x2245c,0x23630,0x1850,0x40000000,0xe4e44444,0xa00000,0x1c8,0xca28,0x0,0x3f80,0x0,0x3f80,0x0,0x0,0x0,0x0,0x40000000,0x22c30,0x0,0x0
.long 0x60,0x32020,0x40000000,0x21860,0x21060,0x20860,0x20060,0x22060,0x2246c,0x23628,0x1860,0x40000000,0xd4d4eeee,0xc01000,0x1d0,0xca30,0x0,0x3f80,0x0,0x3f80,0x0,0x3f800000,0x0,0x0,0x40000000,0x22c20,0x0,0x0
.long 0x70,0x32030,0x40000000,0x21870,0x21070,0x20870,0x20070,0x22070,0x2247c,0x23638,0x1870,0x40000000,0xe4e4eeee,0xe00800,0x1d8,0xca38,0x0,0x3f800000,0x0,0x3f800000,0x0,0x0,0x0,0x0,0x40000000,0x22c30,0x0,0x0
.long 0x80,0x34000,0x10,0x21880,0x21080,0x20880,0x20080,0x22080,0x2248c,0x23640,0x1880,0x40000000,0x4c4c4444,0x1000000,0x1140,0xc620,0x3f80,0x0,0x3f80,0x0,0x0,0x0,0x0,0x0,0x400,0x22c40,0x0,0x0
.long 0x90,0x34010,0x14,0x21890,0x21090,0x20890,0x20090,0x22090,0x2249c,0x23650,0x1890,0x40000000,0x4e4e4444,0x1201000,0x1148,0xc628,0x3f80,0x0,0x3f80,0x0,0x0,0x0,0x0,0x0,0x402,0x22c50,0x0,0x0
.long 0xa0,0x34020,0x18,0x218a0,0x210a0,0x208a0,0x200a0,0x220a0,0x224ac,0x23648,0x18a0,0x40000000,0x4d4deeee,0x1400800,0x1150,0xc630,0x3f80,0x0,0x3f80,0x0,0x0,0x0,0x0,0x0,0x404,0x22c40,0x0,0x0
.long 0xb0,0x34030,0x1c,0x218b0,0x210b0,0x208b0,0x200b0,0x220b0,0x224bc,0x23658,0x18b0,0x40000000,0x4e4eeeee,0x1600000,0x1158,0xc638,0x3f800000,0x0,0x3f800000,0x0,0x0,0x0,0x0,0x0,0x406,0x22c50,0x0,0x0
.long 0xc0,0x36000,0x40000000,0x218c0,0x210c0,0x208c0,0x200c0,0x220c0,0x224cc,0x23660,0x18c0,0x40000000,0xc4c44444,0x1801000,0x1240,0xca40,0x0,0x3f80,0x0,0x3f80,0x0,0x0,0x0,0x0,0x40000000,0x22c60,0x0,0x0
.long 0xd0,0x36010,0x40000000,0x218d0,0x210d0,0x208d0,0x200d0,0x220d0,0x224dc,0x23670,0x18d0,0x40000000,0xe4e44444,0x1a00800,0x1248,0xca48,0x0,0x3f80,0x0,0x3f80,0x0,0x0,0x0,0x0,0x40000000,0x22c70,0x0,0x0
.long 0xe0,0x36020,0x40000000,0x218e0,0x210e0,0x208e0,0x200e0,0x220e0,0x224ec,0x23668,0x18e0,0x40000000,0xd4d4eeee,0x1c00000,0x1250,0xca50,0x0,0x3f80,0x0,0x3f80,0x0,0x0,0x0,0x0,0x40000000,0x22c60,0x0,0x0
.long 0xf0,0x36030,0x40000000,0x218f0,0x210f0,0x208f0,0x200f0,0x220f0,0x224fc,0x23678,0x18f0,0x40000000,0xe4e4eeee,0x1e01000,0x1258,0xca58,0x0,0x3f800000,0x0,0x3f800000,0x0,0x0,0x0,0x0,0x40000000,0x22c70,0x0,0x0
.long 0x100,0x30800,0x200,0x21900,0x21100,0x20900,0x20100,0x22100,0x2250c,0x23680,0x1900,0x40000000,0x4c4c4444,0x2000800,0x900,0xc700,0x3f80,0x0,0x3f80,0x0,0x0,0x0,0x0,0x0,0x40,0x22c80,0x0,0x0
.long 0x110,0x30810,0x204,0x21910,0x21110,0x20910,0x20110,0x22110,0x2251c,0x23690,0x1910,0x40000000,0x4e4e4444,0x2200000,0x908,0xc708,0x3f80,0x0,0x3f80,0x0,0x0,0x0,0x0,0x0,0x42,0x22c90,0x0,0x0
.long 0x120,0x30820,0x208,0x21920,0x21120,0x20920,0x20120,0x22120,0x2252c,0x23688,0x1920,0x40000000,0x4d4deeee,0x2401000,0x910,0xc710,0x3f80,0x0,0x3f80,0x0,0x0,0x0,0x0,0x0,0x44,0x22c80,0x0,0x0
.long 0x130,0x30830,0x20c,0x21930,0x21130,0x20930,0x20130,0x22130,0x2253c,0x23698,0x1930,0x40000000,0x4e4eeeee,0x2600800,0x918,0xc718,0x3f800000,0x0,0x3f800000,0x0,0x0,0x0,0x0,0x0,0x46,0x22c90,0x0,0x0
.long 0x140,0x32800,0x40000000,0x21940,0x21140,0x20940,0x20140,0x22140,0x2254c,0x236a0,0x1940,0x40000000,0xc4c44444,0x2800000,0xa00,0xcb20,0x0,0x3f80,0x0,0x3f80,0x0,0x0,0x3f80,0x0,0x40000000,0x22ca0,0x0,0x0
.long 0x150,0x32810,0x40000000,0x21950,0x21150,0x20950,0x20150,0x22150,0x2255c,0x236b0,0x1950,0x40000000,0xe4e44444,0x2a01000,0xa08,0xcb28,0x0,0x3f80,0x0,0x3f80,0x0,0x0,0x3f800000,0x0,0x40000000,0x22cb0,0x0,0x0
.long 0x160,0x32820,0x40000000,0x21960,0x21160,0x20960,0x20160,0x22160,0x2256c,0x236a8,0x1960,0x40000000,0xd4d4eeee,0x2c00800,0xa10,0xcb30,0x0,0x3f80,0x0,0x3f80,0x0,0x0,0x3f80,0x0,0x40000000,0x22ca0,0x0,0x0
.long 0x170,0x32830,0x40000000,0x21970,0x21170,0x20970,0x20170,0x22170,0x2257c,0x236b8,0x1970,0x40000000,0xe4e4eeee,0x2e00000,0xa18,0xcb38,0x0,0x3f800000,0x0,0x3f800000,0x0,0x0,0x3f800000,0x0,0x40000000,0x22cb0,0x0,0x0
.long 0x180,0x34800,0x210,0x21980,0x21180,0x20980,0x20180,0x22180,0x2258c,0x236c0,0x1980,0x40000000,0x4c4c4444,0x3000000,0x1980,0xc720,0x3f80,0x0,0x3f80,0x0,0x3f80,0x0,0x0,0x3f80,0x440,0x22cc0,0x0,0x0
.long 0x190,0x34810,0x214,0x21990,0x21190,0x20990,0x20190,0x22190,0x2259c,0x236d0,0x1990,0x40000000,0x4e4e4444,0x3200000,0x1988,0xc728,0x3f80,0x0,0x3f80,0x0,0x0,0x0,0x0,0x0,0x442,0x22cd0,0x0,0x0
.long 0x1a0,0x34820,0x218,0x219a0,0x211a0,0x209a0,0x201a0,0x221a0,0x225ac,0x236c8,0x19a0,0x40000000,0x4d4deeee,0x3400000,0x1990,0xc730,0x3f80,0x0,0x3f80,0x0,0x0,0x3f80,0x0,0x0,0x444,0x22cc0,0x0,0x0
.long 0x1b0,0x34830,0x21c,0x219b0,0x211b0,0x209b0,0x201b0,0x221b0,0x225bc,0x236d8,0x19b0,0x40000000,0x4e4eeeee,0x3600000,0x1998,0xc738,0x3f800000,0x0,0x3f800000,0x0,0x0,0x0,0x0,0x0,0x446,0x22cd0,0x0,0x0
.long 0x1c0,0x36800,0x40000000,0x219c0,0x211c0,0x209c0,0x201c0,0x221c0,0x225cc,0x236e0,0x19c0,0x40000000,0xc4c44444,0x4378000,0x1a80,0xcb40,0x0,0x3f80,0x0,0x3f80,0x3f800000,0x0,0x0,0x3f800000,0x40000000,0x22ce0,0x0,0x0
.long 0x1d0,0x36810,0x40000000,0x219d0,0x211d0,0x209d0,0x201d0,0x221d0,0x225dc,0x236f0,0x19d0,0x40000000,0xe4e44444,0x40000000,0x1a88,0xcb48,0x0,0x3f80,0x0,0x3f80,0x0,0x0,0x0,0x0,0x40000000,0x22cf0,0x0,0x0
.long 0x1e0,0x36820,0x40000000,0x219e0,0x211e0,0x209e0,0x201e0,0x221e0,0x225ec,0x236e8,0x19e0,0x40000000,0xd4d4eeee,0x40000000,0x1a90,0xcb50,0x0,0x3f80,0x0,0x3f80,0x0,0x3f800000,0x0,0x0,0x40000000,0x22ce0,0x0,0x0
.long 0x1f0,0x36830,0x40000000,0x219f0,0x211f0,0x209f0,0x201f0,0x221f0,0x225fc,0x236f8,0x19f0,0x40000000,0xe4e4eeee,0x40000000,0x1a98,0xcb58,0x0,0x3f800000,0x0,0x3f800000,0x0,0x0,0x0,0x0,0x40000000,0x22cf0,0x0,0x0
.long 0x200,0x31000,0x40000000,0x21a00,0x21200,0x20a00,0x20200,0x22200,0x2260c,0x23700,0x1a00,0x40000000,0x4c4c4444,0x40000000,0x21c0,0xd680,0x3f80,0x0,0x3f80,0x0,0x0,0x0,0x0,0x0,0x40000000,0x22d00,0x0,0x0
.long 0x210,0x31010,0x40000000,0x21a10,0x21210,0x20a10,0x20210,0x22210,0x2261c,0x23710,0x1a10,0x40000000,0x4e4e4444,0x40000000,0x21c8,0xd688,0x3f80,0x0,0x3f80,0x0,0x3f80,0x0,0x0,0x3f80,0x40000000,0x22d10,0x0,0x0
.long 0x220,0x31020,0x40000000,0x21a20,0x21220,0x20a20,0x20220,0x22220,0x2262c,0x23708,0x1a20,0x40000000,0x4d4deeee,0x40000000,0x21d0,0xd690,0x3f80,0x0,0x3f80,0x0,0x0,0x0,0x0,0x0,0x40000000,0x22d00,0x0,0x0
.long 0x230,0x31030,0x40000000,0x21a30,0x21230,0x20a30,0x20230,0x22230,0x2263c,0x23718,0x1a30,0x40000000,0x4e4eeeee,0x40000000,0x21d8,0xd698,0x3f800000,0x0,0x3f800000,0x0,0x0,0x3f80,0x0,0x0,0x40000000,0x22d10,0x0,0x0
.long 0x240,0x33000,0x40000000,0x21a40,0x21240,0x20a40,0x20240,0x22240,0x2264c,0x23720,0x1a40,0x40000000,0xc4c44444,0x40000000,0x22c0,0xdaa0,0x0,0x3f80,0x0,0x3f80,0x0,0x0,0x0,0x0,0x40000000,0x22d20,0x0,0x0
.long 0x250,0x33010,0x40000000,0x21a50,0x21250,0x20a50,0x20250,0x22250,0x2265c,0x23730,0x1a50,0x40000000,0xe4e44444,0x40000000,0x22c8,0xdaa8,0x0,0x3f80,0x0,0x3f80,0x3f800000,0x0,0x0,0x3f800000,0x40000000,0x22d30,0x0,0x0
.long 0x260,0x33020,0x40000000,0x21a60,0x21260,0x20a60,0x20260,0x22260,0x2266c,0x23728,0x1a60,0x40000000,0xd4d4eeee,0x40000000,0x22d0,0xdab0,0x0,0x3f80,0x0,0x3f80,0x0,0x0,0x0,0x0,0x40000000,0x22d20,0x0,0x0
.long 0x270,0x33030,0x40000000,0x21a70,0x21270,0x20a70,0x20270,0x22270,0x2267c,0x23738,0x1a70,0x40000000,0xe4e4eeee,0x40000000,0x22d8,0xdab8,0x0,0x3f800000,0x0,0x3f800000,0x0,0x3f800000,0x0,0x0,0x40000000,0x22d30,0x0,0x0
.long 0x280,0x35000,0x40000000,0x21a80,0x21280,0x20a80,0x20280,0x22280,0x2268c,0x23740,0x1a80,0x40000000,0x4c4c4444,0x40000000,0x3240,0xd6a0,0x3f80,0x0,0x3f80,0x0,0x0,0x0,0x3f80,0x0,0x40000000,0x22d40,0x0,0x0
.long 0x290,0x35010,0x40000000,0x21a90,0x21290,0x20a90,0x20290,0x22290,0x2269c,0x23750,0x1a90,0x40000000,0x4e4e4444,0x40000000,0x3248,0xd6a8,0x3f80,0x0,0x3f80,0x0,0x0,0x0,0x3f800000,0x0,0x40000000,0x22d50,0x0,0x0
.long 0x2a0,0x35020,0x40000000,0x21aa0,0x212a0,0x20aa0,0x202a0,0x222a0,0x226ac,0x23748,0x1aa0,0x40000000,0x4d4deeee,0x40000000,0x3250,0xd6b0,0x3f80,0x0,0x3f80,0x0,0x0,0x0,0x3f80,0x0,0x40000000,0x22d40,0x0,0x0
.long 0x2b0,0x35030,0x40000000,0x21ab0,0x212b0,0x20ab0,0x202b0,0x222b0,0x226bc,0x23758,0x1ab0,0x40000000,0x4e4eeeee,0x40000000,0x3258,0xd6b8,0x3f800000,0x0,0x3f800000,0x0,0x0,0x0,0x3f800000,0x0,0x40000000,0x22d50,0x0,0x0
.long 0x2c0,0x37000,0x40000000,0x21ac0,0x212c0,0x20ac0,0x202c0,0x222c0,0x226cc,0x23760,0x1ac0,0x40000000,0xc4c44444,0x40000000,0x3340,0xdac0,0x0,0x3f80,0x0,0x3f80,0x0,0x0,0x0,0x0,0x40000000,0x22d60,0x0,0x0
.long 0x2d0,0x37010,0x40000000,0x21ad0,0x212d0,0x20ad0,0x202d0,0x222d0,0x226dc,0x23770,0x1ad0,0x40000000,0xe4e44444,0x40000000,0x3348,0xdac8,0x0,0x3f80,0x0,0x3f80,0x0,0x0,0x0,0x0,0x40000000,0x22d70,0x0,0x0
.long 0x2e0,0x37020,0x40000000,0x21ae0,0x212e0,0x20ae0,0x202e0,0x222e0,0x226ec,0x23768,0x1ae0,0x40000000,0xd4d4eeee,0x40000000,0x3350,0xdad0,0x0,0x3f80,0x0,0x3f80,0x0,0x0,0x0,0x0,0x40000000,0x22d60,0x0,0x0
.long 0x2f0,0x37030,0x40000000,0x21af0,0x212f0,0x20af0,0x202f0,0x222f0,0x226fc,0x23778,0x1af0,0x40000000,0xe4e4eeee,0x40000000,0x3358,0xdad8,0x0,0x3f800000,0x0,0x3f800000,0x0,0x0,0x0,0x0,0x40000000,0x22d70,0x0,0x0
.long 0x300,0x31800,0x40000000,0x21b00,0x21300,0x20b00,0x20300,0x22300,0x2270c,0x23780,0x1b00,0x40000000,0x4c4c4444,0x40000000,0x2a00,0xd780,0x3f80,0x0,0x3f80,0x0,0x0,0x0,0x0,0x0,0x40000000,0x22d80,0x0,0x0
.long 0x310,0x31810,0x40000000,0x21b10,0x21310,0x20b10,0x20310,0x22310,0x2271c,0x23790,0x1b10,0x40000000,0x4e4e4444,0x40000000,0x2a08,0xd788,0x3f80,0x0,0x3f80,0x0,0x0,0x0,0x0,0x0,0x40000000,0x22d90,0x0,0x0
.long 0x320,0x31820,0x40000000,0x21b20,0x21320,0x20b20,0x20320,0x22320,0x2272c,0x23788,0x1b20,0x40000000,0x4d4deeee,0x40000000,0x2a10,0xd790,0x3f80,0x0,0x3f80,0x0,0x0,0x0,0x0,0x0,0x40000000,0x22d80,0x0,0x0
.long 0x330,0x31830,0x40000000,0x21b30,0x21330,0x20b30,0x20330,0x22330,0x2273c,0x23798,0x1b30,0x40000000,0x4e4eeeee,0x40000000,0x2a18,0xd798,0x3f800000,0x0,0x3f800000,0x0,0x0,0x0,0x0,0x0,0x40000000,0x22d90,0x0,0x0
.long 0x340,0x33800,0x40000000,0x21b40,0x21340,0x20b40,0x20340,0x22340,0x2274c,0x237a0,0x1b40,0x40000000,0xc4c44444,0x40000000,0x2b00,0xdba0,0x0,0x3f80,0x0,0x3f80,0x0,0x0,0x0,0x0,0x40000000,0x22da0,0x0,0x0
.long 0x350,0x33810,0x40000000,0x21b50,0x21350,0x20b50,0x20350,0x22350,0x2275c,0x237b0,0x1b50,0x40000000,0xe4e44444,0x40000000,0x2b08,0xdba8,0x0,0x3f80,0x0,0x3f80,0x0,0x0,0x0,0x0,0x40000000,0x22db0,0x0,0x0
.long 0x360,0x33820,0x40000000,0x21b60,0x21360,0x20b60,0x20360,0x22360,0x2276c,0x237a8,0x1b60,0x40000000,0xd4d4eeee,0x40000000,0x2b10,0xdbb0,0x0,0x3f80,0x0,0x3f80,0x0,0x0,0x0,0x0,0x40000000,0x22da0,0x0,0x0
.long 0x370,0x33830,0x40000000,0x21b70,0x21370,0x20b70,0x20370,0x22370,0x2277c,0x237b8,0x1b70,0x40000000,0xe4e4eeee,0x40000000,0x2b18,0xdbb8,0x0,0x3f800000,0x0,0x3f800000,0x0,0x0,0x0,0x0,0x40000000,0x22db0,0x0,0x0
.long 0x380,0x35800,0x40000000,0x21b80,0x21380,0x20b80,0x20380,0x22380,0x2278c,0x237c0,0x1b80,0x40000000,0x4c4c4444,0x40000000,0x3a80,0xd7a0,0x3f80,0x0,0x3f80,0x0,0x0,0x0,0x0,0x0,0x40000000,0x22dc0,0x0,0x0
.long 0x390,0x35810,0x40000000,0x21b90,0x21390,0x20b90,0x20390,0x22390,0x2279c,0x237d0,0x1b90,0x40000000,0x4e4e4444,0x40000000,0x3a88,0xd7a8,0x3f80,0x0,0x3f80,0x0,0x3f80,0x0,0x0,0x3f80,0x40000000,0x22dd0,0x0,0x0
.long 0x3a0,0x35820,0x40000000,0x21ba0,0x213a0,0x20ba0,0x203a0,0x223a0,0x227ac,0x237c8,0x1ba0,0x40000000,0x4d4deeee,0x40000000,0x3a90,0xd7b0,0x3f80,0x0,0x3f80,0x0,0x0,0x0,0x0,0x0,0x40000000,0x22dc0,0x0,0x0
.long 0x3b0,0x35830,0x40000000,0x21bb0,0x213b0,0x20bb0,0x203b0,0x223b0,0x227bc,0x237d8,0x1bb0,0x40000000,0x4e4eeeee,0x40000000,0x3a98,0xd7b8,0x3f800000,0x0,0x3f800000,0x0,0x0,0x3f80,0x0,0x0,0x40000000,0x22dd0,0x0,0x0
.long 0x3c0,0x37800,0x40000000,0x21bc0,0x213c0,0x20bc0,0x203c0,0x223c0,0x227cc,0x237e0,0x1bc0,0x40000000,0xc4c44444,0x40000000,0x3b80,0xdbc0,0x0,0x3f80,0x0,0x3f80,0x0,0x0,0x3f80,0x0,0x40000000,0x22de0,0x0,0x0
.long 0x3d0,0x37810,0x40000000,0x21bd0,0x213d0,0x20bd0,0x203d0,0x223d0,0x227dc,0x237f0,0x1bd0,0x40000000,0xe4e44444,0x40000000,0x3b88,0xdbc8,0x0,0x3f80,0x0,0x3f80,0x3f800000,0x0,0x3f800000,0x3f800000,0x40000000,0x22df0,0x0,0x0
.long 0x3e0,0x37820,0x40000000,0x21be0,0x213e0,0x20be0,0x203e0,0x223e0,0x227ec,0x237e8,0x1be0,0x40000000,0xd4d4eeee,0x40000000,0x3b90,0xdbd0,0x0,0x3f80,0x0,0x3f80,0x0,0x0,0x3f80,0x0,0x40000000,0x22de0,0x0,0x0
.long 0x3f0,0x37830,0x40000000,0x21bf0,0x213f0,0x20bf0,0x203f0,0x223f0,0x227fc,0x237f8,0x1bf0,0x40000000,0xe4e4eeee,0x40000000,0x3b98,0xdbd8,0x0,0x3f800000,0x0,0x3f800000,0x0,0x3f800000,0x3f800000,0x0,0x40000000,0x22df0,0x0,0x0
.p2align 8
T_W:
.long 0x0,0x0,0x0,0x0,0xffff,0x0,0x0,0xffff,0x0,0x0,0x0,0x0,0x0,0x0,0x0,0x0,0x3f80,0x0,0x0,0x0,0x24000,0x24000,0x0,0x20
.long 0x10,0x40000000,0x8,0x10,0xffff0000,0x0,0x0,0xffff0000,0x4,0x8,0x10,0x10,0x40,0x10,0x400,0x4,0x3f800000,0x0,0x0,0x0,0x24010,0x24010,0x1,0x28
.long 0x20,0x40000000,0x10,0x20,0xffff,0xffff,0x0,0x0,0x8,0x10,0x20,0x20,0x80,0x20,0x800,0x8,0x0,0x3f80,0x0,0x0,0x24020,0x24020,0x2,0x30
.long 0x30,0x40000000,0x18,0x30,0xffff0000,0xffff0000,0x0,0x0,0xc,0x18,0x30,0x30,0xc0,0x30,0xc00,0xc,0x0,0x3f800000,0x0,0x0,0x24030,0x24030,0x3,0x38
.long 0x40,0x40000000,0x420,0x400,0xffff,0xffff,0x0,0x0,0x10,0x20,0x40,0x400,0x110,0x40,0x1000,0x10,0x0,0x0,0x3f80,0x0,0x24040,0x24040,0x4,0x60
.long 0x50,0x40000000,0x428,0x410,0xffff0000,0xffff0000,0x0,0x0,0x14,0x28,0x50,0x410,0x150,0x50,0x1400,0x14,0x0,0x0,0x3f800000,0x0,0x24050,0x24050,0x5,0x68
.long 0x60,0x40000000,0x430,0x420,0xffff,0xffff,0x0,0x0,0x18,0x30,0x60,0x420,0x190,0x60,0x1800,0x18,0x0,0x0,0x0,0x3f80,0x24060,0x24060,0x6,0x70
.long 0x70,0x40000000,0x438,0x430,0xffff0000,0xffff0000,0x0,0x0,0x1c,0x38,0x70,0x430,0x1d0,0x70,0x1c00,0x1c,0x0,0x0,0x0,0x3f800000,0x24070,0x24070,0x7,0x78
.long 0x80,0x40000000,0x840,0x800,0xffff,0xffff,0x0,0x0,0x20,0x40,0x80,0x800,0x220,0x80,0x2000,0x20,0x0,0x0,0x0,0x0,0x24080,0x24080,0x8,0xa0
.long 0x90,0x40000000,0x848,0x810,0xffff0000,0xffff0000,0x0,0x0,0x24,0x48,0x90,0x810,0x260,0x90,0x2400,0x24,0x0,0x0,0x0,0x0,0x24090,0x24090,0x9,0xa8
.long 0xa0,0x40000000,0x850,0x820,0xffff,0xffff,0x0,0x0,0x28,0x50,0xa0,0x820,0x2a0,0xa0,0x2800,0x28,0x0,0x0,0x0,0x0,0x240a0,0x240a0,0xa,0xb0
.long 0xb0,0x40000000,0x858,0x830,0xffff0000,0xffff0000,0x0,0x0,0x2c,0x58,0xb0,0x830,0x2e0,0xb0,0x2c00,0x2c,0x0,0x0,0x0,0x0,0x240b0,0x240b0,0xb,0xb8
.long 0xc0,0x40000000,0xc60,0xc00,0xffff,0xffff,0x0,0x0,0x30,0x60,0xc0,0xc00,0x330,0xc0,0x3000,0x30,0x0,0x0,0x0,0x0,0x240c0,0x240c0,0xc,0xe0
.long 0xd0,0x40000000,0xc68,0xc10,0xffff0000,0xffff0000,0x0,0x0,0x34,0x68,0xd0,0xc10,0x370,0xd0,0x3400,0x34,0x0,0x0,0x0,0x0,0x240d0,0x240d0,0xd,0xe8
.long 0xe0,0x40000000,0xc70,0xc20,0xffff,0xffff,0x0,0x0,0x38,0x70,0xe0,0xc20,0x3b0,0xe0,0x3800,0x38,0x0,0x0,0x0,0x0,0x240e0,0x240e0,0xe,0xf0
.long 0xf0,0x40000000,0xc78,0xc30,0xffff0000,0xffff0000,0x0,0x0,0x3c,0x78,0xf0,0xc30,0x3f0,0xf0,0x3c00,0x3c,0x0,0x0,0x0,0x0,0x240f0,0x240f0,0xf,0xf8
.long 0x100,0x40000000,0x2100,0x1010,0x0,0x0,0xffff,0xffff,0x0,0x80,0x100,0x1000,0x10,0x400,0x8,0x40,0x3f80,0x0,0x0,0x0,0x24100,0x24100,0xfffffffc,0x120
.long 0x110,0x40000000,0x2108,0x1000,0x0,0x0,0xffff0000,0xffff0000,0x4,0x88,0x110,0x1010,0x50,0x410,0x408,0x44,0x3f800000,0x0,0x0,0x0,0x24110,0x24110,0xfffffffd,0x128
.long 0x120,0x40000000,0x2110,0x1030,0x0,0x0,0xffff,0xffff,0x8,0x90,0x120,0x1020,0x90,0x420,0x808,0x48,0x0,0x3f80,0x0,0x0,0x24120,0x24120,0xfffffffe,0x130
.long 0x130,0x40000000,0x2118,0x1020,0x0,0x0,0xffff0000,0xffff0000,0xc,0x98,0x130,0x1030,0xd0,0x430,0xc08,0x4c,0x0,0x3f800000,0x0,0x0,0x24130,0x24130,0xffffffff,0x138
.long 0x140,0x40000000,0x2520,0x1410,0xffff,0x0,0x0,0xffff,0x10,0xa0,0x140,0x1400,0x100,0x440,0x1008,0x50,0x0,0x0,0x3f80,0x0,0x24140,0x24140,0x0,0x160
.long 0x150,0x40000000,0x2528,0x1400,0xffff0000,0x0,0x0,0xffff0000,0x14,0xa8,0x150,0x1410,0x140,0x450,0x1408,0x54,0x0,0x0,0x3f800000,0x0,0x24150,0x24150,0x1,0x168
.long 0x160,0x40000000,0x2530,0x1430,0xffff,0xffff,0x0,0x0,0x18,0xb0,0x160,0x1420,0x180,0x460,0x1808,0x58,0x0,0x0,0x0,0x3f80,0x24160,0x24160,0x2,0x170
.long 0x170,0x40000000,0x2538,0x1420,0xffff0000,0xffff0000,0x0,0x0,0x1c,0xb8,0x170,0x1430,0x1c0,0x470,0x1c08,0x5c,0x0,0x0,0x0,0x3f800000,0x24170,0x24170,0x3,0x178
.long 0x180,0x40000000,0x2940,0x1810,0xffff,0xffff,0x0,0x0,0x20,0xc0,0x180,0x1800,0x230,0x480,0x2008,0x60,0x0,0x0,0x0,0x0,0x24180,0x24180,0x4,0x1a0
.long 0x190,0x40000000,0x2948,0x1800,0xffff0000,0xffff0000,0x0,0x0,0x24,0xc8,0x190,0x1810,0x270,0x490,0x2408,0x64,0x0,0x0,0x0,0x0,0x24190,0x24190,0x5,0x1a8
.long 0x1a0,0x40000000,0x2950,0x1830,0xffff,0xffff,0x0,0x0,0x28,0xd0,0x1a0,0x1820,0x2b0,0x4a0,0x2808,0x68,0x0,0x0,0x0,0x0,0x241a0,0x241a0,0x6,0x1b0
.long 0x1b0,0x40000000,0x2958,0x1820,0xffff0000,0xffff0000,0x0,0x0,0x2c,0xd8,0x1b0,0x1830,0x2f0,0x4b0,0x2c08,0x6c,0x0,0x0,0x0,0x0,0x241b0,0x241b0,0x7,0x1b8
.long 0x1c0,0x40000000,0x2d60,0x1c10,0xffff,0xffff,0x0,0x0,0x30,0xe0,0x1c0,0x1c00,0x320,0x4c0,0x3008,0x70,0x0,0x0,0x0,0x0,0x241c0,0x241c0,0x8,0x1e0
.long 0x1d0,0x40000000,0x2d68,0x1c00,0xffff0000,0xffff0000,0x0,0x0,0x34,0xe8,0x1d0,0x1c10,0x360,0x4d0,0x3408,0x74,0x0,0x0,0x0,0x0,0x241d0,0x241d0,0x9,0x1e8
.long 0x1e0,0x40000000,0x2d70,0x1c30,0xffff,0xffff,0x0,0x0,0x38,0xf0,0x1e0,0x1c20,0x3a0,0x4e0,0x3808,0x78,0x0,0x0,0x0,0x0,0x241e0,0x241e0,0xa,0x1f0
.long 0x1f0,0x40000000,0x2d78,0x1c20,0xffff0000,0xffff0000,0x0,0x0,0x3c,0xf8,0x1f0,0x1c30,0x3e0,0x4f0,0x3c08,0x7c,0x0,0x0,0x0,0x0,0x241f0,0x241f0,0xb,0x1f8
.long 0x200,0x40000000,0x100,0x2020,0x0,0x0,0xffff,0xffff,0x0,0x100,0x200,0x2000,0x20,0x800,0x40000000,0x0,0x3f80,0x0,0x0,0x0,0x24200,0x24200,0xfffffff8,0x220
.long 0x210,0x40000000,0x108,0x2030,0x0,0x0,0xffff0000,0xffff0000,0x4,0x108,0x210,0x2010,0x60,0x810,0x40000000,0x4,0x3f800000,0x0,0x0,0x0,0x24210,0x24210,0xfffffff9,0x228
.long 0x220,0x40000000,0x110,0x2000,0x0,0x0,0xffff,0xffff,0x8,0x110,0x220,0x2020,0xa0,0x820,0x40000000,0x8,0x0,0x3f80,0x0,0x0,0x24220,0x24220,0xfffffffa,0x230
.long 0x230,0x40000000,0x118,0x2010,0x0,0x0,0xffff0000,0xffff0000,0xc,0x118,0x230,0x2030,0xe0,0x830,0x40000000,0xc,0x0,0x3f800000,0x0,0x0,0x24230,0x24230,0xfffffffb,0x238
.long 0x240,0x40000000,0x520,0x2420,0x0,0x0,0xffff,0xffff,0x10,0x120,0x240,0x2400,0x130,0x840,0x40000000,0x10,0x0,0x0,0x3f80,0x0,0x24240,0x24240,0xfffffffc,0x260
.long 0x250,0x40000000,0x528,0x2430,0x0,0x0,0xffff0000,0xffff0000,0x14,0x128,0x250,0x2410,0x170,0x850,0x40000000,0x14,0x0,0x0,0x3f800000,0x0,0x24250,0x24250,0xfffffffd,0x268
.long 0x260,0x40000000,0x530,0x2400,0x0,0x0,0xffff,0xffff,0x18,0x130,0x260,0x2420,0x1b0,0x860,0x40000000,0x18,0x0,0x0,0x0,0x3f80,0x24260,0x24260,0xfffffffe,0x270
.long 0x270,0x40000000,0x538,0x2410,0x0,0x0,0xffff0000,0xffff0000,0x1c,0x138,0x270,0x2430,0x1f0,0x870,0x40000000,0x1c,0x0,0x0,0x0,0x3f800000,0x24270,0x24270,0xffffffff,0x278
.long 0x280,0x40000000,0x940,0x2820,0xffff,0x0,0x0,0xffff,0x20,0x140,0x280,0x2800,0x200,0x880,0x40000000,0x20,0x0,0x0,0x0,0x0,0x24280,0x24280,0x0,0x2a0
.long 0x290,0x40000000,0x948,0x2830,0xffff0000,0x0,0x0,0xffff0000,0x24,0x148,0x290,0x2810,0x240,0x890,0x40000000,0x24,0x0,0x0,0x0,0x0,0x24290,0x24290,0x1,0x2a8
.long 0x2a0,0x40000000,0x950,0x2800,0xffff,0xffff,0x0,0x0,0x28,0x150,0x2a0,0x2820,0x280,0x8a0,0x40000000,0x28,0x0,0x0,0x0,0x0,0x242a0,0x242a0,0x2,0x2b0
.long 0x2b0,0x40000000,0x958,0x2810,0xffff0000,0xffff0000,0x0,0x0,0x2c,0x158,0x2b0,0x2830,0x2c0,0x8b0,0x40000000,0x2c,0x0,0x0,0x0,0x0,0x242b0,0x242b0,0x3,0x2b8
.long 0x2c0,0x40000000,0xd60,0x2c20,0xffff,0xffff,0x0,0x0,0x30,0x160,0x2c0,0x2c00,0x310,0x8c0,0x40000000,0x30,0x0,0x0,0x0,0x0,0x242c0,0x242c0,0x4,0x2e0
.long 0x2d0,0x40000000,0xd68,0x2c30,0xffff0000,0xffff0000,0x0,0x0,0x34,0x168,0x2d0,0x2c10,0x350,0x8d0,0x40000000,0x34,0x0,0x0,0x0,0x0,0x242d0,0x242d0,0x5,0x2e8
.long 0x2e0,0x40000000,0xd70,0x2c00,0xffff,0xffff,0x0,0x0,0x38,0x170,0x2e0,0x2c20,0x390,0x8e0,0x40000000,0x38,0x0,0x0,0x0,0x0,0x242e0,0x242e0,0x6,0x2f0
.long 0x2f0,0x40000000,0xd78,0x2c10,0xffff0000,0xffff0000,0x0,0x0,0x3c,0x178,0x2f0,0x2c30,0x3d0,0x8f0,0x40000000,0x3c,0x0,0x0,0x0,0x0,0x242f0,0x242f0,0x7,0x2f8
.long 0x300,0x40000000,0x2200,0x3030,0x0,0x0,0xffff,0xffff,0x0,0x180,0x300,0x3000,0x30,0xc00,0x40000000,0x40,0x3f80,0x0,0x0,0x0,0x24300,0x24300,0xfffffff4,0x320
.long 0x310,0x40000000,0x2208,0x3020,0x0,0x0,0xffff0000,0xffff0000,0x4,0x188,0x310,0x3010,0x70,0xc10,0x40000000,0x44,0x3f800000,0x0,0x0,0x0,0x24310,0x24310,0xfffffff5,0x328
.long 0x320,0x40000000,0x2210,0x3010,0x0,0x0,0xffff,0xffff,0x8,0x190,0x320,0x3020,0xb0,0xc20,0x40000000,0x48,0x0,0x3f80,0x0,0x0,0x24320,0x24320,0xfffffff6,0x330
.long 0x330,0x40000000,0x2218,0x3000,0x0,0x0,0xffff0000,0xffff0000,0xc,0x198,0x330,0x3030,0xf0,0xc30,0x40000000,0x4c,0x0,0x3f800000,0x0,0x0,0x24330,0x24330,0xfffffff7,0x338
.long 0x340,0x40000000,0x2620,0x3430,0x0,0x0,0xffff,0xffff,0x10,0x1a0,0x340,0x3400,0x120,0xc40,0x40000000,0x50,0x0,0x0,0x3f80,0x0,0x24340,0x24340,0xfffffff8,0x360
.long 0x350,0x40000000,0x2628,0x3420,0x0,0x0,0xffff0000,0xffff0000,0x14,0x1a8,0x350,0x3410,0x160,0xc50,0x40000000,0x54,0x0,0x0,0x3f800000,0x0,0x24350,0x24350,0xfffffff9,0x368
.long 0x360,0x40000000,0x2630,0x3410,0x0,0x0,0xffff,0xffff,0x18,0x1b0,0x360,0x3420,0x1a0,0xc60,0x40000000,0x58,0x0,0x0,0x0,0x3f80,0x24360,0x24360,0xfffffffa,0x370
.long 0x370,0x40000000,0x2638,0x3400,0x0,0x0,0xffff0000,0xffff0000,0x1c,0x1b8,0x370,0x3430,0x1e0,0xc70,0x40000000,0x5c,0x0,0x0,0x0,0x3f800000,0x24370,0x24370,0xfffffffb,0x378
.long 0x380,0x40000000,0x2a40,0x3830,0x0,0x0,0xffff,0xffff,0x20,0x1c0,0x380,0x3800,0x210,0xc80,0x40000000,0x60,0x0,0x0,0x0,0x0,0x24380,0x24380,0xfffffffc,0x3a0
.long 0x390,0x40000000,0x2a48,0x3820,0x0,0x0,0xffff0000,0xffff0000,0x24,0x1c8,0x390,0x3810,0x250,0xc90,0x40000000,0x64,0x0,0x0,0x0,0x0,0x24390,0x24390,0xfffffffd,0x3a8
.long 0x3a0,0x40000000,0x2a50,0x3810,0x0,0x0,0xffff,0xffff,0x28,0x1d0,0x3a0,0x3820,0x290,0xca0,0x40000000,0x68,0x0,0x0,0x0,0x0,0x243a0,0x243a0,0xfffffffe,0x3b0
.long 0x3b0,0x40000000,0x2a58,0x3800,0x0,0x0,0xffff0000,0xffff0000,0x2c,0x1d8,0x3b0,0x3830,0x2d0,0xcb0,0x40000000,0x6c,0x0,0x0,0x0,0x0,0x243b0,0x243b0,0xffffffff,0x3b8
.long 0x3c0,0x40000000,0x2e60,0x3c30,0xffff,0x0,0x0,0xffff,0x30,0x1e0,0x3c0,0x3c00,0x300,0xcc0,0x40000000,0x70,0x0,0x0,0x0,0x0,0x243c0,0x243c0,0x0,0x3e0
.long 0x3d0,0x40000000,0x2e68,0x3c20,0xffff0000,0x0,0x0,0xffff0000,0x34,0x1e8,0x3d0,0x3c10,0x340,0xcd0,0x40000000,0x74,0x0,0x0,0x0,0x0,0x243d0,0x243d0,0x1,0x3e8
.long 0x3e0,0x40000000,0x2e70,0x3c10,0xffff,0xffff,0x0,0x0,0x38,0x1f0,0x3e0,0x3c20,0x380,0xce0,0x40000000,0x78,0x0,0x0,0x0,0x0,0x243e0,0x243e0,0x2,0x3f0
.long 0x3f0,0x40000000,0x2e78,0x3c00,0xffff0000,0xffff0000,0x0,0x0,0x3c,0x1f8,0x3f0,0x3c30,0x3c0,0xcf0,0x40000000,0x7c,0x0,0x0,0x0,0x0,0x243f0,0x243f0,0x3,0x3f8
.long 0x0,0x0,0x40,0x0,0xffff,0x0,0x0,0xffff,0x0,0x0,0x9000,0x100,0x0,0x100,0x10,0x0,0x3f80,0x0,0x0,0x0,0x24800,0x24000,0x0,0x20
.long 0x10,0x40000000,0x48,0x10,0xffff0000,0x0,0x0,0xffff0000,0x4,0x8,0x9010,0x110,0x40,0x110,0x410,0x4,0x3f800000,0x0,0x0,0x0,0x24810,0x24010,0x1,0x28
.long 0x20,0x40000000,0x50,0x20,0xffff,0xffff,0x0,0x0,0x8,0x10,0x9020,0x120,0x80,0x120,0x810,0x8,0x0,0x3f80,0x0,0x0,0x24820,0x24020,0x2,0x30
.long 0x30,0x40000000,0x58,0x30,0xffff0000,0xffff0000,0x0,0x0,0xc,0x18,0x9030,0x130,0xc0,0x130,0xc10,0xc,0x0,0x3f800000,0x0,0x0,0x24830,0x24030,0x3,0x38
.long 0x40,0x40000000,0x460,0x400,0xffff,0xffff,0x0,0x0,0x10,0x20,0x9040,0x500,0x110,0x140,0x1010,0x10,0x0,0x0,0x3f80,0x0,0x24840,0x24040,0x4,0x60
.long 0x50,0x40000000,0x468,0x410,0xffff0000,0xffff0000,0x0,0x0,0x14,0x28,0x9050,0x510,0x150,0x150,0x1410,0x14,0x0,0x0,0x3f800000,0x0,0x24850,0x24050,0x5,0x68
.long 0x60,0x40000000,0x470,0x420,0xffff,0xffff,0x0,0x0,0x18,0x30,0x9060,0x520,0x190,0x160,0x1810,0x18,0x0,0x0,0x0,0x3f80,0x24860,0x24060,0x6,0x70
.long 0x70,0x40000000,0x478,0x430,0xffff0000,0xffff0000,0x0,0x0,0x1c,0x38,0x9070,0x530,0x1d0,0x170,0x1c10,0x1c,0x0,0x0,0x0,0x3f800000,0x24870,0x24070,0x7,0x78
.long 0x80,0x40000000,0x880,0x800,0xffff,0xffff,0x0,0x0,0x20,0x40,0x9080,0x900,0x220,0x180,0x2010,0x20,0x0,0x0,0x0,0x0,0x24880,0x24080,0x8,0xa0
.long 0x90,0x40000000,0x888,0x810,0xffff0000,0xffff0000,0x0,0x0,0x24,0x48,0x9090,0x910,0x260,0x190,0x2410,0x24,0x0,0x0,0x0,0x0,0x24890,0x24090,0x9,0xa8
.long 0xa0,0x40000000,0x890,0x820,0xffff,0xffff,0x0,0x0,0x28,0x50,0x90a0,0x920,0x2a0,0x1a0,0x2810,0x28,0x0,0x0,0x0,0x0,0x248a0,0x240a0,0xa,0xb0
.long 0xb0,0x40000000,0x898,0x830,0xffff0000,0xffff0000,0x0,0x0,0x2c,0x58,0x90b0,0x930,0x2e0,0x1b0,0x2c10,0x2c,0x0,0x0,0x0,0x0,0x248b0,0x240b0,0xb,0xb8
.long 0xc0,0x40000000,0xca0,0xc00,0xffff,0xffff,0x0,0x0,0x30,0x60,0x90c0,0xd00,0x330,0x1c0,0x3010,0x30,0x0,0x0,0x0,0x0,0x248c0,0x240c0,0xc,0xe0
.long 0xd0,0x40000000,0xca8,0xc10,0xffff0000,0xffff0000,0x0,0x0,0x34,0x68,0x90d0,0xd10,0x370,0x1d0,0x3410,0x34,0x0,0x0,0x0,0x0,0x248d0,0x240d0,0xd,0xe8
.long 0xe0,0x40000000,0xcb0,0xc20,0xffff,0xffff,0x0,0x0,0x38,0x70,0x90e0,0xd20,0x3b0,0x1e0,0x3810,0x38,0x0,0x0,0x0,0x0,0x248e0,0x240e0,0xe,0xf0
.long 0xf0,0x40000000,0xcb8,0xc30,0xffff0000,0xffff0000,0x0,0x0,0x3c,0x78,0x90f0,0xd30,0x3f0,0x1f0,0x3c10,0x3c,0x0,0x0,0x0,0x0,0x248f0,0x240f0,0xf,0xf8
.long 0x100,0x40000000,0x2140,0x1010,0x0,0x0,0xffff,0xffff,0x0,0x80,0x9100,0x1100,0x10,0x500,0x18,0x40,0x3f80,0x0,0x0,0x0,0x24900,0x24100,0xfffffffc,0x120
.long 0x110,0x40000000,0x2148,0x1000,0x0,0x0,0xffff0000,0xffff0000,0x4,0x88,0x9110,0x1110,0x50,0x510,0x418,0x44,0x3f800000,0x0,0x0,0x0,0x24910,0x24110,0xfffffffd,0x128
.long 0x120,0x40000000,0x2150,0x1030,0x0,0x0,0xffff,0xffff,0x8,0x90,0x9120,0x1120,0x90,0x520,0x818,0x48,0x0,0x3f80,0x0,0x0,0x24920,0x24120,0xfffffffe,0x130
.long 0x130,0x40000000,0x2158,0x1020,0x0,0x0,0xffff0000,0xffff0000,0xc,0x98,0x9130,0x1130,0xd0,0x530,0xc18,0x4c,0x0,0x3f800000,0x0,0x0,0x24930,0x24130,0xffffffff,0x138
.long 0x140,0x40000000,0x2560,0x1410,0xffff,0x0,0x0,0xffff,0x10,0xa0,0x9140,0x1500,0x100,0x540,0x1018,0x50,0x0,0x0,0x3f80,0x0,0x24940,0x24140,0x0,0x160
.long 0x150,0x40000000,0x2568,0x1400,0xffff0000,0x0,0x0,0xffff0000,0x14,0xa8,0x9150,0x1510,0x140,0x550,0x1418,0x54,0x0,0x0,0x3f800000,0x0,0x24950,0x24150,0x1,0x168
.long 0x160,0x40000000,0x2570,0x1430,0xffff,0xffff,0x0,0x0,0x18,0xb0,0x9160,0x1520,0x180,0x560,0x1818,0x58,0x0,0x0,0x0,0x3f80,0x24960,0x24160,0x2,0x170
.long 0x170,0x40000000,0x2578,0x1420,0xffff0000,0xffff0000,0x0,0x0,0x1c,0xb8,0x9170,0x1530,0x1c0,0x570,0x1c18,0x5c,0x0,0x0,0x0,0x3f800000,0x24970,0x24170,0x3,0x178
.long 0x180,0x40000000,0x2980,0x1810,0xffff,0xffff,0x0,0x0,0x20,0xc0,0x9180,0x1900,0x230,0x580,0x2018,0x60,0x0,0x0,0x0,0x0,0x24980,0x24180,0x4,0x1a0
.long 0x190,0x40000000,0x2988,0x1800,0xffff0000,0xffff0000,0x0,0x0,0x24,0xc8,0x9190,0x1910,0x270,0x590,0x2418,0x64,0x0,0x0,0x0,0x0,0x24990,0x24190,0x5,0x1a8
.long 0x1a0,0x40000000,0x2990,0x1830,0xffff,0xffff,0x0,0x0,0x28,0xd0,0x91a0,0x1920,0x2b0,0x5a0,0x2818,0x68,0x0,0x0,0x0,0x0,0x249a0,0x241a0,0x6,0x1b0
.long 0x1b0,0x40000000,0x2998,0x1820,0xffff0000,0xffff0000,0x0,0x0,0x2c,0xd8,0x91b0,0x1930,0x2f0,0x5b0,0x2c18,0x6c,0x0,0x0,0x0,0x0,0x249b0,0x241b0,0x7,0x1b8
.long 0x1c0,0x40000000,0x2da0,0x1c10,0xffff,0xffff,0x0,0x0,0x30,0xe0,0x91c0,0x1d00,0x320,0x5c0,0x3018,0x70,0x0,0x0,0x0,0x0,0x249c0,0x241c0,0x8,0x1e0
.long 0x1d0,0x40000000,0x2da8,0x1c00,0xffff0000,0xffff0000,0x0,0x0,0x34,0xe8,0x91d0,0x1d10,0x360,0x5d0,0x3418,0x74,0x0,0x0,0x0,0x0,0x249d0,0x241d0,0x9,0x1e8
.long 0x1e0,0x40000000,0x2db0,0x1c30,0xffff,0xffff,0x0,0x0,0x38,0xf0,0x91e0,0x1d20,0x3a0,0x5e0,0x3818,0x78,0x0,0x0,0x0,0x0,0x249e0,0x241e0,0xa,0x1f0
.long 0x1f0,0x40000000,0x2db8,0x1c20,0xffff0000,0xffff0000,0x0,0x0,0x3c,0xf8,0x91f0,0x1d30,0x3e0,0x5f0,0x3c18,0x7c,0x0,0x0,0x0,0x0,0x249f0,0x241f0,0xb,0x1f8
.long 0x200,0x40000000,0x140,0x2020,0x0,0x0,0xffff,0xffff,0x0,0x100,0x9200,0x2100,0x20,0x900,0x40000000,0x0,0x3f80,0x0,0x0,0x0,0x24a00,0x24200,0xfffffff8,0x220
.long 0x210,0x40000000,0x148,0x2030,0x0,0x0,0xffff0000,0xffff0000,0x4,0x108,0x9210,0x2110,0x60,0x910,0x40000000,0x4,0x3f800000,0x0,0x0,0x0,0x24a10,0x24210,0xfffffff9,0x228
.long 0x220,0x40000000,0x150,0x2000,0x0,0x0,0xffff,0xffff,0x8,0x110,0x9220,0x2120,0xa0,0x920,0x40000000,0x8,0x0,0x3f80,0x0,0x0,0x24a20,0x24220,0xfffffffa,0x230
.long 0x230,0x40000000,0x158,0x2010,0x0,0x0,0xffff0000,0xffff0000,0xc,0x118,0x9230,0x2130,0xe0,0x930,0x40000000,0xc,0x0,0x3f800000,0x0,0x0,0x24a30,0x24230,0xfffffffb,0x238
.long 0x240,0x40000000,0x560,0x2420,0x0,0x0,0xffff,0xffff,0x10,0x120,0x9240,0x2500,0x130,0x940,0x40000000,0x10,0x0,0x0,0x3f80,0x0,0x24a40,0x24240,0xfffffffc,0x260
.long 0x250,0x40000000,0x568,0x2430,0x0,0x0,0xffff0000,0xffff0000,0x14,0x128,0x9250,0x2510,0x170,0x950,0x40000000,0x14,0x0,0x0,0x3f800000,0x0,0x24a50,0x24250,0xfffffffd,0x268
.long 0x260,0x40000000,0x570,0x2400,0x0,0x0,0xffff,0xffff,0x18,0x130,0x9260,0x2520,0x1b0,0x960,0x40000000,0x18,0x0,0x0,0x0,0x3f80,0x24a60,0x24260,0xfffffffe,0x270
.long 0x270,0x40000000,0x578,0x2410,0x0,0x0,0xffff0000,0xffff0000,0x1c,0x138,0x9270,0x2530,0x1f0,0x970,0x40000000,0x1c,0x0,0x0,0x0,0x3f800000,0x24a70,0x24270,0xffffffff,0x278
.long 0x280,0x40000000,0x980,0x2820,0xffff,0x0,0x0,0xffff,0x20,0x140,0x9280,0x2900,0x200,0x980,0x40000000,0x20,0x0,0x0,0x0,0x0,0x24a80,0x24280,0x0,0x2a0
.long 0x290,0x40000000,0x988,0x2830,0xffff0000,0x0,0x0,0xffff0000,0x24,0x148,0x9290,0x2910,0x240,0x990,0x40000000,0x24,0x0,0x0,0x0,0x0,0x24a90,0x24290,0x1,0x2a8
.long 0x2a0,0x40000000,0x990,0x2800,0xffff,0xffff,0x0,0x0,0x28,0x150,0x92a0,0x2920,0x280,0x9a0,0x40000000,0x28,0x0,0x0,0x0,0x0,0x24aa0,0x242a0,0x2,0x2b0
.long 0x2b0,0x40000000,0x998,0x2810,0xffff0000,0xffff0000,0x0,0x0,0x2c,0x158,0x92b0,0x2930,0x2c0,0x9b0,0x40000000,0x2c,0x0,0x0,0x0,0x0,0x24ab0,0x242b0,0x3,0x2b8
.long 0x2c0,0x40000000,0xda0,0x2c20,0xffff,0xffff,0x0,0x0,0x30,0x160,0x92c0,0x2d00,0x310,0x9c0,0x40000000,0x30,0x0,0x0,0x0,0x0,0x24ac0,0x242c0,0x4,0x2e0
.long 0x2d0,0x40000000,0xda8,0x2c30,0xffff0000,0xffff0000,0x0,0x0,0x34,0x168,0x92d0,0x2d10,0x350,0x9d0,0x40000000,0x34,0x0,0x0,0x0,0x0,0x24ad0,0x242d0,0x5,0x2e8
.long 0x2e0,0x40000000,0xdb0,0x2c00,0xffff,0xffff,0x0,0x0,0x38,0x170,0x92e0,0x2d20,0x390,0x9e0,0x40000000,0x38,0x0,0x0,0x0,0x0,0x24ae0,0x242e0,0x6,0x2f0
.long 0x2f0,0x40000000,0xdb8,0x2c10,0xffff0000,0xffff0000,0x0,0x0,0x3c,0x178,0x92f0,0x2d30,0x3d0,0x9f0,0x40000000,0x3c,0x0,0x0,0x0,0x0,0x24af0,0x242f0,0x7,0x2f8
.long 0x300,0x40000000,0x2240,0x3030,0x0,0x0,0xffff,0xffff,0x0,0x180,0x9300,0x3100,0x30,0xd00,0x40000000,0x40,0x3f80,0x0,0x0,0x0,0x24b00,0x24300,0xfffffff4,0x320
.long 0x310,0x40000000,0x2248,0x3020,0x0,0x0,0xffff0000,0xffff0000,0x4,0x188,0x9310,0x3110,0x70,0xd10,0x40000000,0x44,0x3f800000,0x0,0x0,0x0,0x24b10,0x24310,0xfffffff5,0x328
.long 0x320,0x40000000,0x2250,0x3010,0x0,0x0,0xffff,0xffff,0x8,0x190,0x9320,0x3120,0xb0,0xd20,0x40000000,0x48,0x0,0x3f80,0x0,0x0,0x24b20,0x24320,0xfffffff6,0x330
.long 0x330,0x40000000,0x2258,0x3000,0x0,0x0,0xffff0000,0xffff0000,0xc,0x198,0x9330,0x3130,0xf0,0xd30,0x40000000,0x4c,0x0,0x3f800000,0x0,0x0,0x24b30,0x24330,0xfffffff7,0x338
.long 0x340,0x40000000,0x2660,0x3430,0x0,0x0,0xffff,0xffff,0x10,0x1a0,0x9340,0x3500,0x120,0xd40,0x40000000,0x50,0x0,0x0,0x3f80,0x0,0x24b40,0x24340,0xfffffff8,0x360
.long 0x350,0x40000000,0x2668,0x3420,0x0,0x0,0xffff0000,0xffff0000,0x14,0x1a8,0x9350,0x3510,0x160,0xd50,0x40000000,0x54,0x0,0x0,0x3f800000,0x0,0x24b50,0x24350,0xfffffff9,0x368
.long 0x360,0x40000000,0x2670,0x3410,0x0,0x0,0xffff,0xffff,0x18,0x1b0,0x9360,0x3520,0x1a0,0xd60,0x40000000,0x58,0x0,0x0,0x0,0x3f80,0x24b60,0x24360,0xfffffffa,0x370
.long 0x370,0x40000000,0x2678,0x3400,0x0,0x0,0xffff0000,0xffff0000,0x1c,0x1b8,0x9370,0x3530,0x1e0,0xd70,0x40000000,0x5c,0x0,0x0,0x0,0x3f800000,0x24b70,0x24370,0xfffffffb,0x378
.long 0x380,0x40000000,0x2a80,0x3830,0x0,0x0,0xffff,0xffff,0x20,0x1c0,0x9380,0x3900,0x210,0xd80,0x40000000,0x60,0x0,0x0,0x0,0x0,0x24b80,0x24380,0xfffffffc,0x3a0
.long 0x390,0x40000000,0x2a88,0x3820,0x0,0x0,0xffff0000,0xffff0000,0x24,0x1c8,0x9390,0x3910,0x250,0xd90,0x40000000,0x64,0x0,0x0,0x0,0x0,0x24b90,0x24390,0xfffffffd,0x3a8
.long 0x3a0,0x40000000,0x2a90,0x3810,0x0,0x0,0xffff,0xffff,0x28,0x1d0,0x93a0,0x3920,0x290,0xda0,0x40000000,0x68,0x0,0x0,0x0,0x0,0x24ba0,0x243a0,0xfffffffe,0x3b0
.long 0x3b0,0x40000000,0x2a98,0x3800,0x0,0x0,0xffff0000,0xffff0000,0x2c,0x1d8,0x93b0,0x3930,0x2d0,0xdb0,0x40000000,0x6c,0x0,0x0,0x0,0x0,0x24bb0,0x243b0,0xffffffff,0x3b8
.long 0x3c0,0x40000000,0x2ea0,0x3c30,0xffff,0x0,0x0,0xffff,0x30,0x1e0,0x93c0,0x3d00,0x300,0xdc0,0x40000000,0x70,0x0,0x0,0x0,0x0,0x24bc0,0x243c0,0x0,0x3e0
.long 0x3d0,0x40000000,0x2ea8,0x3c20,0xffff0000,0x0,0x0,0xffff0000,0x34,0x1e8,0x93d0,0x3d10,0x340,0xdd0,0x40000000,0x74,0x0,0x0,0x0,0x0,0x24bd0,0x243d0,0x1,0x3e8
.long 0x3e0,0x40000000,0x2eb0,0x3c10,0xffff,0xffff,0x0,0x0,0x38,0x1f0,0x93e0,0x3d20,0x380,0xde0,0x40000000,0x78,0x0,0x0,0x0,0x0,0x24be0,0x243e0,0x2,0x3f0
.long 0x3f0,0x40000000,0x2eb8,0x3c00,0xffff0000,0xffff0000,0x0,0x0,0x3c,0x1f8,0x93f0,0x3d30,0x3c0,0xdf0,0x40000000,0x7c,0x0,0x0,0x0,0x0,0x24bf0,0x243f0,0x3,0x3f8
.long 0x0,0x0,0x80,0x0,0xffff,0x0,0x0,0xffff,0x0,0x0,0x12000,0x200,0x0,0x200,0x20,0x0,0x3f80,0x0,0x0,0x0,0x25000,0x24000,0x10,0x20
.long 0x10,0x40000000,0x88,0x10,0xffff0000,0x0,0x0,0xffff0000,0x4,0x8,0x12010,0x210,0x40,0x210,0x420,0x4,0x3f800000,0x0,0x0,0x0,0x25010,0x24010,0x11,0x28
.long 0x20,0x40000000,0x90,0x20,0xffff,0xffff,0x0,0x0,0x8,0x10,0x12020,0x220,0x80,0x220,0x820,0x8,0x0,0x3f80,0x0,0x0,0x25020,0x24020,0x12,0x30
.long 0x30,0x40000000,0x98,0x30,0xffff0000,0xffff0000,0x0,0x0,0xc,0x18,0x12030,0x230,0xc0,0x230,0xc20,0xc,0x0,0x3f800000,0x0,0x0,0x25030,0x24030,0x13,0x38
.long 0x40,0x40000000,0x4a0,0x400,0xffff,0xffff,0x0,0x0,0x10,0x20,0x12040,0x600,0x110,0x240,0x1020,0x10,0x0,0x0,0x3f80,0x0,0x25040,0x24040,0x14,0x60
.long 0x50,0x40000000,0x4a8,0x410,0xffff0000,0xffff0000,0x0,0x0,0x14,0x28,0x12050,0x610,0x150,0x250,0x1420,0x14,0x0,0x0,0x3f800000,0x0,0x25050,0x24050,0x15,0x68
.long 0x60,0x40000000,0x4b0,0x420,0xffff,0xffff,0x0,0x0,0x18,0x30,0x12060,0x620,0x190,0x260,0x1820,0x18,0x0,0x0,0x0,0x3f80,0x25060,0x24060,0x16,0x70
.long 0x70,0x40000000,0x4b8,0x430,0xffff0000,0xffff0000,0x0,0x0,0x1c,0x38,0x12070,0x630,0x1d0,0x270,0x1c20,0x1c,0x0,0x0,0x0,0x3f800000,0x25070,0x24070,0x17,0x78
.long 0x80,0x40000000,0x8c0,0x800,0xffff,0xffff,0x0,0x0,0x20,0x40,0x12080,0xa00,0x220,0x280,0x2020,0x20,0x0,0x0,0x0,0x0,0x25080,0x24080,0x18,0xa0
.long 0x90,0x40000000,0x8c8,0x810,0xffff0000,0xffff0000,0x0,0x0,0x24,0x48,0x12090,0xa10,0x260,0x290,0x2420,0x24,0x0,0x0,0x0,0x0,0x25090,0x24090,0x19,0xa8
.long 0xa0,0x40000000,0x8d0,0x820,0xffff,0xffff,0x0,0x0,0x28,0x50,0x120a0,0xa20,0x2a0,0x2a0,0x2820,0x28,0x0,0x0,0x0,0x0,0x250a0,0x240a0,0x1a,0xb0
.long 0xb0,0x40000000,0x8d8,0x830,0xffff0000,0xffff0000,0x0,0x0,0x2c,0x58,0x120b0,0xa30,0x2e0,0x2b0,0x2c20,0x2c,0x0,0x0,0x0,0x0,0x250b0,0x240b0,0x1b,0xb8
.long 0xc0,0x40000000,0xce0,0xc00,0xffff,0xffff,0x0,0x0,0x30,0x60,0x120c0,0xe00,0x330,0x2c0,0x3020,0x30,0x0,0x0,0x0,0x0,0x250c0,0x240c0,0x1c,0xe0
.long 0xd0,0x40000000,0xce8,0xc10,0xffff0000,0xffff0000,0x0,0x0,0x34,0x68,0x120d0,0xe10,0x370,0x2d0,0x3420,0x34,0x0,0x0,0x0,0x0,0x250d0,0x240d0,0x1d,0xe8
.long 0xe0,0x40000000,0xcf0,0xc20,0xffff,0xffff,0x0,0x0,0x38,0x70,0x120e0,0xe20,0x3b0,0x2e0,0x3820,0x38,0x0,0x0,0x0,0x0,0x250e0,0x240e0,0x1e,0xf0
.long 0xf0,0x40000000,0xcf8,0xc30,0xffff0000,0xffff0000,0x0,0x0,0x3c,0x78,0x120f0,0xe30,0x3f0,0x2f0,0x3c20,0x3c,0x0,0x0,0x0,0x0,0x250f0,0x240f0,0x1f,0xf8
.long 0x100,0x40000000,0x2180,0x1010,0x0,0x0,0xffff,0xffff,0x0,0x80,0x12100,0x1200,0x10,0x600,0x28,0x40,0x3f80,0x0,0x0,0x0,0x25100,0x24100,0xc,0x120
.long 0x110,0x40000000,0x2188,0x1000,0x0,0x0,0xffff0000,0xffff0000,0x4,0x88,0x12110,0x1210,0x50,0x610,0x428,0x44,0x3f800000,0x0,0x0,0x0,0x25110,0x24110,0xd,0x128
.long 0x120,0x40000000,0x2190,0x1030,0x0,0x0,0xffff,0xffff,0x8,0x90,0x12120,0x1220,0x90,0x620,0x828,0x48,0x0,0x3f80,0x0,0x0,0x25120,0x24120,0xe,0x130
.long 0x130,0x40000000,0x2198,0x1020,0x0,0x0,0xffff0000,0xffff0000,0xc,0x98,0x12130,0x1230,0xd0,0x630,0xc28,0x4c,0x0,0x3f800000,0x0,0x0,0x25130,0x24130,0xf,0x138
.long 0x140,0x40000000,0x25a0,0x1410,0xffff,0x0,0x0,0xffff,0x10,0xa0,0x12140,0x1600,0x100,0x640,0x1028,0x50,0x0,0x0,0x3f80,0x0,0x25140,0x24140,0x10,0x160
.long 0x150,0x40000000,0x25a8,0x1400,0xffff0000,0x0,0x0,0xffff0000,0x14,0xa8,0x12150,0x1610,0x140,0x650,0x1428,0x54,0x0,0x0,0x3f800000,0x0,0x25150,0x24150,0x11,0x168
.long 0x160,0x40000000,0x25b0,0x1430,0xffff,0xffff,0x0,0x0,0x18,0xb0,0x12160,0x1620,0x180,0x660,0x1828,0x58,0x0,0x0,0x0,0x3f80,0x25160,0x24160,0x12,0x170
.long 0x170,0x40000000,0x25b8,0x1420,0xffff0000,0xffff0000,0x0,0x0,0x1c,0xb8,0x12170,0x1630,0x1c0,0x670,0x1c28,0x5c,0x0,0x0,0x0,0x3f800000,0x25170,0x24170,0x13,0x178
.long 0x180,0x40000000,0x29c0,0x1810,0xffff,0xffff,0x0,0x0,0x20,0xc0,0x12180,0x1a00,0x230,0x680,0x2028,0x60,0x0,0x0,0x0,0x0,0x25180,0x24180,0x14,0x1a0
.long 0x190,0x40000000,0x29c8,0x1800,0xffff0000,0xffff0000,0x0,0x0,0x24,0xc8,0x12190,0x1a10,0x270,0x690,0x2428,0x64,0x0,0x0,0x0,0x0,0x25190,0x24190,0x15,0x1a8
.long 0x1a0,0x40000000,0x29d0,0x1830,0xffff,0xffff,0x0,0x0,0x28,0xd0,0x121a0,0x1a20,0x2b0,0x6a0,0x2828,0x68,0x0,0x0,0x0,0x0,0x251a0,0x241a0,0x16,0x1b0
.long 0x1b0,0x40000000,0x29d8,0x1820,0xffff0000,0xffff0000,0x0,0x0,0x2c,0xd8,0x121b0,0x1a30,0x2f0,0x6b0,0x2c28,0x6c,0x0,0x0,0x0,0x0,0x251b0,0x241b0,0x17,0x1b8
.long 0x1c0,0x40000000,0x2de0,0x1c10,0xffff,0xffff,0x0,0x0,0x30,0xe0,0x121c0,0x1e00,0x320,0x6c0,0x3028,0x70,0x0,0x0,0x0,0x0,0x251c0,0x241c0,0x18,0x1e0
.long 0x1d0,0x40000000,0x2de8,0x1c00,0xffff0000,0xffff0000,0x0,0x0,0x34,0xe8,0x121d0,0x1e10,0x360,0x6d0,0x3428,0x74,0x0,0x0,0x0,0x0,0x251d0,0x241d0,0x19,0x1e8
.long 0x1e0,0x40000000,0x2df0,0x1c30,0xffff,0xffff,0x0,0x0,0x38,0xf0,0x121e0,0x1e20,0x3a0,0x6e0,0x3828,0x78,0x0,0x0,0x0,0x0,0x251e0,0x241e0,0x1a,0x1f0
.long 0x1f0,0x40000000,0x2df8,0x1c20,0xffff0000,0xffff0000,0x0,0x0,0x3c,0xf8,0x121f0,0x1e30,0x3e0,0x6f0,0x3c28,0x7c,0x0,0x0,0x0,0x0,0x251f0,0x241f0,0x1b,0x1f8
.long 0x200,0x40000000,0x180,0x2020,0x0,0x0,0xffff,0xffff,0x0,0x100,0x12200,0x2200,0x20,0xa00,0x40000000,0x0,0x3f80,0x0,0x0,0x0,0x25200,0x24200,0x8,0x220
.long 0x210,0x40000000,0x188,0x2030,0x0,0x0,0xffff0000,0xffff0000,0x4,0x108,0x12210,0x2210,0x60,0xa10,0x40000000,0x4,0x3f800000,0x0,0x0,0x0,0x25210,0x24210,0x9,0x228
.long 0x220,0x40000000,0x190,0x2000,0x0,0x0,0xffff,0xffff,0x8,0x110,0x12220,0x2220,0xa0,0xa20,0x40000000,0x8,0x0,0x3f80,0x0,0x0,0x25220,0x24220,0xa,0x230
.long 0x230,0x40000000,0x198,0x2010,0x0,0x0,0xffff0000,0xffff0000,0xc,0x118,0x12230,0x2230,0xe0,0xa30,0x40000000,0xc,0x0,0x3f800000,0x0,0x0,0x25230,0x24230,0xb,0x238
.long 0x240,0x40000000,0x5a0,0x2420,0x0,0x0,0xffff,0xffff,0x10,0x120,0x12240,0x2600,0x130,0xa40,0x40000000,0x10,0x0,0x0,0x3f80,0x0,0x25240,0x24240,0xc,0x260
.long 0x250,0x40000000,0x5a8,0x2430,0x0,0x0,0xffff0000,0xffff0000,0x14,0x128,0x12250,0x2610,0x170,0xa50,0x40000000,0x14,0x0,0x0,0x3f800000,0x0,0x25250,0x24250,0xd,0x268
.long 0x260,0x40000000,0x5b0,0x2400,0x0,0x0,0xffff,0xffff,0x18,0x130,0x12260,0x2620,0x1b0,0xa60,0x40000000,0x18,0x0,0x0,0x0,0x3f80,0x25260,0x24260,0xe,0x270
.long 0x270,0x40000000,0x5b8,0x2410,0x0,0x0,0xffff0000,0xffff0000,0x1c,0x138,0x12270,0x2630,0x1f0,0xa70,0x40000000,0x1c,0x0,0x0,0x0,0x3f800000,0x25270,0x24270,0xf,0x278
.long 0x280,0x40000000,0x9c0,0x2820,0xffff,0x0,0x0,0xffff,0x20,0x140,0x12280,0x2a00,0x200,0xa80,0x40000000,0x20,0x0,0x0,0x0,0x0,0x25280,0x24280,0x10,0x2a0
.long 0x290,0x40000000,0x9c8,0x2830,0xffff0000,0x0,0x0,0xffff0000,0x24,0x148,0x12290,0x2a10,0x240,0xa90,0x40000000,0x24,0x0,0x0,0x0,0x0,0x25290,0x24290,0x11,0x2a8
.long 0x2a0,0x40000000,0x9d0,0x2800,0xffff,0xffff,0x0,0x0,0x28,0x150,0x122a0,0x2a20,0x280,0xaa0,0x40000000,0x28,0x0,0x0,0x0,0x0,0x252a0,0x242a0,0x12,0x2b0
.long 0x2b0,0x40000000,0x9d8,0x2810,0xffff0000,0xffff0000,0x0,0x0,0x2c,0x158,0x122b0,0x2a30,0x2c0,0xab0,0x40000000,0x2c,0x0,0x0,0x0,0x0,0x252b0,0x242b0,0x13,0x2b8
.long 0x2c0,0x40000000,0xde0,0x2c20,0xffff,0xffff,0x0,0x0,0x30,0x160,0x122c0,0x2e00,0x310,0xac0,0x40000000,0x30,0x0,0x0,0x0,0x0,0x252c0,0x242c0,0x14,0x2e0
.long 0x2d0,0x40000000,0xde8,0x2c30,0xffff0000,0xffff0000,0x0,0x0,0x34,0x168,0x122d0,0x2e10,0x350,0xad0,0x40000000,0x34,0x0,0x0,0x0,0x0,0x252d0,0x242d0,0x15,0x2e8
.long 0x2e0,0x40000000,0xdf0,0x2c00,0xffff,0xffff,0x0,0x0,0x38,0x170,0x122e0,0x2e20,0x390,0xae0,0x40000000,0x38,0x0,0x0,0x0,0x0,0x252e0,0x242e0,0x16,0x2f0
.long 0x2f0,0x40000000,0xdf8,0x2c10,0xffff0000,0xffff0000,0x0,0x0,0x3c,0x178,0x122f0,0x2e30,0x3d0,0xaf0,0x40000000,0x3c,0x0,0x0,0x0,0x0,0x252f0,0x242f0,0x17,0x2f8
.long 0x300,0x40000000,0x2280,0x3030,0x0,0x0,0xffff,0xffff,0x0,0x180,0x12300,0x3200,0x30,0xe00,0x40000000,0x40,0x3f80,0x0,0x0,0x0,0x25300,0x24300,0x4,0x320
.long 0x310,0x40000000,0x2288,0x3020,0x0,0x0,0xffff0000,0xffff0000,0x4,0x188,0x12310,0x3210,0x70,0xe10,0x40000000,0x44,0x3f800000,0x0,0x0,0x0,0x25310,0x24310,0x5,0x328
.long 0x320,0x40000000,0x2290,0x3010,0x0,0x0,0xffff,0xffff,0x8,0x190,0x12320,0x3220,0xb0,0xe20,0x40000000,0x48,0x0,0x3f80,0x0,0x0,0x25320,0x24320,0x6,0x330
.long 0x330,0x40000000,0x2298,0x3000,0x0,0x0,0xffff0000,0xffff0000,0xc,0x198,0x12330,0x3230,0xf0,0xe30,0x40000000,0x4c,0x0,0x3f800000,0x0,0x0,0x25330,0x24330,0x7,0x338
.long 0x340,0x40000000,0x26a0,0x3430,0x0,0x0,0xffff,0xffff,0x10,0x1a0,0x12340,0x3600,0x120,0xe40,0x40000000,0x50,0x0,0x0,0x3f80,0x0,0x25340,0x24340,0x8,0x360
.long 0x350,0x40000000,0x26a8,0x3420,0x0,0x0,0xffff0000,0xffff0000,0x14,0x1a8,0x12350,0x3610,0x160,0xe50,0x40000000,0x54,0x0,0x0,0x3f800000,0x0,0x25350,0x24350,0x9,0x368
.long 0x360,0x40000000,0x26b0,0x3410,0x0,0x0,0xffff,0xffff,0x18,0x1b0,0x12360,0x3620,0x1a0,0xe60,0x40000000,0x58,0x0,0x0,0x0,0x3f80,0x25360,0x24360,0xa,0x370
.long 0x370,0x40000000,0x26b8,0x3400,0x0,0x0,0xffff0000,0xffff0000,0x1c,0x1b8,0x12370,0x3630,0x1e0,0xe70,0x40000000,0x5c,0x0,0x0,0x0,0x3f800000,0x25370,0x24370,0xb,0x378
.long 0x380,0x40000000,0x2ac0,0x3830,0x0,0x0,0xffff,0xffff,0x20,0x1c0,0x12380,0x3a00,0x210,0xe80,0x40000000,0x60,0x0,0x0,0x0,0x0,0x25380,0x24380,0xc,0x3a0
.long 0x390,0x40000000,0x2ac8,0x3820,0x0,0x0,0xffff0000,0xffff0000,0x24,0x1c8,0x12390,0x3a10,0x250,0xe90,0x40000000,0x64,0x0,0x0,0x0,0x0,0x25390,0x24390,0xd,0x3a8
.long 0x3a0,0x40000000,0x2ad0,0x3810,0x0,0x0,0xffff,0xffff,0x28,0x1d0,0x123a0,0x3a20,0x290,0xea0,0x40000000,0x68,0x0,0x0,0x0,0x0,0x253a0,0x243a0,0xe,0x3b0
.long 0x3b0,0x40000000,0x2ad8,0x3800,0x0,0x0,0xffff0000,0xffff0000,0x2c,0x1d8,0x123b0,0x3a30,0x2d0,0xeb0,0x40000000,0x6c,0x0,0x0,0x0,0x0,0x253b0,0x243b0,0xf,0x3b8
.long 0x3c0,0x40000000,0x2ee0,0x3c30,0xffff,0x0,0x0,0xffff,0x30,0x1e0,0x123c0,0x3e00,0x300,0xec0,0x40000000,0x70,0x0,0x0,0x0,0x0,0x253c0,0x243c0,0x10,0x3e0
.long 0x3d0,0x40000000,0x2ee8,0x3c20,0xffff0000,0x0,0x0,0xffff0000,0x34,0x1e8,0x123d0,0x3e10,0x340,0xed0,0x40000000,0x74,0x0,0x0,0x0,0x0,0x253d0,0x243d0,0x11,0x3e8
.long 0x3e0,0x40000000,0x2ef0,0x3c10,0xffff,0xffff,0x0,0x0,0x38,0x1f0,0x123e0,0x3e20,0x380,0xee0,0x40000000,0x78,0x0,0x0,0x0,0x0,0x253e0,0x243e0,0x12,0x3f0
.long 0x3f0,0x40000000,0x2ef8,0x3c00,0xffff0000,0xffff0000,0x0,0x0,0x3c,0x1f8,0x123f0,0x3e30,0x3c0,0xef0,0x40000000,0x7c,0x0,0x0,0x0,0x0,0x253f0,0x243f0,0x13,0x3f8
.long 0x0,0x0,0xc0,0x0,0xffff,0x0,0x0,0xffff,0x0,0x0,0x1b000,0x300,0x0,0x300,0x30,0x0,0x3f80,0x0,0x0,0x0,0x25800,0x24000,0x10,0x20
.long 0x10,0x40000000,0xc8,0x10,0xffff0000,0x0,0x0,0xffff0000,0x4,0x8,0x1b010,0x310,0x40,0x310,0x430,0x4,0x3f800000,0x0,0x0,0x0,0x25810,0x24010,0x11,0x28
.long 0x20,0x40000000,0xd0,0x20,0xffff,0xffff,0x0,0x0,0x8,0x10,0x1b020,0x320,0x80,0x320,0x830,0x8,0x0,0x3f80,0x0,0x0,0x25820,0x24020,0x12,0x30
.long 0x30,0x40000000,0xd8,0x30,0xffff0000,0xffff0000,0x0,0x0,0xc,0x18,0x1b030,0x330,0xc0,0x330,0xc30,0xc,0x0,0x3f800000,0x0,0x0,0x25830,0x24030,0x13,0x38
.long 0x40,0x40000000,0x4e0,0x400,0xffff,0xffff,0x0,0x0,0x10,0x20,0x1b040,0x700,0x110,0x340,0x1030,0x10,0x0,0x0,0x3f80,0x0,0x25840,0x24040,0x14,0x60
.long 0x50,0x40000000,0x4e8,0x410,0xffff0000,0xffff0000,0x0,0x0,0x14,0x28,0x1b050,0x710,0x150,0x350,0x1430,0x14,0x0,0x0,0x3f800000,0x0,0x25850,0x24050,0x15,0x68
.long 0x60,0x40000000,0x4f0,0x420,0xffff,0xffff,0x0,0x0,0x18,0x30,0x1b060,0x720,0x190,0x360,0x1830,0x18,0x0,0x0,0x0,0x3f80,0x25860,0x24060,0x16,0x70
.long 0x70,0x40000000,0x4f8,0x430,0xffff0000,0xffff0000,0x0,0x0,0x1c,0x38,0x1b070,0x730,0x1d0,0x370,0x1c30,0x1c,0x0,0x0,0x0,0x3f800000,0x25870,0x24070,0x17,0x78
.long 0x80,0x40000000,0x900,0x800,0xffff,0xffff,0x0,0x0,0x20,0x40,0x1b080,0xb00,0x220,0x380,0x2030,0x20,0x0,0x0,0x0,0x0,0x25880,0x24080,0x18,0xa0
.long 0x90,0x40000000,0x908,0x810,0xffff0000,0xffff0000,0x0,0x0,0x24,0x48,0x1b090,0xb10,0x260,0x390,0x2430,0x24,0x0,0x0,0x0,0x0,0x25890,0x24090,0x19,0xa8
.long 0xa0,0x40000000,0x910,0x820,0xffff,0xffff,0x0,0x0,0x28,0x50,0x1b0a0,0xb20,0x2a0,0x3a0,0x2830,0x28,0x0,0x0,0x0,0x0,0x258a0,0x240a0,0x1a,0xb0
.long 0xb0,0x40000000,0x918,0x830,0xffff0000,0xffff0000,0x0,0x0,0x2c,0x58,0x1b0b0,0xb30,0x2e0,0x3b0,0x2c30,0x2c,0x0,0x0,0x0,0x0,0x258b0,0x240b0,0x1b,0xb8
.long 0xc0,0x40000000,0xd20,0xc00,0xffff,0xffff,0x0,0x0,0x30,0x60,0x1b0c0,0xf00,0x330,0x3c0,0x3030,0x30,0x0,0x0,0x0,0x0,0x258c0,0x240c0,0x1c,0xe0
.long 0xd0,0x40000000,0xd28,0xc10,0xffff0000,0xffff0000,0x0,0x0,0x34,0x68,0x1b0d0,0xf10,0x370,0x3d0,0x3430,0x34,0x0,0x0,0x0,0x0,0x258d0,0x240d0,0x1d,0xe8
.long 0xe0,0x40000000,0xd30,0xc20,0xffff,0xffff,0x0,0x0,0x38,0x70,0x1b0e0,0xf20,0x3b0,0x3e0,0x3830,0x38,0x0,0x0,0x0,0x0,0x258e0,0x240e0,0x1e,0xf0
.long 0xf0,0x40000000,0xd38,0xc30,0xffff0000,0xffff0000,0x0,0x0,0x3c,0x78,0x1b0f0,0xf30,0x3f0,0x3f0,0x3c30,0x3c,0x0,0x0,0x0,0x0,0x258f0,0x240f0,0x1f,0xf8
.long 0x100,0x40000000,0x21c0,0x1010,0x0,0x0,0xffff,0xffff,0x0,0x80,0x1b100,0x1300,0x10,0x700,0x38,0x40,0x3f80,0x0,0x0,0x0,0x25900,0x24100,0xc,0x120
.long 0x110,0x40000000,0x21c8,0x1000,0x0,0x0,0xffff0000,0xffff0000,0x4,0x88,0x1b110,0x1310,0x50,0x710,0x438,0x44,0x3f800000,0x0,0x0,0x0,0x25910,0x24110,0xd,0x128
.long 0x120,0x40000000,0x21d0,0x1030,0x0,0x0,0xffff,0xffff,0x8,0x90,0x1b120,0x1320,0x90,0x720,0x838,0x48,0x0,0x3f80,0x0,0x0,0x25920,0x24120,0xe,0x130
.long 0x130,0x40000000,0x21d8,0x1020,0x0,0x0,0xffff0000,0xffff0000,0xc,0x98,0x1b130,0x1330,0xd0,0x730,0xc38,0x4c,0x0,0x3f800000,0x0,0x0,0x25930,0x24130,0xf,0x138
.long 0x140,0x40000000,0x25e0,0x1410,0xffff,0x0,0x0,0xffff,0x10,0xa0,0x1b140,0x1700,0x100,0x740,0x1038,0x50,0x0,0x0,0x3f80,0x0,0x25940,0x24140,0x10,0x160
.long 0x150,0x40000000,0x25e8,0x1400,0xffff0000,0x0,0x0,0xffff0000,0x14,0xa8,0x1b150,0x1710,0x140,0x750,0x1438,0x54,0x0,0x0,0x3f800000,0x0,0x25950,0x24150,0x11,0x168
.long 0x160,0x40000000,0x25f0,0x1430,0xffff,0xffff,0x0,0x0,0x18,0xb0,0x1b160,0x1720,0x180,0x760,0x1838,0x58,0x0,0x0,0x0,0x3f80,0x25960,0x24160,0x12,0x170
.long 0x170,0x40000000,0x25f8,0x1420,0xffff0000,0xffff0000,0x0,0x0,0x1c,0xb8,0x1b170,0x1730,0x1c0,0x770,0x1c38,0x5c,0x0,0x0,0x0,0x3f800000,0x25970,0x24170,0x13,0x178
.long 0x180,0x40000000,0x2a00,0x1810,0xffff,0xffff,0x0,0x0,0x20,0xc0,0x1b180,0x1b00,0x230,0x780,0x2038,0x60,0x0,0x0,0x0,0x0,0x25980,0x24180,0x14,0x1a0
.long 0x190,0x40000000,0x2a08,0x1800,0xffff0000,0xffff0000,0x0,0x0,0x24,0xc8,0x1b190,0x1b10,0x270,0x790,0x2438,0x64,0x0,0x0,0x0,0x0,0x25990,0x24190,0x15,0x1a8
.long 0x1a0,0x40000000,0x2a10,0x1830,0xffff,0xffff,0x0,0x0,0x28,0xd0,0x1b1a0,0x1b20,0x2b0,0x7a0,0x2838,0x68,0x0,0x0,0x0,0x0,0x259a0,0x241a0,0x16,0x1b0
.long 0x1b0,0x40000000,0x2a18,0x1820,0xffff0000,0xffff0000,0x0,0x0,0x2c,0xd8,0x1b1b0,0x1b30,0x2f0,0x7b0,0x2c38,0x6c,0x0,0x0,0x0,0x0,0x259b0,0x241b0,0x17,0x1b8
.long 0x1c0,0x40000000,0x2e20,0x1c10,0xffff,0xffff,0x0,0x0,0x30,0xe0,0x1b1c0,0x1f00,0x320,0x7c0,0x3038,0x70,0x0,0x0,0x0,0x0,0x259c0,0x241c0,0x18,0x1e0
.long 0x1d0,0x40000000,0x2e28,0x1c00,0xffff0000,0xffff0000,0x0,0x0,0x34,0xe8,0x1b1d0,0x1f10,0x360,0x7d0,0x3438,0x74,0x0,0x0,0x0,0x0,0x259d0,0x241d0,0x19,0x1e8
.long 0x1e0,0x40000000,0x2e30,0x1c30,0xffff,0xffff,0x0,0x0,0x38,0xf0,0x1b1e0,0x1f20,0x3a0,0x7e0,0x3838,0x78,0x0,0x0,0x0,0x0,0x259e0,0x241e0,0x1a,0x1f0
.long 0x1f0,0x40000000,0x2e38,0x1c20,0xffff0000,0xffff0000,0x0,0x0,0x3c,0xf8,0x1b1f0,0x1f30,0x3e0,0x7f0,0x3c38,0x7c,0x0,0x0,0x0,0x0,0x259f0,0x241f0,0x1b,0x1f8
.long 0x200,0x40000000,0x1c0,0x2020,0x0,0x0,0xffff,0xffff,0x0,0x100,0x1b200,0x2300,0x20,0xb00,0x40000000,0x0,0x3f80,0x0,0x0,0x0,0x25a00,0x24200,0x8,0x220
.long 0x210,0x40000000,0x1c8,0x2030,0x0,0x0,0xffff0000,0xffff0000,0x4,0x108,0x1b210,0x2310,0x60,0xb10,0x40000000,0x4,0x3f800000,0x0,0x0,0x0,0x25a10,0x24210,0x9,0x228
.long 0x220,0x40000000,0x1d0,0x2000,0x0,0x0,0xffff,0xffff,0x8,0x110,0x1b220,0x2320,0xa0,0xb20,0x40000000,0x8,0x0,0x3f80,0x0,0x0,0x25a20,0x24220,0xa,0x230
.long 0x230,0x40000000,0x1d8,0x2010,0x0,0x0,0xffff0000,0xffff0000,0xc,0x118,0x1b230,0x2330,0xe0,0xb30,0x40000000,0xc,0x0,0x3f800000,0x0,0x0,0x25a30,0x24230,0xb,0x238
.long 0x240,0x40000000,0x5e0,0x2420,0x0,0x0,0xffff,0xffff,0x10,0x120,0x1b240,0x2700,0x130,0xb40,0x40000000,0x10,0x0,0x0,0x3f80,0x0,0x25a40,0x24240,0xc,0x260
.long 0x250,0x40000000,0x5e8,0x2430,0x0,0x0,0xffff0000,0xffff0000,0x14,0x128,0x1b250,0x2710,0x170,0xb50,0x40000000,0x14,0x0,0x0,0x3f800000,0x0,0x25a50,0x24250,0xd,0x268
.long 0x260,0x40000000,0x5f0,0x2400,0x0,0x0,0xffff,0xffff,0x18,0x130,0x1b260,0x2720,0x1b0,0xb60,0x40000000,0x18,0x0,0x0,0x0,0x3f80,0x25a60,0x24260,0xe,0x270
.long 0x270,0x40000000,0x5f8,0x2410,0x0,0x0,0xffff0000,0xffff0000,0x1c,0x138,0x1b270,0x2730,0x1f0,0xb70,0x40000000,0x1c,0x0,0x0,0x0,0x3f800000,0x25a70,0x24270,0xf,0x278
.long 0x280,0x40000000,0xa00,0x2820,0xffff,0x0,0x0,0xffff,0x20,0x140,0x1b280,0x2b00,0x200,0xb80,0x40000000,0x20,0x0,0x0,0x0,0x0,0x25a80,0x24280,0x10,0x2a0
.long 0x290,0x40000000,0xa08,0x2830,0xffff0000,0x0,0x0,0xffff0000,0x24,0x148,0x1b290,0x2b10,0x240,0xb90,0x40000000,0x24,0x0,0x0,0x0,0x0,0x25a90,0x24290,0x11,0x2a8
.long 0x2a0,0x40000000,0xa10,0x2800,0xffff,0xffff,0x0,0x0,0x28,0x150,0x1b2a0,0x2b20,0x280,0xba0,0x40000000,0x28,0x0,0x0,0x0,0x0,0x25aa0,0x242a0,0x12,0x2b0
.long 0x2b0,0x40000000,0xa18,0x2810,0xffff0000,0xffff0000,0x0,0x0,0x2c,0x158,0x1b2b0,0x2b30,0x2c0,0xbb0,0x40000000,0x2c,0x0,0x0,0x0,0x0,0x25ab0,0x242b0,0x13,0x2b8
.long 0x2c0,0x40000000,0xe20,0x2c20,0xffff,0xffff,0x0,0x0,0x30,0x160,0x1b2c0,0x2f00,0x310,0xbc0,0x40000000,0x30,0x0,0x0,0x0,0x0,0x25ac0,0x242c0,0x14,0x2e0
.long 0x2d0,0x40000000,0xe28,0x2c30,0xffff0000,0xffff0000,0x0,0x0,0x34,0x168,0x1b2d0,0x2f10,0x350,0xbd0,0x40000000,0x34,0x0,0x0,0x0,0x0,0x25ad0,0x242d0,0x15,0x2e8
.long 0x2e0,0x40000000,0xe30,0x2c00,0xffff,0xffff,0x0,0x0,0x38,0x170,0x1b2e0,0x2f20,0x390,0xbe0,0x40000000,0x38,0x0,0x0,0x0,0x0,0x25ae0,0x242e0,0x16,0x2f0
.long 0x2f0,0x40000000,0xe38,0x2c10,0xffff0000,0xffff0000,0x0,0x0,0x3c,0x178,0x1b2f0,0x2f30,0x3d0,0xbf0,0x40000000,0x3c,0x0,0x0,0x0,0x0,0x25af0,0x242f0,0x17,0x2f8
.long 0x300,0x40000000,0x22c0,0x3030,0x0,0x0,0xffff,0xffff,0x0,0x180,0x1b300,0x3300,0x30,0xf00,0x40000000,0x40,0x3f80,0x0,0x0,0x0,0x25b00,0x24300,0x4,0x320
.long 0x310,0x40000000,0x22c8,0x3020,0x0,0x0,0xffff0000,0xffff0000,0x4,0x188,0x1b310,0x3310,0x70,0xf10,0x40000000,0x44,0x3f800000,0x0,0x0,0x0,0x25b10,0x24310,0x5,0x328
.long 0x320,0x40000000,0x22d0,0x3010,0x0,0x0,0xffff,0xffff,0x8,0x190,0x1b320,0x3320,0xb0,0xf20,0x40000000,0x48,0x0,0x3f80,0x0,0x0,0x25b20,0x24320,0x6,0x330
.long 0x330,0x40000000,0x22d8,0x3000,0x0,0x0,0xffff0000,0xffff0000,0xc,0x198,0x1b330,0x3330,0xf0,0xf30,0x40000000,0x4c,0x0,0x3f800000,0x0,0x0,0x25b30,0x24330,0x7,0x338
.long 0x340,0x40000000,0x26e0,0x3430,0x0,0x0,0xffff,0xffff,0x10,0x1a0,0x1b340,0x3700,0x120,0xf40,0x40000000,0x50,0x0,0x0,0x3f80,0x0,0x25b40,0x24340,0x8,0x360
.long 0x350,0x40000000,0x26e8,0x3420,0x0,0x0,0xffff0000,0xffff0000,0x14,0x1a8,0x1b350,0x3710,0x160,0xf50,0x40000000,0x54,0x0,0x0,0x3f800000,0x0,0x25b50,0x24350,0x9,0x368
.long 0x360,0x40000000,0x26f0,0x3410,0x0,0x0,0xffff,0xffff,0x18,0x1b0,0x1b360,0x3720,0x1a0,0xf60,0x40000000,0x58,0x0,0x0,0x0,0x3f80,0x25b60,0x24360,0xa,0x370
.long 0x370,0x40000000,0x26f8,0x3400,0x0,0x0,0xffff0000,0xffff0000,0x1c,0x1b8,0x1b370,0x3730,0x1e0,0xf70,0x40000000,0x5c,0x0,0x0,0x0,0x3f800000,0x25b70,0x24370,0xb,0x378
.long 0x380,0x40000000,0x2b00,0x3830,0x0,0x0,0xffff,0xffff,0x20,0x1c0,0x1b380,0x3b00,0x210,0xf80,0x40000000,0x60,0x0,0x0,0x0,0x0,0x25b80,0x24380,0xc,0x3a0
.long 0x390,0x40000000,0x2b08,0x3820,0x0,0x0,0xffff0000,0xffff0000,0x24,0x1c8,0x1b390,0x3b10,0x250,0xf90,0x40000000,0x64,0x0,0x0,0x0,0x0,0x25b90,0x24390,0xd,0x3a8
.long 0x3a0,0x40000000,0x2b10,0x3810,0x0,0x0,0xffff,0xffff,0x28,0x1d0,0x1b3a0,0x3b20,0x290,0xfa0,0x40000000,0x68,0x0,0x0,0x0,0x0,0x25ba0,0x243a0,0xe,0x3b0
.long 0x3b0,0x40000000,0x2b18,0x3800,0x0,0x0,0xffff0000,0xffff0000,0x2c,0x1d8,0x1b3b0,0x3b30,0x2d0,0xfb0,0x40000000,0x6c,0x0,0x0,0x0,0x0,0x25bb0,0x243b0,0xf,0x3b8
.long 0x3c0,0x40000000,0x2f20,0x3c30,0xffff,0x0,0x0,0xffff,0x30,0x1e0,0x1b3c0,0x3f00,0x300,0xfc0,0x40000000,0x70,0x0,0x0,0x0,0x0,0x25bc0,0x243c0,0x10,0x3e0
.long 0x3d0,0x40000000,0x2f28,0x3c20,0xffff0000,0x0,0x0,0xffff0000,0x34,0x1e8,0x1b3d0,0x3f10,0x340,0xfd0,0x40000000,0x74,0x0,0x0,0x0,0x0,0x25bd0,0x243d0,0x11,0x3e8
.long 0x3e0,0x40000000,0x2f30,0x3c10,0xffff,0xffff,0x0,0x0,0x38,0x1f0,0x1b3e0,0x3f20,0x380,0xfe0,0x40000000,0x78,0x0,0x0,0x0,0x0,0x25be0,0x243e0,0x12,0x3f0
.long 0x3f0,0x40000000,0x2f38,0x3c00,0xffff0000,0xffff0000,0x0,0x0,0x3c,0x1f8,0x1b3f0,0x3f30,0x3c0,0xff0,0x40000000,0x7c,0x0,0x0,0x0,0x0,0x25bf0,0x243f0,0x13,0x3f8
.section .rodata,"a"
.p2align 6
.amdhsa_kernel gated_mix__memory_aug_recurrent_mem_tr__sliding_local_dilated__prompt_kernel
  .amdhsa_next_free_vgpr 512
  .amdhsa_next_free_sgpr 102
  .amdhsa_accum_offset 256
  .amdhsa_group_segment_fixed_size 0
  .amdhsa_kernarg_size 112
  .amdhsa_user_sgpr_count 2
  .amdhsa_user_sgpr_kernarg_segment_ptr 1
  .amdhsa_system_sgpr_workgroup_id_x 1
  .amdhsa_float_denorm_mode_32 3
.end_amdhsa_kernel
```
